```python
import torch

def _softmax(x, axis=-1):
    return torch.softmax(x, dim=axis)
def _gelu(x):
    return torch.nn.functional.gelu(x, approximate="tanh")
def _silu(x):
    return torch.nn.functional.silu(x)
def _sigmoid(x):
    return torch.sigmoid(x)
def _layernorm(x, axis=-1, eps=1e-5):
    m = x.mean(dim=axis, keepdim=True)
    v = x.var(dim=axis, keepdim=True, unbiased=False)
    return (x - m) / torch.sqrt(v + eps)
def _scatter_add(tgt, idx, src, axis=0):
    return tgt.clone().index_add_(axis, idx, src)
def _segment_sum(src, seg, n):
    out = torch.zeros((n,) + src.shape[1:], dtype=src.dtype)
    return out.index_add_(0, seg, src)
def _pad(x, pw):
    flat = tuple(v for pair in reversed(pw) for v in pair)
    return torch.nn.functional.pad(x, flat)

kernel_name = 'parallel_sum__ssm_conv_h3__mixer_channel_mlp__prompt'

def setup_inputs():

    _w = (lambda a: (lambda t: t.to(torch.bfloat16) if t.is_floating_point() else t)(torch.as_tensor(a)))
    def _A_setup():
        B, S, D = 1, 2048, 1024
        ks = 4
        return {
            "q": _w((lambda *s: torch.randn(*s, dtype=torch.bfloat16) * 0.05)(B, S, D)),
            "k": _w((lambda *s: torch.randn(*s, dtype=torch.bfloat16) * 0.2)(B, S, D)),
            "v": _w((lambda *s: torch.randn(*s, dtype=torch.bfloat16) * 0.2)(B, S, D)),
            "shift_k": _w((lambda *s: torch.randn(*s, dtype=torch.bfloat16) * 0.2)(D, ks) * 0.5),
            "ssm_k": _w((lambda *s: torch.randn(*s, dtype=torch.bfloat16) * 0.8)(D, S) * (1.0 / S ** 0.5)),
            "ssm_D": _w((lambda *s: torch.randn(*s, dtype=torch.bfloat16) * 0.2)(D)),
        }
    _A_in = _A_setup()

    def _B_setup():
        B, S, D, F = 1, 2048, 1024, 3584
        return {
            "x": _w((lambda *s: torch.randn(*s, dtype=torch.bfloat16) * 0.05)(B, S, D)),
            "w1": _w((lambda *s: torch.randn(*s, dtype=torch.bfloat16) * 0.8)(D, F) * (D ** -0.5)),
            "b1": _w((lambda *s: torch.randn(*s, dtype=torch.bfloat16) * 0.4)(F)),
            "w2": _w((lambda *s: torch.randn(*s, dtype=torch.bfloat16) * 0.05)(F, D) * (F ** -0.5)),
            "b2": _w((lambda *s: torch.randn(*s, dtype=torch.bfloat16) * 0.05)(D)),
        }
    _B_in = _B_setup()

    return {
        "A_q": _A_in["q"],
        "A_k": _A_in["k"],
        "A_v": _A_in["v"],
        "A_shift_k": _A_in["shift_k"],
        "A_ssm_k": _A_in["ssm_k"],
        "A_ssm_D": _A_in["ssm_D"],
        "B_x": _B_in["x"],
        "B_w1": _B_in["w1"],
        "B_b1": _B_in["b1"],
        "B_w2": _B_in["w2"],
        "B_b2": _B_in["b2"],
    }

def reference(A_q, A_k, A_v, A_shift_k, A_ssm_k, A_ssm_D, B_x, B_w1, B_b1, B_w2, B_b2):
    def _A_ref(q, k, v, shift_k, ssm_k, ssm_D):
        B, S, D = q.shape
        ks = shift_k.shape[-1]
        k_pad = _pad(k, ((0, 0), (ks - 1, 0), (0, 0)))
        k_shift = torch.zeros_like(k)
        for t in range(ks):
            k_shift = k_shift + k_pad[:, t:t + S, :] * shift_k[:, ks - 1 - t][None, None, :]
        kv = k_shift * v
        L = 2 * S
        kv_pad = _pad(kv, ((0, 0), (0, S), (0, 0)))
        kf_pad = _pad(ssm_k, ((0, 0), (0, S)))
        kv_f = (lambda x, axes=(-2,-1): torch.fft.rfft2(x.float(), dim=axes))(kv_pad[:, None, :, :], axes=(1, 2))
        kf_f = (lambda x, axes=(-2,-1): torch.fft.rfft2(x.float(), dim=axes))(kf_pad[:, None, :], axes=(1, 2))
        kf_f = (lambda x, *d: x.permute(*d))(kf_f, 1, 2, 0)
        y_f = kv_f * kf_f[None, :, :, :]
        y = (lambda x, s, axes=(-2,-1): torch.fft.irfft2(x, s=s, dim=axes).to(torch.bfloat16))(y_f, (1, L), axes=(1, 2))[:, 0, :S, :]
        y = y + kv * ssm_D[None, None, :]
        return q * y

    def _B_ref(x, w1, b1, w2, b2):
        y = _layernorm(x, axis=-1)
        h = _gelu(torch.einsum("bsd,df->bsf", y, w1) + b1)
        return torch.einsum("bsf,fd->bsd", h, w2) + b2

    x = A_q
    xn = _layernorm(x, axis=-1)
    return x + _A_ref(xn, A_k, A_v, A_shift_k, A_ssm_k, A_ssm_D) + _B_ref(xn, B_w1, B_b1, B_w2, B_b2)
```

```asm
; @launch grid=(256,1,1) block=(512,1,1) lds=163840
.amdgcn_target "amdgcn-amd-amdhsa--gfx950"
.text
.globl parallel_sum__ssm_conv_h3__mixer_channel_mlp__prompt_kernel
.p2align 8
.type parallel_sum__ssm_conv_h3__mixer_channel_mlp__prompt_kernel,@function
parallel_sum__ssm_conv_h3__mixer_channel_mlp__prompt_kernel:
s_cmp_ge_u32 s2, 256
s_cbranch_scc1 L_end_parallel_sum__ssm_conv_h3__mixer_channel_mlp__prompt_kernel
s_load_dwordx16 s[64:79], s[0:1], 0
s_load_dwordx8 s[80:87], s[0:1], 64
s_load_dwordx4 s[88:91], s[0:1], 96
v_lshrrev_b32 v1, 6, v0
s_nop 1
v_readfirstlane_b32 s4, v1
v_and_b32 v1, 63, v0
s_and_b32 s5, s4, 3
s_and_b32 s10, s2, 7
s_lshr_b32 s11, s2, 3
s_and_b32 s6, s10, 1
s_lshl_b32 s6, s6, 3
s_and_b32 s12, s11, 7
s_add_u32 s6, s6, s12
s_lshr_b32 s7, s10, 1
s_lshl_b32 s7, s7, 2
s_lshr_b32 s12, s11, 3
s_add_u32 s7, s7, s12
s_and_b32 s8, s10, 3
s_lshl_b32 s8, s8, 2
s_and_b32 s12, s11, 3
s_add_u32 s8, s8, s12
s_lshr_b32 s12, s11, 2
s_lshl_b32 s9, s12, 1
s_lshr_b32 s12, s10, 2
s_add_u32 s9, s9, s12
s_waitcnt lgkmcnt(0)
s_mov_b32 s16, s64
s_and_b32 s17, s65, 0xffff
s_mov_b32 s18, 4194304
s_mov_b32 s19, 0x20000
s_mov_b32 s20, s78
s_and_b32 s21, s79, 0xffff
s_mov_b32 s22, 7340032
s_mov_b32 s23, 0x20000
s_mov_b32 s24, s90
s_and_b32 s25, s91, 0xffff
s_mov_b32 s26, 268435456
s_mov_b32 s27, 0x20000
s_cmp_ge_u32 s4, 4
s_cbranch_scc1 L_loader_parallel_sum__ssm_conv_h3__mixer_channel_mlp__prompt_kernel
v_lshrrev_b32 v143, 3, v1
v_and_b32 v144, 7, v1
v_xor_b32 v144, v144, v143
v_lshlrev_b32 v144, 4, v144
s_lshl_b32 s10, s5, 5
v_add_u32 v143, s10, v143
v_lshlrev_b32 v143, 11, v143
v_add_u32 v132, v143, v144
v_add_u32 v133, 15360, v132
v_add_u32 v134, 30720, v132
v_add_u32 v135, 46080, v132
s_lshl_b32 s50, s6, 18
s_lshl_b32 s51, s5, 12
s_add_u32 s51, s51, 86016
s_add_u32 m0, s51, 0
s_add_u32 s11, s50, 0
buffer_load_dwordx4 v132, s[16:19], s11 offen offset:0 lds
buffer_load_dwordx4 v133, s[16:19], s11 offen offset:1024 lds
buffer_load_dwordx4 v134, s[16:19], s11 offen offset:2048 lds
buffer_load_dwordx4 v135, s[16:19], s11 offen offset:3072 lds
v_add_u32 v143, 0, v1
v_mul_u32_u24 v144, 2341, v143
v_lshrrev_b32 v144, 16, v144
v_mul_u32_u24 v145, 28, v144
v_sub_u32 v143, v143, v145
v_lshrrev_b32 v145, 3, v144
v_lshlrev_b32 v145, 1, v145
v_xor_b32 v143, v143, v145
v_lshlrev_b32 v143, 4, v143
v_mul_u32_u24 v144, 7168, v144
v_add_u32 v143, v143, v144
v_subrev_u32 v136, 0, v143
v_add_u32 v143, 64, v1
v_mul_u32_u24 v144, 2341, v143
v_lshrrev_b32 v144, 16, v144
v_mul_u32_u24 v145, 28, v144
v_sub_u32 v143, v143, v145
v_lshrrev_b32 v145, 3, v144
v_lshlrev_b32 v145, 1, v145
v_xor_b32 v143, v143, v145
v_lshlrev_b32 v143, 4, v143
v_mul_u32_u24 v144, 7168, v144
v_add_u32 v143, v143, v144
v_subrev_u32 v137, 1024, v143
v_add_u32 v143, 128, v1
v_mul_u32_u24 v144, 2341, v143
v_lshrrev_b32 v144, 16, v144
v_mul_u32_u24 v145, 28, v144
v_sub_u32 v143, v143, v145
v_lshrrev_b32 v145, 3, v144
v_lshlrev_b32 v145, 1, v145
v_xor_b32 v143, v143, v145
v_lshlrev_b32 v143, 4, v143
v_mul_u32_u24 v144, 7168, v144
v_add_u32 v143, v143, v144
v_subrev_u32 v138, 2048, v143
v_add_u32 v143, 192, v1
v_mul_u32_u24 v144, 2341, v143
v_lshrrev_b32 v144, 16, v144
v_mul_u32_u24 v145, 28, v144
v_sub_u32 v143, v143, v145
v_lshrrev_b32 v145, 3, v144
v_lshlrev_b32 v145, 1, v145
v_xor_b32 v143, v143, v145
v_lshlrev_b32 v143, 4, v143
v_mul_u32_u24 v144, 7168, v144
v_add_u32 v143, v143, v144
v_subrev_u32 v139, 3072, v143
v_add_u32 v143, 256, v1
v_mul_u32_u24 v144, 2341, v143
v_lshrrev_b32 v144, 16, v144
v_mul_u32_u24 v145, 28, v144
v_sub_u32 v143, v143, v145
v_lshrrev_b32 v145, 3, v144
v_lshlrev_b32 v145, 1, v145
v_xor_b32 v143, v143, v145
v_lshlrev_b32 v143, 4, v143
v_mul_u32_u24 v144, 7168, v144
v_add_u32 v143, v143, v144
v_subrev_u32 v140, 0, v143
v_add_u32 v143, 320, v1
v_mul_u32_u24 v144, 2341, v143
v_lshrrev_b32 v144, 16, v144
v_mul_u32_u24 v145, 28, v144
v_sub_u32 v143, v143, v145
v_lshrrev_b32 v145, 3, v144
v_lshlrev_b32 v145, 1, v145
v_xor_b32 v143, v143, v145
v_lshlrev_b32 v143, 4, v143
v_mul_u32_u24 v144, 7168, v144
v_add_u32 v143, v143, v144
v_subrev_u32 v141, 1024, v143
v_add_u32 v143, 384, v1
v_mul_u32_u24 v144, 2341, v143
v_lshrrev_b32 v144, 16, v144
v_mul_u32_u24 v145, 28, v144
v_sub_u32 v143, v143, v145
v_lshrrev_b32 v145, 3, v144
v_lshlrev_b32 v145, 1, v145
v_xor_b32 v143, v143, v145
v_lshlrev_b32 v143, 4, v143
v_mul_u32_u24 v144, 7168, v144
v_add_u32 v143, v143, v144
v_subrev_u32 v142, 2048, v143
s_lshr_b32 s52, s5, 1
s_and_b32 s53, s5, 1
s_mul_i32 s54, s7, 448
s_mul_i32 s10, s53, 114688
s_add_u32 s54, s54, s10
s_mul_i32 s10, s52, 229376
s_sub_u32 s54, s54, s10
s_mul_i32 s55, s52, 71680
s_mul_i32 s10, s53, 7168
s_add_u32 s55, s55, s10
s_cmp_eq_u32 s52, 1
s_cbranch_scc1 L_skip_1
s_mov_b32 m0, s55
s_nop 0
buffer_load_dwordx4 v136, s[20:23], s54 offen offset:0 lds
buffer_load_dwordx4 v137, s[20:23], s54 offen offset:1024 lds
buffer_load_dwordx4 v138, s[20:23], s54 offen offset:2048 lds
buffer_load_dwordx4 v139, s[20:23], s54 offen offset:3072 lds
s_add_u32 m0, s55, 4096
s_nop 0
buffer_load_dwordx4 v140, s[20:23], s54 offen offset:0 lds
buffer_load_dwordx4 v141, s[20:23], s54 offen offset:1024 lds
buffer_load_dwordx4 v142, s[20:23], s54 offen offset:2048 lds
L_skip_1:
s_add_u32 s54, s54, 458752
s_add_u32 s55, s55, 28672
s_cmp_ge_u32 s55, 86016
s_cselect_b32 s10, 86016, 0
s_sub_u32 s55, s55, s10
s_add_u32 m0, s51, 16384
s_add_u32 s11, s50, 128
buffer_load_dwordx4 v132, s[16:19], s11 offen offset:0 lds
buffer_load_dwordx4 v133, s[16:19], s11 offen offset:1024 lds
buffer_load_dwordx4 v134, s[16:19], s11 offen offset:2048 lds
buffer_load_dwordx4 v135, s[16:19], s11 offen offset:3072 lds
s_mov_b32 m0, s55
s_nop 0
buffer_load_dwordx4 v136, s[20:23], s54 offen offset:0 lds
buffer_load_dwordx4 v137, s[20:23], s54 offen offset:1024 lds
buffer_load_dwordx4 v138, s[20:23], s54 offen offset:2048 lds
buffer_load_dwordx4 v139, s[20:23], s54 offen offset:3072 lds
s_add_u32 m0, s55, 4096
s_nop 0
buffer_load_dwordx4 v140, s[20:23], s54 offen offset:0 lds
buffer_load_dwordx4 v141, s[20:23], s54 offen offset:1024 lds
buffer_load_dwordx4 v142, s[20:23], s54 offen offset:2048 lds
s_add_u32 s54, s54, 458752
s_add_u32 s55, s55, 28672
s_cmp_ge_u32 s55, 86016
s_cselect_b32 s10, 86016, 0
s_sub_u32 s55, s55, s10
s_add_u32 m0, s51, 32768
s_add_u32 s11, s50, 256
buffer_load_dwordx4 v132, s[16:19], s11 offen offset:0 lds
buffer_load_dwordx4 v133, s[16:19], s11 offen offset:1024 lds
buffer_load_dwordx4 v134, s[16:19], s11 offen offset:2048 lds
buffer_load_dwordx4 v135, s[16:19], s11 offen offset:3072 lds
s_mov_b32 m0, s55
s_nop 0
buffer_load_dwordx4 v136, s[20:23], s54 offen offset:0 lds
buffer_load_dwordx4 v137, s[20:23], s54 offen offset:1024 lds
buffer_load_dwordx4 v138, s[20:23], s54 offen offset:2048 lds
buffer_load_dwordx4 v139, s[20:23], s54 offen offset:3072 lds
s_add_u32 m0, s55, 4096
s_nop 0
buffer_load_dwordx4 v140, s[20:23], s54 offen offset:0 lds
buffer_load_dwordx4 v141, s[20:23], s54 offen offset:1024 lds
buffer_load_dwordx4 v142, s[20:23], s54 offen offset:2048 lds
s_add_u32 s54, s54, 458752
s_add_u32 s55, s55, 28672
s_cmp_ge_u32 s55, 86016
s_cselect_b32 s10, 86016, 0
s_sub_u32 s55, s55, s10
s_and_b32 s44, s5, 1
s_lshr_b32 s45, s5, 1
v_and_b32 v8, 15, v1
v_lshrrev_b32 v9, 4, v1
s_lshl_b32 s10, s44, 6
v_add_u32 v10, s10, v8
v_lshlrev_b32 v10, 7, v10
v_and_b32 v11, 7, v8
v_xor_b32 v12, v9, v11
v_lshlrev_b32 v12, 4, v12
v_add_u32 v2, v10, v12
v_add_u32 v2, 86016, v2
v_xor_b32 v3, 64, v2
v_lshrrev_b32 v10, 2, v8
v_lshlrev_b32 v11, 3, v9
v_add_u32 v10, v10, v11
v_mul_u32_u24 v10, 448, v10
v_and_b32 v11, 3, v8
v_lshlrev_b32 v11, 3, v11
v_add_u32 v10, v10, v11
s_mul_i32 s10, s45, 224
s_add_u32 s10, s10, 0
v_add_u32 v10, s10, v10
v_and_b32 v11, 1, v9
v_lshlrev_b32 v11, 5, v11
v_add_u32 v12, v10, v11
v_sub_u32 v13, v10, v11
s_cmp_eq_u32 s45, 0
s_cselect_b64 vcc, -1, 0
v_cndmask_b32 v4, v13, v12, vcc
v_cndmask_b32 v5, v12, v13, vcc
v_add_u32 v6, 43008, v4
v_add_u32 v7, 43008, v5
s_waitcnt vmcnt(11)
s_barrier
ds_read_b64_tr_b16 a[32:33], v4 offset:0
ds_read_b64_tr_b16 a[34:35], v4 offset:1792
ds_read_b128 a[0:3], v2 offset:0
ds_read_b128 a[4:7], v2 offset:2048
ds_read_b128 a[8:11], v2 offset:4096
ds_read_b128 a[12:15], v2 offset:6144
ds_read_b64_tr_b16 a[36:37], v5 offset:32
ds_read_b64_tr_b16 a[38:39], v5 offset:1824
ds_read_b64_tr_b16 a[40:41], v4 offset:64
ds_read_b64_tr_b16 a[42:43], v4 offset:1856
ds_read_b64_tr_b16 a[44:45], v5 offset:96
ds_read_b64_tr_b16 a[46:47], v5 offset:1888
ds_read_b64_tr_b16 a[48:49], v4 offset:128
ds_read_b64_tr_b16 a[50:51], v4 offset:1920
ds_read_b64_tr_b16 a[52:53], v5 offset:160
ds_read_b64_tr_b16 a[54:55], v5 offset:1952
ds_read_b64_tr_b16 a[56:57], v4 offset:192
ds_read_b64_tr_b16 a[58:59], v4 offset:1984
s_waitcnt lgkmcnt(0)
s_barrier
v_mfma_f32_16x16x32_bf16 v[16:19], a[32:35], a[0:3], 0
ds_read_b64_tr_b16 a[60:61], v4 offset:14336
s_add_u32 m0, s51, 49152
s_add_u32 s11, s50, 384
buffer_load_dwordx4 v132, s[16:19], s11 offen offset:0 lds
v_mfma_f32_16x16x32_bf16 v[20:23], a[32:35], a[4:7], 0
ds_read_b64_tr_b16 a[62:63], v4 offset:16128
v_mfma_f32_16x16x32_bf16 v[24:27], a[32:35], a[8:11], 0
ds_read_b128 a[16:19], v3 offset:0
v_mfma_f32_16x16x32_bf16 v[28:31], a[32:35], a[12:15], 0
ds_read_b128 a[20:23], v3 offset:2048
v_mfma_f32_16x16x32_bf16 v[32:35], a[36:39], a[0:3], 0
ds_read_b128 a[24:27], v3 offset:4096
v_mfma_f32_16x16x32_bf16 v[36:39], a[36:39], a[4:7], 0
ds_read_b128 a[28:31], v3 offset:6144
buffer_load_dwordx4 v133, s[16:19], s11 offen offset:1024 lds
v_mfma_f32_16x16x32_bf16 v[40:43], a[36:39], a[8:11], 0
ds_read_b64_tr_b16 a[64:65], v5 offset:14368
v_mfma_f32_16x16x32_bf16 v[44:47], a[36:39], a[12:15], 0
ds_read_b64_tr_b16 a[66:67], v5 offset:16160
v_mfma_f32_16x16x32_bf16 v[48:51], a[40:43], a[0:3], 0
ds_read_b64_tr_b16 a[68:69], v4 offset:14400
v_mfma_f32_16x16x32_bf16 v[52:55], a[40:43], a[4:7], 0
ds_read_b64_tr_b16 a[70:71], v4 offset:16192
v_mfma_f32_16x16x32_bf16 v[56:59], a[40:43], a[8:11], 0
ds_read_b64_tr_b16 a[72:73], v5 offset:14432
buffer_load_dwordx4 v134, s[16:19], s11 offen offset:2048 lds
v_mfma_f32_16x16x32_bf16 v[60:63], a[40:43], a[12:15], 0
ds_read_b64_tr_b16 a[74:75], v5 offset:16224
v_mfma_f32_16x16x32_bf16 v[64:67], a[44:47], a[0:3], 0
ds_read_b64_tr_b16 a[76:77], v4 offset:14464
v_mfma_f32_16x16x32_bf16 v[68:71], a[44:47], a[4:7], 0
ds_read_b64_tr_b16 a[78:79], v4 offset:16256
v_mfma_f32_16x16x32_bf16 v[72:75], a[44:47], a[8:11], 0
ds_read_b64_tr_b16 a[80:81], v5 offset:14496
v_mfma_f32_16x16x32_bf16 v[76:79], a[44:47], a[12:15], 0
ds_read_b64_tr_b16 a[82:83], v5 offset:16288
buffer_load_dwordx4 v135, s[16:19], s11 offen offset:3072 lds
v_mfma_f32_16x16x32_bf16 v[80:83], a[48:51], a[0:3], 0
ds_read_b64_tr_b16 a[84:85], v4 offset:14528
v_mfma_f32_16x16x32_bf16 v[84:87], a[48:51], a[4:7], 0
ds_read_b64_tr_b16 a[86:87], v4 offset:16320
v_mfma_f32_16x16x32_bf16 v[88:91], a[48:51], a[8:11], 0
v_mfma_f32_16x16x32_bf16 v[92:95], a[48:51], a[12:15], 0
v_mfma_f32_16x16x32_bf16 v[96:99], a[52:55], a[0:3], 0
s_mov_b32 m0, s55
s_nop 0
buffer_load_dwordx4 v136, s[20:23], s54 offen offset:0 lds
v_mfma_f32_16x16x32_bf16 v[100:103], a[52:55], a[4:7], 0
v_mfma_f32_16x16x32_bf16 v[104:107], a[52:55], a[8:11], 0
v_mfma_f32_16x16x32_bf16 v[108:111], a[52:55], a[12:15], 0
v_mfma_f32_16x16x32_bf16 v[112:115], a[56:59], a[0:3], 0
v_mfma_f32_16x16x32_bf16 v[116:119], a[56:59], a[4:7], 0
buffer_load_dwordx4 v137, s[20:23], s54 offen offset:1024 lds
v_mfma_f32_16x16x32_bf16 v[120:123], a[56:59], a[8:11], 0
v_mfma_f32_16x16x32_bf16 v[124:127], a[56:59], a[12:15], 0
s_waitcnt lgkmcnt(0)
v_mfma_f32_16x16x32_bf16 v[16:19], a[60:63], a[16:19], v[16:19]
ds_read_b64_tr_b16 a[32:33], v4 offset:28672
buffer_load_dwordx4 v138, s[20:23], s54 offen offset:2048 lds
v_mfma_f32_16x16x32_bf16 v[20:23], a[60:63], a[20:23], v[20:23]
ds_read_b64_tr_b16 a[34:35], v4 offset:30464
v_mfma_f32_16x16x32_bf16 v[24:27], a[60:63], a[24:27], v[24:27]
ds_read_b128 a[0:3], v2 offset:16384
v_mfma_f32_16x16x32_bf16 v[28:31], a[60:63], a[28:31], v[28:31]
ds_read_b128 a[4:7], v2 offset:18432
v_mfma_f32_16x16x32_bf16 v[32:35], a[64:67], a[16:19], v[32:35]
ds_read_b128 a[8:11], v2 offset:20480
v_mfma_f32_16x16x32_bf16 v[36:39], a[64:67], a[20:23], v[36:39]
ds_read_b128 a[12:15], v2 offset:22528
buffer_load_dwordx4 v139, s[20:23], s54 offen offset:3072 lds
v_mfma_f32_16x16x32_bf16 v[40:43], a[64:67], a[24:27], v[40:43]
ds_read_b64_tr_b16 a[36:37], v5 offset:28704
v_mfma_f32_16x16x32_bf16 v[44:47], a[64:67], a[28:31], v[44:47]
ds_read_b64_tr_b16 a[38:39], v5 offset:30496
v_mfma_f32_16x16x32_bf16 v[48:51], a[68:71], a[16:19], v[48:51]
ds_read_b64_tr_b16 a[40:41], v4 offset:28736
v_mfma_f32_16x16x32_bf16 v[52:55], a[68:71], a[20:23], v[52:55]
ds_read_b64_tr_b16 a[42:43], v4 offset:30528
v_mfma_f32_16x16x32_bf16 v[56:59], a[68:71], a[24:27], v[56:59]
ds_read_b64_tr_b16 a[44:45], v5 offset:28768
s_add_u32 m0, s55, 4096
s_nop 0
buffer_load_dwordx4 v140, s[20:23], s54 offen offset:0 lds
v_mfma_f32_16x16x32_bf16 v[60:63], a[68:71], a[28:31], v[60:63]
ds_read_b64_tr_b16 a[46:47], v5 offset:30560
v_mfma_f32_16x16x32_bf16 v[64:67], a[72:75], a[16:19], v[64:67]
ds_read_b64_tr_b16 a[48:49], v4 offset:28800
v_mfma_f32_16x16x32_bf16 v[68:71], a[72:75], a[20:23], v[68:71]
ds_read_b64_tr_b16 a[50:51], v4 offset:30592
v_mfma_f32_16x16x32_bf16 v[72:75], a[72:75], a[24:27], v[72:75]
ds_read_b64_tr_b16 a[52:53], v5 offset:28832
v_mfma_f32_16x16x32_bf16 v[76:79], a[72:75], a[28:31], v[76:79]
ds_read_b64_tr_b16 a[54:55], v5 offset:30624
buffer_load_dwordx4 v141, s[20:23], s54 offen offset:1024 lds
v_mfma_f32_16x16x32_bf16 v[80:83], a[76:79], a[16:19], v[80:83]
ds_read_b64_tr_b16 a[56:57], v4 offset:28864
v_mfma_f32_16x16x32_bf16 v[84:87], a[76:79], a[20:23], v[84:87]
ds_read_b64_tr_b16 a[58:59], v4 offset:30656
v_mfma_f32_16x16x32_bf16 v[88:91], a[76:79], a[24:27], v[88:91]
v_mfma_f32_16x16x32_bf16 v[92:95], a[76:79], a[28:31], v[92:95]
v_mfma_f32_16x16x32_bf16 v[96:99], a[80:83], a[16:19], v[96:99]
buffer_load_dwordx4 v142, s[20:23], s54 offen offset:2048 lds
s_add_u32 s54, s54, 458752
s_add_u32 s55, s55, 28672
s_cmp_ge_u32 s55, 86016
s_cselect_b32 s10, 86016, 0
s_sub_u32 s55, s55, s10
v_mfma_f32_16x16x32_bf16 v[100:103], a[80:83], a[20:23], v[100:103]
v_mfma_f32_16x16x32_bf16 v[104:107], a[80:83], a[24:27], v[104:107]
v_mfma_f32_16x16x32_bf16 v[108:111], a[80:83], a[28:31], v[108:111]
v_mfma_f32_16x16x32_bf16 v[112:115], a[84:87], a[16:19], v[112:115]
v_mfma_f32_16x16x32_bf16 v[116:119], a[84:87], a[20:23], v[116:119]
v_mfma_f32_16x16x32_bf16 v[120:123], a[84:87], a[24:27], v[120:123]
v_mfma_f32_16x16x32_bf16 v[124:127], a[84:87], a[28:31], v[124:127]
s_waitcnt lgkmcnt(0)
s_waitcnt vmcnt(11)
s_barrier
v_mfma_f32_16x16x32_bf16 v[16:19], a[32:35], a[0:3], v[16:19]
ds_read_b64_tr_b16 a[60:61], v6 offset:0
s_add_u32 m0, s51, 0
s_add_u32 s11, s50, 512
buffer_load_dwordx4 v132, s[16:19], s11 offen offset:0 lds
v_mfma_f32_16x16x32_bf16 v[20:23], a[32:35], a[4:7], v[20:23]
ds_read_b64_tr_b16 a[62:63], v6 offset:1792
v_mfma_f32_16x16x32_bf16 v[24:27], a[32:35], a[8:11], v[24:27]
ds_read_b128 a[16:19], v3 offset:16384
v_mfma_f32_16x16x32_bf16 v[28:31], a[32:35], a[12:15], v[28:31]
ds_read_b128 a[20:23], v3 offset:18432
v_mfma_f32_16x16x32_bf16 v[32:35], a[36:39], a[0:3], v[32:35]
ds_read_b128 a[24:27], v3 offset:20480
v_mfma_f32_16x16x32_bf16 v[36:39], a[36:39], a[4:7], v[36:39]
ds_read_b128 a[28:31], v3 offset:22528
buffer_load_dwordx4 v133, s[16:19], s11 offen offset:1024 lds
v_mfma_f32_16x16x32_bf16 v[40:43], a[36:39], a[8:11], v[40:43]
ds_read_b64_tr_b16 a[64:65], v7 offset:32
v_mfma_f32_16x16x32_bf16 v[44:47], a[36:39], a[12:15], v[44:47]
ds_read_b64_tr_b16 a[66:67], v7 offset:1824
v_mfma_f32_16x16x32_bf16 v[48:51], a[40:43], a[0:3], v[48:51]
ds_read_b64_tr_b16 a[68:69], v6 offset:64
v_mfma_f32_16x16x32_bf16 v[52:55], a[40:43], a[4:7], v[52:55]
ds_read_b64_tr_b16 a[70:71], v6 offset:1856
v_mfma_f32_16x16x32_bf16 v[56:59], a[40:43], a[8:11], v[56:59]
ds_read_b64_tr_b16 a[72:73], v7 offset:96
buffer_load_dwordx4 v134, s[16:19], s11 offen offset:2048 lds
v_mfma_f32_16x16x32_bf16 v[60:63], a[40:43], a[12:15], v[60:63]
ds_read_b64_tr_b16 a[74:75], v7 offset:1888
v_mfma_f32_16x16x32_bf16 v[64:67], a[44:47], a[0:3], v[64:67]
ds_read_b64_tr_b16 a[76:77], v6 offset:128
v_mfma_f32_16x16x32_bf16 v[68:71], a[44:47], a[4:7], v[68:71]
ds_read_b64_tr_b16 a[78:79], v6 offset:1920
v_mfma_f32_16x16x32_bf16 v[72:75], a[44:47], a[8:11], v[72:75]
ds_read_b64_tr_b16 a[80:81], v7 offset:160
v_mfma_f32_16x16x32_bf16 v[76:79], a[44:47], a[12:15], v[76:79]
ds_read_b64_tr_b16 a[82:83], v7 offset:1952
buffer_load_dwordx4 v135, s[16:19], s11 offen offset:3072 lds
v_mfma_f32_16x16x32_bf16 v[80:83], a[48:51], a[0:3], v[80:83]
ds_read_b64_tr_b16 a[84:85], v6 offset:192
v_mfma_f32_16x16x32_bf16 v[84:87], a[48:51], a[4:7], v[84:87]
ds_read_b64_tr_b16 a[86:87], v6 offset:1984
v_mfma_f32_16x16x32_bf16 v[88:91], a[48:51], a[8:11], v[88:91]
v_mfma_f32_16x16x32_bf16 v[92:95], a[48:51], a[12:15], v[92:95]
v_mfma_f32_16x16x32_bf16 v[96:99], a[52:55], a[0:3], v[96:99]
s_mov_b32 m0, s55
s_nop 0
buffer_load_dwordx4 v136, s[20:23], s54 offen offset:0 lds
v_mfma_f32_16x16x32_bf16 v[100:103], a[52:55], a[4:7], v[100:103]
v_mfma_f32_16x16x32_bf16 v[104:107], a[52:55], a[8:11], v[104:107]
v_mfma_f32_16x16x32_bf16 v[108:111], a[52:55], a[12:15], v[108:111]
v_mfma_f32_16x16x32_bf16 v[112:115], a[56:59], a[0:3], v[112:115]
v_mfma_f32_16x16x32_bf16 v[116:119], a[56:59], a[4:7], v[116:119]
buffer_load_dwordx4 v137, s[20:23], s54 offen offset:1024 lds
v_mfma_f32_16x16x32_bf16 v[120:123], a[56:59], a[8:11], v[120:123]
v_mfma_f32_16x16x32_bf16 v[124:127], a[56:59], a[12:15], v[124:127]
s_waitcnt lgkmcnt(0)
v_mfma_f32_16x16x32_bf16 v[16:19], a[60:63], a[16:19], v[16:19]
ds_read_b64_tr_b16 a[32:33], v6 offset:14336
buffer_load_dwordx4 v138, s[20:23], s54 offen offset:2048 lds
v_mfma_f32_16x16x32_bf16 v[20:23], a[60:63], a[20:23], v[20:23]
ds_read_b64_tr_b16 a[34:35], v6 offset:16128
v_mfma_f32_16x16x32_bf16 v[24:27], a[60:63], a[24:27], v[24:27]
ds_read_b128 a[0:3], v2 offset:32768
v_mfma_f32_16x16x32_bf16 v[28:31], a[60:63], a[28:31], v[28:31]
ds_read_b128 a[4:7], v2 offset:34816
v_mfma_f32_16x16x32_bf16 v[32:35], a[64:67], a[16:19], v[32:35]
ds_read_b128 a[8:11], v2 offset:36864
v_mfma_f32_16x16x32_bf16 v[36:39], a[64:67], a[20:23], v[36:39]
ds_read_b128 a[12:15], v2 offset:38912
buffer_load_dwordx4 v139, s[20:23], s54 offen offset:3072 lds
v_mfma_f32_16x16x32_bf16 v[40:43], a[64:67], a[24:27], v[40:43]
ds_read_b64_tr_b16 a[36:37], v7 offset:14368
v_mfma_f32_16x16x32_bf16 v[44:47], a[64:67], a[28:31], v[44:47]
ds_read_b64_tr_b16 a[38:39], v7 offset:16160
v_mfma_f32_16x16x32_bf16 v[48:51], a[68:71], a[16:19], v[48:51]
ds_read_b64_tr_b16 a[40:41], v6 offset:14400
v_mfma_f32_16x16x32_bf16 v[52:55], a[68:71], a[20:23], v[52:55]
ds_read_b64_tr_b16 a[42:43], v6 offset:16192
v_mfma_f32_16x16x32_bf16 v[56:59], a[68:71], a[24:27], v[56:59]
ds_read_b64_tr_b16 a[44:45], v7 offset:14432
s_add_u32 m0, s55, 4096
s_nop 0
buffer_load_dwordx4 v140, s[20:23], s54 offen offset:0 lds
v_mfma_f32_16x16x32_bf16 v[60:63], a[68:71], a[28:31], v[60:63]
ds_read_b64_tr_b16 a[46:47], v7 offset:16224
v_mfma_f32_16x16x32_bf16 v[64:67], a[72:75], a[16:19], v[64:67]
ds_read_b64_tr_b16 a[48:49], v6 offset:14464
v_mfma_f32_16x16x32_bf16 v[68:71], a[72:75], a[20:23], v[68:71]
ds_read_b64_tr_b16 a[50:51], v6 offset:16256
v_mfma_f32_16x16x32_bf16 v[72:75], a[72:75], a[24:27], v[72:75]
ds_read_b64_tr_b16 a[52:53], v7 offset:14496
v_mfma_f32_16x16x32_bf16 v[76:79], a[72:75], a[28:31], v[76:79]
ds_read_b64_tr_b16 a[54:55], v7 offset:16288
buffer_load_dwordx4 v141, s[20:23], s54 offen offset:1024 lds
v_mfma_f32_16x16x32_bf16 v[80:83], a[76:79], a[16:19], v[80:83]
ds_read_b64_tr_b16 a[56:57], v6 offset:14528
v_mfma_f32_16x16x32_bf16 v[84:87], a[76:79], a[20:23], v[84:87]
ds_read_b64_tr_b16 a[58:59], v6 offset:16320
v_mfma_f32_16x16x32_bf16 v[88:91], a[76:79], a[24:27], v[88:91]
v_mfma_f32_16x16x32_bf16 v[92:95], a[76:79], a[28:31], v[92:95]
v_mfma_f32_16x16x32_bf16 v[96:99], a[80:83], a[16:19], v[96:99]
buffer_load_dwordx4 v142, s[20:23], s54 offen offset:2048 lds
s_add_u32 s54, s54, 458752
s_add_u32 s55, s55, 28672
s_cmp_ge_u32 s55, 86016
s_cselect_b32 s10, 86016, 0
s_sub_u32 s55, s55, s10
v_mfma_f32_16x16x32_bf16 v[100:103], a[80:83], a[20:23], v[100:103]
v_mfma_f32_16x16x32_bf16 v[104:107], a[80:83], a[24:27], v[104:107]
v_mfma_f32_16x16x32_bf16 v[108:111], a[80:83], a[28:31], v[108:111]
v_mfma_f32_16x16x32_bf16 v[112:115], a[84:87], a[16:19], v[112:115]
v_mfma_f32_16x16x32_bf16 v[116:119], a[84:87], a[20:23], v[116:119]
v_mfma_f32_16x16x32_bf16 v[120:123], a[84:87], a[24:27], v[120:123]
v_mfma_f32_16x16x32_bf16 v[124:127], a[84:87], a[28:31], v[124:127]
s_waitcnt lgkmcnt(0)
s_waitcnt vmcnt(11)
s_barrier
v_mfma_f32_16x16x32_bf16 v[16:19], a[32:35], a[0:3], v[16:19]
ds_read_b64_tr_b16 a[60:61], v6 offset:28672
s_add_u32 m0, s51, 16384
s_add_u32 s11, s50, 640
buffer_load_dwordx4 v132, s[16:19], s11 offen offset:0 lds
v_mfma_f32_16x16x32_bf16 v[20:23], a[32:35], a[4:7], v[20:23]
ds_read_b64_tr_b16 a[62:63], v6 offset:30464
v_mfma_f32_16x16x32_bf16 v[24:27], a[32:35], a[8:11], v[24:27]
ds_read_b128 a[16:19], v3 offset:32768
v_mfma_f32_16x16x32_bf16 v[28:31], a[32:35], a[12:15], v[28:31]
ds_read_b128 a[20:23], v3 offset:34816
v_mfma_f32_16x16x32_bf16 v[32:35], a[36:39], a[0:3], v[32:35]
ds_read_b128 a[24:27], v3 offset:36864
v_mfma_f32_16x16x32_bf16 v[36:39], a[36:39], a[4:7], v[36:39]
ds_read_b128 a[28:31], v3 offset:38912
buffer_load_dwordx4 v133, s[16:19], s11 offen offset:1024 lds
v_mfma_f32_16x16x32_bf16 v[40:43], a[36:39], a[8:11], v[40:43]
ds_read_b64_tr_b16 a[64:65], v7 offset:28704
v_mfma_f32_16x16x32_bf16 v[44:47], a[36:39], a[12:15], v[44:47]
ds_read_b64_tr_b16 a[66:67], v7 offset:30496
v_mfma_f32_16x16x32_bf16 v[48:51], a[40:43], a[0:3], v[48:51]
ds_read_b64_tr_b16 a[68:69], v6 offset:28736
v_mfma_f32_16x16x32_bf16 v[52:55], a[40:43], a[4:7], v[52:55]
ds_read_b64_tr_b16 a[70:71], v6 offset:30528
v_mfma_f32_16x16x32_bf16 v[56:59], a[40:43], a[8:11], v[56:59]
ds_read_b64_tr_b16 a[72:73], v7 offset:28768
buffer_load_dwordx4 v134, s[16:19], s11 offen offset:2048 lds
v_mfma_f32_16x16x32_bf16 v[60:63], a[40:43], a[12:15], v[60:63]
ds_read_b64_tr_b16 a[74:75], v7 offset:30560
v_mfma_f32_16x16x32_bf16 v[64:67], a[44:47], a[0:3], v[64:67]
ds_read_b64_tr_b16 a[76:77], v6 offset:28800
v_mfma_f32_16x16x32_bf16 v[68:71], a[44:47], a[4:7], v[68:71]
ds_read_b64_tr_b16 a[78:79], v6 offset:30592
v_mfma_f32_16x16x32_bf16 v[72:75], a[44:47], a[8:11], v[72:75]
ds_read_b64_tr_b16 a[80:81], v7 offset:28832
v_mfma_f32_16x16x32_bf16 v[76:79], a[44:47], a[12:15], v[76:79]
ds_read_b64_tr_b16 a[82:83], v7 offset:30624
buffer_load_dwordx4 v135, s[16:19], s11 offen offset:3072 lds
v_mfma_f32_16x16x32_bf16 v[80:83], a[48:51], a[0:3], v[80:83]
ds_read_b64_tr_b16 a[84:85], v6 offset:28864
v_mfma_f32_16x16x32_bf16 v[84:87], a[48:51], a[4:7], v[84:87]
ds_read_b64_tr_b16 a[86:87], v6 offset:30656
v_mfma_f32_16x16x32_bf16 v[88:91], a[48:51], a[8:11], v[88:91]
v_mfma_f32_16x16x32_bf16 v[92:95], a[48:51], a[12:15], v[92:95]
v_mfma_f32_16x16x32_bf16 v[96:99], a[52:55], a[0:3], v[96:99]
s_mov_b32 m0, s55
s_nop 0
buffer_load_dwordx4 v136, s[20:23], s54 offen offset:0 lds
v_mfma_f32_16x16x32_bf16 v[100:103], a[52:55], a[4:7], v[100:103]
v_mfma_f32_16x16x32_bf16 v[104:107], a[52:55], a[8:11], v[104:107]
v_mfma_f32_16x16x32_bf16 v[108:111], a[52:55], a[12:15], v[108:111]
v_mfma_f32_16x16x32_bf16 v[112:115], a[56:59], a[0:3], v[112:115]
v_mfma_f32_16x16x32_bf16 v[116:119], a[56:59], a[4:7], v[116:119]
buffer_load_dwordx4 v137, s[20:23], s54 offen offset:1024 lds
v_mfma_f32_16x16x32_bf16 v[120:123], a[56:59], a[8:11], v[120:123]
v_mfma_f32_16x16x32_bf16 v[124:127], a[56:59], a[12:15], v[124:127]
s_waitcnt lgkmcnt(0)
v_mfma_f32_16x16x32_bf16 v[16:19], a[60:63], a[16:19], v[16:19]
ds_read_b64_tr_b16 a[32:33], v4 offset:0
buffer_load_dwordx4 v138, s[20:23], s54 offen offset:2048 lds
v_mfma_f32_16x16x32_bf16 v[20:23], a[60:63], a[20:23], v[20:23]
ds_read_b64_tr_b16 a[34:35], v4 offset:1792
v_mfma_f32_16x16x32_bf16 v[24:27], a[60:63], a[24:27], v[24:27]
ds_read_b128 a[0:3], v2 offset:49152
v_mfma_f32_16x16x32_bf16 v[28:31], a[60:63], a[28:31], v[28:31]
ds_read_b128 a[4:7], v2 offset:51200
v_mfma_f32_16x16x32_bf16 v[32:35], a[64:67], a[16:19], v[32:35]
ds_read_b128 a[8:11], v2 offset:53248
v_mfma_f32_16x16x32_bf16 v[36:39], a[64:67], a[20:23], v[36:39]
ds_read_b128 a[12:15], v2 offset:55296
buffer_load_dwordx4 v139, s[20:23], s54 offen offset:3072 lds
v_mfma_f32_16x16x32_bf16 v[40:43], a[64:67], a[24:27], v[40:43]
ds_read_b64_tr_b16 a[36:37], v5 offset:32
v_mfma_f32_16x16x32_bf16 v[44:47], a[64:67], a[28:31], v[44:47]
ds_read_b64_tr_b16 a[38:39], v5 offset:1824
v_mfma_f32_16x16x32_bf16 v[48:51], a[68:71], a[16:19], v[48:51]
ds_read_b64_tr_b16 a[40:41], v4 offset:64
v_mfma_f32_16x16x32_bf16 v[52:55], a[68:71], a[20:23], v[52:55]
ds_read_b64_tr_b16 a[42:43], v4 offset:1856
v_mfma_f32_16x16x32_bf16 v[56:59], a[68:71], a[24:27], v[56:59]
ds_read_b64_tr_b16 a[44:45], v5 offset:96
s_add_u32 m0, s55, 4096
s_nop 0
buffer_load_dwordx4 v140, s[20:23], s54 offen offset:0 lds
v_mfma_f32_16x16x32_bf16 v[60:63], a[68:71], a[28:31], v[60:63]
ds_read_b64_tr_b16 a[46:47], v5 offset:1888
v_mfma_f32_16x16x32_bf16 v[64:67], a[72:75], a[16:19], v[64:67]
ds_read_b64_tr_b16 a[48:49], v4 offset:128
v_mfma_f32_16x16x32_bf16 v[68:71], a[72:75], a[20:23], v[68:71]
ds_read_b64_tr_b16 a[50:51], v4 offset:1920
v_mfma_f32_16x16x32_bf16 v[72:75], a[72:75], a[24:27], v[72:75]
ds_read_b64_tr_b16 a[52:53], v5 offset:160
v_mfma_f32_16x16x32_bf16 v[76:79], a[72:75], a[28:31], v[76:79]
ds_read_b64_tr_b16 a[54:55], v5 offset:1952
buffer_load_dwordx4 v141, s[20:23], s54 offen offset:1024 lds
v_mfma_f32_16x16x32_bf16 v[80:83], a[76:79], a[16:19], v[80:83]
ds_read_b64_tr_b16 a[56:57], v4 offset:192
v_mfma_f32_16x16x32_bf16 v[84:87], a[76:79], a[20:23], v[84:87]
ds_read_b64_tr_b16 a[58:59], v4 offset:1984
v_mfma_f32_16x16x32_bf16 v[88:91], a[76:79], a[24:27], v[88:91]
v_mfma_f32_16x16x32_bf16 v[92:95], a[76:79], a[28:31], v[92:95]
v_mfma_f32_16x16x32_bf16 v[96:99], a[80:83], a[16:19], v[96:99]
buffer_load_dwordx4 v142, s[20:23], s54 offen offset:2048 lds
s_add_u32 s54, s54, 458752
s_add_u32 s55, s55, 28672
s_cmp_ge_u32 s55, 86016
s_cselect_b32 s10, 86016, 0
s_sub_u32 s55, s55, s10
v_mfma_f32_16x16x32_bf16 v[100:103], a[80:83], a[20:23], v[100:103]
v_mfma_f32_16x16x32_bf16 v[104:107], a[80:83], a[24:27], v[104:107]
v_mfma_f32_16x16x32_bf16 v[108:111], a[80:83], a[28:31], v[108:111]
v_mfma_f32_16x16x32_bf16 v[112:115], a[84:87], a[16:19], v[112:115]
v_mfma_f32_16x16x32_bf16 v[116:119], a[84:87], a[20:23], v[116:119]
v_mfma_f32_16x16x32_bf16 v[120:123], a[84:87], a[24:27], v[120:123]
v_mfma_f32_16x16x32_bf16 v[124:127], a[84:87], a[28:31], v[124:127]
s_waitcnt lgkmcnt(0)
s_waitcnt vmcnt(11)
s_barrier
v_mfma_f32_16x16x32_bf16 v[16:19], a[32:35], a[0:3], v[16:19]
ds_read_b64_tr_b16 a[60:61], v4 offset:14336
s_add_u32 m0, s51, 32768
s_add_u32 s11, s50, 768
buffer_load_dwordx4 v132, s[16:19], s11 offen offset:0 lds
v_mfma_f32_16x16x32_bf16 v[20:23], a[32:35], a[4:7], v[20:23]
ds_read_b64_tr_b16 a[62:63], v4 offset:16128
v_mfma_f32_16x16x32_bf16 v[24:27], a[32:35], a[8:11], v[24:27]
ds_read_b128 a[16:19], v3 offset:49152
v_mfma_f32_16x16x32_bf16 v[28:31], a[32:35], a[12:15], v[28:31]
ds_read_b128 a[20:23], v3 offset:51200
v_mfma_f32_16x16x32_bf16 v[32:35], a[36:39], a[0:3], v[32:35]
ds_read_b128 a[24:27], v3 offset:53248
v_mfma_f32_16x16x32_bf16 v[36:39], a[36:39], a[4:7], v[36:39]
ds_read_b128 a[28:31], v3 offset:55296
buffer_load_dwordx4 v133, s[16:19], s11 offen offset:1024 lds
v_mfma_f32_16x16x32_bf16 v[40:43], a[36:39], a[8:11], v[40:43]
ds_read_b64_tr_b16 a[64:65], v5 offset:14368
v_mfma_f32_16x16x32_bf16 v[44:47], a[36:39], a[12:15], v[44:47]
ds_read_b64_tr_b16 a[66:67], v5 offset:16160
v_mfma_f32_16x16x32_bf16 v[48:51], a[40:43], a[0:3], v[48:51]
ds_read_b64_tr_b16 a[68:69], v4 offset:14400
v_mfma_f32_16x16x32_bf16 v[52:55], a[40:43], a[4:7], v[52:55]
ds_read_b64_tr_b16 a[70:71], v4 offset:16192
v_mfma_f32_16x16x32_bf16 v[56:59], a[40:43], a[8:11], v[56:59]
ds_read_b64_tr_b16 a[72:73], v5 offset:14432
buffer_load_dwordx4 v134, s[16:19], s11 offen offset:2048 lds
v_mfma_f32_16x16x32_bf16 v[60:63], a[40:43], a[12:15], v[60:63]
ds_read_b64_tr_b16 a[74:75], v5 offset:16224
v_mfma_f32_16x16x32_bf16 v[64:67], a[44:47], a[0:3], v[64:67]
ds_read_b64_tr_b16 a[76:77], v4 offset:14464
v_mfma_f32_16x16x32_bf16 v[68:71], a[44:47], a[4:7], v[68:71]
ds_read_b64_tr_b16 a[78:79], v4 offset:16256
v_mfma_f32_16x16x32_bf16 v[72:75], a[44:47], a[8:11], v[72:75]
ds_read_b64_tr_b16 a[80:81], v5 offset:14496
v_mfma_f32_16x16x32_bf16 v[76:79], a[44:47], a[12:15], v[76:79]
ds_read_b64_tr_b16 a[82:83], v5 offset:16288
buffer_load_dwordx4 v135, s[16:19], s11 offen offset:3072 lds
v_mfma_f32_16x16x32_bf16 v[80:83], a[48:51], a[0:3], v[80:83]
ds_read_b64_tr_b16 a[84:85], v4 offset:14528
v_mfma_f32_16x16x32_bf16 v[84:87], a[48:51], a[4:7], v[84:87]
ds_read_b64_tr_b16 a[86:87], v4 offset:16320
v_mfma_f32_16x16x32_bf16 v[88:91], a[48:51], a[8:11], v[88:91]
v_mfma_f32_16x16x32_bf16 v[92:95], a[48:51], a[12:15], v[92:95]
v_mfma_f32_16x16x32_bf16 v[96:99], a[52:55], a[0:3], v[96:99]
s_mov_b32 m0, s55
s_nop 0
buffer_load_dwordx4 v136, s[20:23], s54 offen offset:0 lds
v_mfma_f32_16x16x32_bf16 v[100:103], a[52:55], a[4:7], v[100:103]
v_mfma_f32_16x16x32_bf16 v[104:107], a[52:55], a[8:11], v[104:107]
v_mfma_f32_16x16x32_bf16 v[108:111], a[52:55], a[12:15], v[108:111]
v_mfma_f32_16x16x32_bf16 v[112:115], a[56:59], a[0:3], v[112:115]
v_mfma_f32_16x16x32_bf16 v[116:119], a[56:59], a[4:7], v[116:119]
buffer_load_dwordx4 v137, s[20:23], s54 offen offset:1024 lds
v_mfma_f32_16x16x32_bf16 v[120:123], a[56:59], a[8:11], v[120:123]
v_mfma_f32_16x16x32_bf16 v[124:127], a[56:59], a[12:15], v[124:127]
s_waitcnt lgkmcnt(0)
v_mfma_f32_16x16x32_bf16 v[16:19], a[60:63], a[16:19], v[16:19]
ds_read_b64_tr_b16 a[32:33], v4 offset:28672
buffer_load_dwordx4 v138, s[20:23], s54 offen offset:2048 lds
v_mfma_f32_16x16x32_bf16 v[20:23], a[60:63], a[20:23], v[20:23]
ds_read_b64_tr_b16 a[34:35], v4 offset:30464
v_mfma_f32_16x16x32_bf16 v[24:27], a[60:63], a[24:27], v[24:27]
ds_read_b128 a[0:3], v2 offset:0
v_mfma_f32_16x16x32_bf16 v[28:31], a[60:63], a[28:31], v[28:31]
ds_read_b128 a[4:7], v2 offset:2048
v_mfma_f32_16x16x32_bf16 v[32:35], a[64:67], a[16:19], v[32:35]
ds_read_b128 a[8:11], v2 offset:4096
v_mfma_f32_16x16x32_bf16 v[36:39], a[64:67], a[20:23], v[36:39]
ds_read_b128 a[12:15], v2 offset:6144
buffer_load_dwordx4 v139, s[20:23], s54 offen offset:3072 lds
v_mfma_f32_16x16x32_bf16 v[40:43], a[64:67], a[24:27], v[40:43]
ds_read_b64_tr_b16 a[36:37], v5 offset:28704
v_mfma_f32_16x16x32_bf16 v[44:47], a[64:67], a[28:31], v[44:47]
ds_read_b64_tr_b16 a[38:39], v5 offset:30496
v_mfma_f32_16x16x32_bf16 v[48:51], a[68:71], a[16:19], v[48:51]
ds_read_b64_tr_b16 a[40:41], v4 offset:28736
v_mfma_f32_16x16x32_bf16 v[52:55], a[68:71], a[20:23], v[52:55]
ds_read_b64_tr_b16 a[42:43], v4 offset:30528
v_mfma_f32_16x16x32_bf16 v[56:59], a[68:71], a[24:27], v[56:59]
ds_read_b64_tr_b16 a[44:45], v5 offset:28768
s_add_u32 m0, s55, 4096
s_nop 0
buffer_load_dwordx4 v140, s[20:23], s54 offen offset:0 lds
v_mfma_f32_16x16x32_bf16 v[60:63], a[68:71], a[28:31], v[60:63]
ds_read_b64_tr_b16 a[46:47], v5 offset:30560
v_mfma_f32_16x16x32_bf16 v[64:67], a[72:75], a[16:19], v[64:67]
ds_read_b64_tr_b16 a[48:49], v4 offset:28800
v_mfma_f32_16x16x32_bf16 v[68:71], a[72:75], a[20:23], v[68:71]
ds_read_b64_tr_b16 a[50:51], v4 offset:30592
v_mfma_f32_16x16x32_bf16 v[72:75], a[72:75], a[24:27], v[72:75]
ds_read_b64_tr_b16 a[52:53], v5 offset:28832
v_mfma_f32_16x16x32_bf16 v[76:79], a[72:75], a[28:31], v[76:79]
ds_read_b64_tr_b16 a[54:55], v5 offset:30624
buffer_load_dwordx4 v141, s[20:23], s54 offen offset:1024 lds
v_mfma_f32_16x16x32_bf16 v[80:83], a[76:79], a[16:19], v[80:83]
ds_read_b64_tr_b16 a[56:57], v4 offset:28864
v_mfma_f32_16x16x32_bf16 v[84:87], a[76:79], a[20:23], v[84:87]
ds_read_b64_tr_b16 a[58:59], v4 offset:30656
v_mfma_f32_16x16x32_bf16 v[88:91], a[76:79], a[24:27], v[88:91]
v_mfma_f32_16x16x32_bf16 v[92:95], a[76:79], a[28:31], v[92:95]
v_mfma_f32_16x16x32_bf16 v[96:99], a[80:83], a[16:19], v[96:99]
buffer_load_dwordx4 v142, s[20:23], s54 offen offset:2048 lds
s_add_u32 s54, s54, 458752
s_add_u32 s55, s55, 28672
s_cmp_ge_u32 s55, 86016
s_cselect_b32 s10, 86016, 0
s_sub_u32 s55, s55, s10
v_mfma_f32_16x16x32_bf16 v[100:103], a[80:83], a[20:23], v[100:103]
v_mfma_f32_16x16x32_bf16 v[104:107], a[80:83], a[24:27], v[104:107]
v_mfma_f32_16x16x32_bf16 v[108:111], a[80:83], a[28:31], v[108:111]
v_mfma_f32_16x16x32_bf16 v[112:115], a[84:87], a[16:19], v[112:115]
v_mfma_f32_16x16x32_bf16 v[116:119], a[84:87], a[20:23], v[116:119]
v_mfma_f32_16x16x32_bf16 v[120:123], a[84:87], a[24:27], v[120:123]
v_mfma_f32_16x16x32_bf16 v[124:127], a[84:87], a[28:31], v[124:127]
s_waitcnt lgkmcnt(0)
s_waitcnt vmcnt(11)
s_barrier
v_mfma_f32_16x16x32_bf16 v[16:19], a[32:35], a[0:3], v[16:19]
ds_read_b64_tr_b16 a[60:61], v6 offset:0
s_add_u32 m0, s51, 49152
s_add_u32 s11, s50, 896
buffer_load_dwordx4 v132, s[16:19], s11 offen offset:0 lds
v_mfma_f32_16x16x32_bf16 v[20:23], a[32:35], a[4:7], v[20:23]
ds_read_b64_tr_b16 a[62:63], v6 offset:1792
v_mfma_f32_16x16x32_bf16 v[24:27], a[32:35], a[8:11], v[24:27]
ds_read_b128 a[16:19], v3 offset:0
v_mfma_f32_16x16x32_bf16 v[28:31], a[32:35], a[12:15], v[28:31]
ds_read_b128 a[20:23], v3 offset:2048
v_mfma_f32_16x16x32_bf16 v[32:35], a[36:39], a[0:3], v[32:35]
ds_read_b128 a[24:27], v3 offset:4096
v_mfma_f32_16x16x32_bf16 v[36:39], a[36:39], a[4:7], v[36:39]
ds_read_b128 a[28:31], v3 offset:6144
buffer_load_dwordx4 v133, s[16:19], s11 offen offset:1024 lds
v_mfma_f32_16x16x32_bf16 v[40:43], a[36:39], a[8:11], v[40:43]
ds_read_b64_tr_b16 a[64:65], v7 offset:32
v_mfma_f32_16x16x32_bf16 v[44:47], a[36:39], a[12:15], v[44:47]
ds_read_b64_tr_b16 a[66:67], v7 offset:1824
v_mfma_f32_16x16x32_bf16 v[48:51], a[40:43], a[0:3], v[48:51]
ds_read_b64_tr_b16 a[68:69], v6 offset:64
v_mfma_f32_16x16x32_bf16 v[52:55], a[40:43], a[4:7], v[52:55]
ds_read_b64_tr_b16 a[70:71], v6 offset:1856
v_mfma_f32_16x16x32_bf16 v[56:59], a[40:43], a[8:11], v[56:59]
ds_read_b64_tr_b16 a[72:73], v7 offset:96
buffer_load_dwordx4 v134, s[16:19], s11 offen offset:2048 lds
v_mfma_f32_16x16x32_bf16 v[60:63], a[40:43], a[12:15], v[60:63]
ds_read_b64_tr_b16 a[74:75], v7 offset:1888
v_mfma_f32_16x16x32_bf16 v[64:67], a[44:47], a[0:3], v[64:67]
ds_read_b64_tr_b16 a[76:77], v6 offset:128
v_mfma_f32_16x16x32_bf16 v[68:71], a[44:47], a[4:7], v[68:71]
ds_read_b64_tr_b16 a[78:79], v6 offset:1920
v_mfma_f32_16x16x32_bf16 v[72:75], a[44:47], a[8:11], v[72:75]
ds_read_b64_tr_b16 a[80:81], v7 offset:160
v_mfma_f32_16x16x32_bf16 v[76:79], a[44:47], a[12:15], v[76:79]
ds_read_b64_tr_b16 a[82:83], v7 offset:1952
buffer_load_dwordx4 v135, s[16:19], s11 offen offset:3072 lds
v_mfma_f32_16x16x32_bf16 v[80:83], a[48:51], a[0:3], v[80:83]
ds_read_b64_tr_b16 a[84:85], v6 offset:192
v_mfma_f32_16x16x32_bf16 v[84:87], a[48:51], a[4:7], v[84:87]
ds_read_b64_tr_b16 a[86:87], v6 offset:1984
v_mfma_f32_16x16x32_bf16 v[88:91], a[48:51], a[8:11], v[88:91]
v_mfma_f32_16x16x32_bf16 v[92:95], a[48:51], a[12:15], v[92:95]
v_mfma_f32_16x16x32_bf16 v[96:99], a[52:55], a[0:3], v[96:99]
s_mov_b32 m0, s55
s_nop 0
buffer_load_dwordx4 v136, s[20:23], s54 offen offset:0 lds
v_mfma_f32_16x16x32_bf16 v[100:103], a[52:55], a[4:7], v[100:103]
v_mfma_f32_16x16x32_bf16 v[104:107], a[52:55], a[8:11], v[104:107]
v_mfma_f32_16x16x32_bf16 v[108:111], a[52:55], a[12:15], v[108:111]
v_mfma_f32_16x16x32_bf16 v[112:115], a[56:59], a[0:3], v[112:115]
v_mfma_f32_16x16x32_bf16 v[116:119], a[56:59], a[4:7], v[116:119]
buffer_load_dwordx4 v137, s[20:23], s54 offen offset:1024 lds
v_mfma_f32_16x16x32_bf16 v[120:123], a[56:59], a[8:11], v[120:123]
v_mfma_f32_16x16x32_bf16 v[124:127], a[56:59], a[12:15], v[124:127]
s_waitcnt lgkmcnt(0)
v_mfma_f32_16x16x32_bf16 v[16:19], a[60:63], a[16:19], v[16:19]
ds_read_b64_tr_b16 a[32:33], v6 offset:14336
buffer_load_dwordx4 v138, s[20:23], s54 offen offset:2048 lds
v_mfma_f32_16x16x32_bf16 v[20:23], a[60:63], a[20:23], v[20:23]
ds_read_b64_tr_b16 a[34:35], v6 offset:16128
v_mfma_f32_16x16x32_bf16 v[24:27], a[60:63], a[24:27], v[24:27]
ds_read_b128 a[0:3], v2 offset:16384
v_mfma_f32_16x16x32_bf16 v[28:31], a[60:63], a[28:31], v[28:31]
ds_read_b128 a[4:7], v2 offset:18432
v_mfma_f32_16x16x32_bf16 v[32:35], a[64:67], a[16:19], v[32:35]
ds_read_b128 a[8:11], v2 offset:20480
v_mfma_f32_16x16x32_bf16 v[36:39], a[64:67], a[20:23], v[36:39]
ds_read_b128 a[12:15], v2 offset:22528
buffer_load_dwordx4 v139, s[20:23], s54 offen offset:3072 lds
v_mfma_f32_16x16x32_bf16 v[40:43], a[64:67], a[24:27], v[40:43]
ds_read_b64_tr_b16 a[36:37], v7 offset:14368
v_mfma_f32_16x16x32_bf16 v[44:47], a[64:67], a[28:31], v[44:47]
ds_read_b64_tr_b16 a[38:39], v7 offset:16160
v_mfma_f32_16x16x32_bf16 v[48:51], a[68:71], a[16:19], v[48:51]
ds_read_b64_tr_b16 a[40:41], v6 offset:14400
v_mfma_f32_16x16x32_bf16 v[52:55], a[68:71], a[20:23], v[52:55]
ds_read_b64_tr_b16 a[42:43], v6 offset:16192
v_mfma_f32_16x16x32_bf16 v[56:59], a[68:71], a[24:27], v[56:59]
ds_read_b64_tr_b16 a[44:45], v7 offset:14432
s_add_u32 m0, s55, 4096
s_nop 0
buffer_load_dwordx4 v140, s[20:23], s54 offen offset:0 lds
v_mfma_f32_16x16x32_bf16 v[60:63], a[68:71], a[28:31], v[60:63]
ds_read_b64_tr_b16 a[46:47], v7 offset:16224
v_mfma_f32_16x16x32_bf16 v[64:67], a[72:75], a[16:19], v[64:67]
ds_read_b64_tr_b16 a[48:49], v6 offset:14464
v_mfma_f32_16x16x32_bf16 v[68:71], a[72:75], a[20:23], v[68:71]
ds_read_b64_tr_b16 a[50:51], v6 offset:16256
v_mfma_f32_16x16x32_bf16 v[72:75], a[72:75], a[24:27], v[72:75]
ds_read_b64_tr_b16 a[52:53], v7 offset:14496
v_mfma_f32_16x16x32_bf16 v[76:79], a[72:75], a[28:31], v[76:79]
ds_read_b64_tr_b16 a[54:55], v7 offset:16288
buffer_load_dwordx4 v141, s[20:23], s54 offen offset:1024 lds
v_mfma_f32_16x16x32_bf16 v[80:83], a[76:79], a[16:19], v[80:83]
ds_read_b64_tr_b16 a[56:57], v6 offset:14528
v_mfma_f32_16x16x32_bf16 v[84:87], a[76:79], a[20:23], v[84:87]
ds_read_b64_tr_b16 a[58:59], v6 offset:16320
v_mfma_f32_16x16x32_bf16 v[88:91], a[76:79], a[24:27], v[88:91]
v_mfma_f32_16x16x32_bf16 v[92:95], a[76:79], a[28:31], v[92:95]
v_mfma_f32_16x16x32_bf16 v[96:99], a[80:83], a[16:19], v[96:99]
buffer_load_dwordx4 v142, s[20:23], s54 offen offset:2048 lds
s_add_u32 s54, s54, 458752
s_add_u32 s55, s55, 28672
s_cmp_ge_u32 s55, 86016
s_cselect_b32 s10, 86016, 0
s_sub_u32 s55, s55, s10
v_mfma_f32_16x16x32_bf16 v[100:103], a[80:83], a[20:23], v[100:103]
v_mfma_f32_16x16x32_bf16 v[104:107], a[80:83], a[24:27], v[104:107]
v_mfma_f32_16x16x32_bf16 v[108:111], a[80:83], a[28:31], v[108:111]
v_mfma_f32_16x16x32_bf16 v[112:115], a[84:87], a[16:19], v[112:115]
v_mfma_f32_16x16x32_bf16 v[116:119], a[84:87], a[20:23], v[116:119]
v_mfma_f32_16x16x32_bf16 v[120:123], a[84:87], a[24:27], v[120:123]
v_mfma_f32_16x16x32_bf16 v[124:127], a[84:87], a[28:31], v[124:127]
s_waitcnt lgkmcnt(0)
s_waitcnt vmcnt(11)
s_barrier
v_mfma_f32_16x16x32_bf16 v[16:19], a[32:35], a[0:3], v[16:19]
ds_read_b64_tr_b16 a[60:61], v6 offset:28672
s_add_u32 m0, s51, 0
s_add_u32 s11, s50, 1024
buffer_load_dwordx4 v132, s[16:19], s11 offen offset:0 lds
v_mfma_f32_16x16x32_bf16 v[20:23], a[32:35], a[4:7], v[20:23]
ds_read_b64_tr_b16 a[62:63], v6 offset:30464
v_mfma_f32_16x16x32_bf16 v[24:27], a[32:35], a[8:11], v[24:27]
ds_read_b128 a[16:19], v3 offset:16384
v_mfma_f32_16x16x32_bf16 v[28:31], a[32:35], a[12:15], v[28:31]
ds_read_b128 a[20:23], v3 offset:18432
v_mfma_f32_16x16x32_bf16 v[32:35], a[36:39], a[0:3], v[32:35]
ds_read_b128 a[24:27], v3 offset:20480
v_mfma_f32_16x16x32_bf16 v[36:39], a[36:39], a[4:7], v[36:39]
ds_read_b128 a[28:31], v3 offset:22528
buffer_load_dwordx4 v133, s[16:19], s11 offen offset:1024 lds
v_mfma_f32_16x16x32_bf16 v[40:43], a[36:39], a[8:11], v[40:43]
ds_read_b64_tr_b16 a[64:65], v7 offset:28704
v_mfma_f32_16x16x32_bf16 v[44:47], a[36:39], a[12:15], v[44:47]
ds_read_b64_tr_b16 a[66:67], v7 offset:30496
v_mfma_f32_16x16x32_bf16 v[48:51], a[40:43], a[0:3], v[48:51]
ds_read_b64_tr_b16 a[68:69], v6 offset:28736
v_mfma_f32_16x16x32_bf16 v[52:55], a[40:43], a[4:7], v[52:55]
ds_read_b64_tr_b16 a[70:71], v6 offset:30528
v_mfma_f32_16x16x32_bf16 v[56:59], a[40:43], a[8:11], v[56:59]
ds_read_b64_tr_b16 a[72:73], v7 offset:28768
buffer_load_dwordx4 v134, s[16:19], s11 offen offset:2048 lds
v_mfma_f32_16x16x32_bf16 v[60:63], a[40:43], a[12:15], v[60:63]
ds_read_b64_tr_b16 a[74:75], v7 offset:30560
v_mfma_f32_16x16x32_bf16 v[64:67], a[44:47], a[0:3], v[64:67]
ds_read_b64_tr_b16 a[76:77], v6 offset:28800
v_mfma_f32_16x16x32_bf16 v[68:71], a[44:47], a[4:7], v[68:71]
ds_read_b64_tr_b16 a[78:79], v6 offset:30592
v_mfma_f32_16x16x32_bf16 v[72:75], a[44:47], a[8:11], v[72:75]
ds_read_b64_tr_b16 a[80:81], v7 offset:28832
v_mfma_f32_16x16x32_bf16 v[76:79], a[44:47], a[12:15], v[76:79]
ds_read_b64_tr_b16 a[82:83], v7 offset:30624
buffer_load_dwordx4 v135, s[16:19], s11 offen offset:3072 lds
v_mfma_f32_16x16x32_bf16 v[80:83], a[48:51], a[0:3], v[80:83]
ds_read_b64_tr_b16 a[84:85], v6 offset:28864
v_mfma_f32_16x16x32_bf16 v[84:87], a[48:51], a[4:7], v[84:87]
ds_read_b64_tr_b16 a[86:87], v6 offset:30656
v_mfma_f32_16x16x32_bf16 v[88:91], a[48:51], a[8:11], v[88:91]
v_mfma_f32_16x16x32_bf16 v[92:95], a[48:51], a[12:15], v[92:95]
v_mfma_f32_16x16x32_bf16 v[96:99], a[52:55], a[0:3], v[96:99]
s_mov_b32 m0, s55
s_nop 0
buffer_load_dwordx4 v136, s[20:23], s54 offen offset:0 lds
v_mfma_f32_16x16x32_bf16 v[100:103], a[52:55], a[4:7], v[100:103]
v_mfma_f32_16x16x32_bf16 v[104:107], a[52:55], a[8:11], v[104:107]
v_mfma_f32_16x16x32_bf16 v[108:111], a[52:55], a[12:15], v[108:111]
v_mfma_f32_16x16x32_bf16 v[112:115], a[56:59], a[0:3], v[112:115]
v_mfma_f32_16x16x32_bf16 v[116:119], a[56:59], a[4:7], v[116:119]
buffer_load_dwordx4 v137, s[20:23], s54 offen offset:1024 lds
v_mfma_f32_16x16x32_bf16 v[120:123], a[56:59], a[8:11], v[120:123]
v_mfma_f32_16x16x32_bf16 v[124:127], a[56:59], a[12:15], v[124:127]
s_waitcnt lgkmcnt(0)
v_mfma_f32_16x16x32_bf16 v[16:19], a[60:63], a[16:19], v[16:19]
ds_read_b64_tr_b16 a[32:33], v4 offset:0
buffer_load_dwordx4 v138, s[20:23], s54 offen offset:2048 lds
v_mfma_f32_16x16x32_bf16 v[20:23], a[60:63], a[20:23], v[20:23]
ds_read_b64_tr_b16 a[34:35], v4 offset:1792
v_mfma_f32_16x16x32_bf16 v[24:27], a[60:63], a[24:27], v[24:27]
ds_read_b128 a[0:3], v2 offset:32768
v_mfma_f32_16x16x32_bf16 v[28:31], a[60:63], a[28:31], v[28:31]
ds_read_b128 a[4:7], v2 offset:34816
v_mfma_f32_16x16x32_bf16 v[32:35], a[64:67], a[16:19], v[32:35]
ds_read_b128 a[8:11], v2 offset:36864
v_mfma_f32_16x16x32_bf16 v[36:39], a[64:67], a[20:23], v[36:39]
ds_read_b128 a[12:15], v2 offset:38912
buffer_load_dwordx4 v139, s[20:23], s54 offen offset:3072 lds
v_mfma_f32_16x16x32_bf16 v[40:43], a[64:67], a[24:27], v[40:43]
ds_read_b64_tr_b16 a[36:37], v5 offset:32
v_mfma_f32_16x16x32_bf16 v[44:47], a[64:67], a[28:31], v[44:47]
ds_read_b64_tr_b16 a[38:39], v5 offset:1824
v_mfma_f32_16x16x32_bf16 v[48:51], a[68:71], a[16:19], v[48:51]
ds_read_b64_tr_b16 a[40:41], v4 offset:64
v_mfma_f32_16x16x32_bf16 v[52:55], a[68:71], a[20:23], v[52:55]
ds_read_b64_tr_b16 a[42:43], v4 offset:1856
v_mfma_f32_16x16x32_bf16 v[56:59], a[68:71], a[24:27], v[56:59]
ds_read_b64_tr_b16 a[44:45], v5 offset:96
s_add_u32 m0, s55, 4096
s_nop 0
buffer_load_dwordx4 v140, s[20:23], s54 offen offset:0 lds
v_mfma_f32_16x16x32_bf16 v[60:63], a[68:71], a[28:31], v[60:63]
ds_read_b64_tr_b16 a[46:47], v5 offset:1888
v_mfma_f32_16x16x32_bf16 v[64:67], a[72:75], a[16:19], v[64:67]
ds_read_b64_tr_b16 a[48:49], v4 offset:128
v_mfma_f32_16x16x32_bf16 v[68:71], a[72:75], a[20:23], v[68:71]
ds_read_b64_tr_b16 a[50:51], v4 offset:1920
v_mfma_f32_16x16x32_bf16 v[72:75], a[72:75], a[24:27], v[72:75]
ds_read_b64_tr_b16 a[52:53], v5 offset:160
v_mfma_f32_16x16x32_bf16 v[76:79], a[72:75], a[28:31], v[76:79]
ds_read_b64_tr_b16 a[54:55], v5 offset:1952
buffer_load_dwordx4 v141, s[20:23], s54 offen offset:1024 lds
v_mfma_f32_16x16x32_bf16 v[80:83], a[76:79], a[16:19], v[80:83]
ds_read_b64_tr_b16 a[56:57], v4 offset:192
v_mfma_f32_16x16x32_bf16 v[84:87], a[76:79], a[20:23], v[84:87]
ds_read_b64_tr_b16 a[58:59], v4 offset:1984
v_mfma_f32_16x16x32_bf16 v[88:91], a[76:79], a[24:27], v[88:91]
v_mfma_f32_16x16x32_bf16 v[92:95], a[76:79], a[28:31], v[92:95]
v_mfma_f32_16x16x32_bf16 v[96:99], a[80:83], a[16:19], v[96:99]
buffer_load_dwordx4 v142, s[20:23], s54 offen offset:2048 lds
s_add_u32 s54, s54, 458752
s_add_u32 s55, s55, 28672
s_cmp_ge_u32 s55, 86016
s_cselect_b32 s10, 86016, 0
s_sub_u32 s55, s55, s10
v_mfma_f32_16x16x32_bf16 v[100:103], a[80:83], a[20:23], v[100:103]
v_mfma_f32_16x16x32_bf16 v[104:107], a[80:83], a[24:27], v[104:107]
v_mfma_f32_16x16x32_bf16 v[108:111], a[80:83], a[28:31], v[108:111]
v_mfma_f32_16x16x32_bf16 v[112:115], a[84:87], a[16:19], v[112:115]
v_mfma_f32_16x16x32_bf16 v[116:119], a[84:87], a[20:23], v[116:119]
v_mfma_f32_16x16x32_bf16 v[120:123], a[84:87], a[24:27], v[120:123]
v_mfma_f32_16x16x32_bf16 v[124:127], a[84:87], a[28:31], v[124:127]
s_waitcnt lgkmcnt(0)
s_waitcnt vmcnt(11)
s_barrier
v_mfma_f32_16x16x32_bf16 v[16:19], a[32:35], a[0:3], v[16:19]
ds_read_b64_tr_b16 a[60:61], v4 offset:14336
s_add_u32 m0, s51, 16384
s_add_u32 s11, s50, 1152
buffer_load_dwordx4 v132, s[16:19], s11 offen offset:0 lds
v_mfma_f32_16x16x32_bf16 v[20:23], a[32:35], a[4:7], v[20:23]
ds_read_b64_tr_b16 a[62:63], v4 offset:16128
v_mfma_f32_16x16x32_bf16 v[24:27], a[32:35], a[8:11], v[24:27]
ds_read_b128 a[16:19], v3 offset:32768
v_mfma_f32_16x16x32_bf16 v[28:31], a[32:35], a[12:15], v[28:31]
ds_read_b128 a[20:23], v3 offset:34816
v_mfma_f32_16x16x32_bf16 v[32:35], a[36:39], a[0:3], v[32:35]
ds_read_b128 a[24:27], v3 offset:36864
v_mfma_f32_16x16x32_bf16 v[36:39], a[36:39], a[4:7], v[36:39]
ds_read_b128 a[28:31], v3 offset:38912
buffer_load_dwordx4 v133, s[16:19], s11 offen offset:1024 lds
v_mfma_f32_16x16x32_bf16 v[40:43], a[36:39], a[8:11], v[40:43]
ds_read_b64_tr_b16 a[64:65], v5 offset:14368
v_mfma_f32_16x16x32_bf16 v[44:47], a[36:39], a[12:15], v[44:47]
ds_read_b64_tr_b16 a[66:67], v5 offset:16160
v_mfma_f32_16x16x32_bf16 v[48:51], a[40:43], a[0:3], v[48:51]
ds_read_b64_tr_b16 a[68:69], v4 offset:14400
v_mfma_f32_16x16x32_bf16 v[52:55], a[40:43], a[4:7], v[52:55]
ds_read_b64_tr_b16 a[70:71], v4 offset:16192
v_mfma_f32_16x16x32_bf16 v[56:59], a[40:43], a[8:11], v[56:59]
ds_read_b64_tr_b16 a[72:73], v5 offset:14432
buffer_load_dwordx4 v134, s[16:19], s11 offen offset:2048 lds
v_mfma_f32_16x16x32_bf16 v[60:63], a[40:43], a[12:15], v[60:63]
ds_read_b64_tr_b16 a[74:75], v5 offset:16224
v_mfma_f32_16x16x32_bf16 v[64:67], a[44:47], a[0:3], v[64:67]
ds_read_b64_tr_b16 a[76:77], v4 offset:14464
v_mfma_f32_16x16x32_bf16 v[68:71], a[44:47], a[4:7], v[68:71]
ds_read_b64_tr_b16 a[78:79], v4 offset:16256
v_mfma_f32_16x16x32_bf16 v[72:75], a[44:47], a[8:11], v[72:75]
ds_read_b64_tr_b16 a[80:81], v5 offset:14496
v_mfma_f32_16x16x32_bf16 v[76:79], a[44:47], a[12:15], v[76:79]
ds_read_b64_tr_b16 a[82:83], v5 offset:16288
buffer_load_dwordx4 v135, s[16:19], s11 offen offset:3072 lds
v_mfma_f32_16x16x32_bf16 v[80:83], a[48:51], a[0:3], v[80:83]
ds_read_b64_tr_b16 a[84:85], v4 offset:14528
v_mfma_f32_16x16x32_bf16 v[84:87], a[48:51], a[4:7], v[84:87]
ds_read_b64_tr_b16 a[86:87], v4 offset:16320
v_mfma_f32_16x16x32_bf16 v[88:91], a[48:51], a[8:11], v[88:91]
v_mfma_f32_16x16x32_bf16 v[92:95], a[48:51], a[12:15], v[92:95]
v_mfma_f32_16x16x32_bf16 v[96:99], a[52:55], a[0:3], v[96:99]
s_mov_b32 m0, s55
s_nop 0
buffer_load_dwordx4 v136, s[20:23], s54 offen offset:0 lds
v_mfma_f32_16x16x32_bf16 v[100:103], a[52:55], a[4:7], v[100:103]
v_mfma_f32_16x16x32_bf16 v[104:107], a[52:55], a[8:11], v[104:107]
v_mfma_f32_16x16x32_bf16 v[108:111], a[52:55], a[12:15], v[108:111]
v_mfma_f32_16x16x32_bf16 v[112:115], a[56:59], a[0:3], v[112:115]
v_mfma_f32_16x16x32_bf16 v[116:119], a[56:59], a[4:7], v[116:119]
buffer_load_dwordx4 v137, s[20:23], s54 offen offset:1024 lds
v_mfma_f32_16x16x32_bf16 v[120:123], a[56:59], a[8:11], v[120:123]
v_mfma_f32_16x16x32_bf16 v[124:127], a[56:59], a[12:15], v[124:127]
s_waitcnt lgkmcnt(0)
v_mfma_f32_16x16x32_bf16 v[16:19], a[60:63], a[16:19], v[16:19]
ds_read_b64_tr_b16 a[32:33], v4 offset:28672
buffer_load_dwordx4 v138, s[20:23], s54 offen offset:2048 lds
v_mfma_f32_16x16x32_bf16 v[20:23], a[60:63], a[20:23], v[20:23]
ds_read_b64_tr_b16 a[34:35], v4 offset:30464
v_mfma_f32_16x16x32_bf16 v[24:27], a[60:63], a[24:27], v[24:27]
ds_read_b128 a[0:3], v2 offset:49152
v_mfma_f32_16x16x32_bf16 v[28:31], a[60:63], a[28:31], v[28:31]
ds_read_b128 a[4:7], v2 offset:51200
v_mfma_f32_16x16x32_bf16 v[32:35], a[64:67], a[16:19], v[32:35]
ds_read_b128 a[8:11], v2 offset:53248
v_mfma_f32_16x16x32_bf16 v[36:39], a[64:67], a[20:23], v[36:39]
ds_read_b128 a[12:15], v2 offset:55296
buffer_load_dwordx4 v139, s[20:23], s54 offen offset:3072 lds
v_mfma_f32_16x16x32_bf16 v[40:43], a[64:67], a[24:27], v[40:43]
ds_read_b64_tr_b16 a[36:37], v5 offset:28704
v_mfma_f32_16x16x32_bf16 v[44:47], a[64:67], a[28:31], v[44:47]
ds_read_b64_tr_b16 a[38:39], v5 offset:30496
v_mfma_f32_16x16x32_bf16 v[48:51], a[68:71], a[16:19], v[48:51]
ds_read_b64_tr_b16 a[40:41], v4 offset:28736
v_mfma_f32_16x16x32_bf16 v[52:55], a[68:71], a[20:23], v[52:55]
ds_read_b64_tr_b16 a[42:43], v4 offset:30528
v_mfma_f32_16x16x32_bf16 v[56:59], a[68:71], a[24:27], v[56:59]
ds_read_b64_tr_b16 a[44:45], v5 offset:28768
s_add_u32 m0, s55, 4096
s_nop 0
buffer_load_dwordx4 v140, s[20:23], s54 offen offset:0 lds
v_mfma_f32_16x16x32_bf16 v[60:63], a[68:71], a[28:31], v[60:63]
ds_read_b64_tr_b16 a[46:47], v5 offset:30560
v_mfma_f32_16x16x32_bf16 v[64:67], a[72:75], a[16:19], v[64:67]
ds_read_b64_tr_b16 a[48:49], v4 offset:28800
v_mfma_f32_16x16x32_bf16 v[68:71], a[72:75], a[20:23], v[68:71]
ds_read_b64_tr_b16 a[50:51], v4 offset:30592
v_mfma_f32_16x16x32_bf16 v[72:75], a[72:75], a[24:27], v[72:75]
ds_read_b64_tr_b16 a[52:53], v5 offset:28832
v_mfma_f32_16x16x32_bf16 v[76:79], a[72:75], a[28:31], v[76:79]
ds_read_b64_tr_b16 a[54:55], v5 offset:30624
buffer_load_dwordx4 v141, s[20:23], s54 offen offset:1024 lds
v_mfma_f32_16x16x32_bf16 v[80:83], a[76:79], a[16:19], v[80:83]
ds_read_b64_tr_b16 a[56:57], v4 offset:28864
v_mfma_f32_16x16x32_bf16 v[84:87], a[76:79], a[20:23], v[84:87]
ds_read_b64_tr_b16 a[58:59], v4 offset:30656
v_mfma_f32_16x16x32_bf16 v[88:91], a[76:79], a[24:27], v[88:91]
v_mfma_f32_16x16x32_bf16 v[92:95], a[76:79], a[28:31], v[92:95]
v_mfma_f32_16x16x32_bf16 v[96:99], a[80:83], a[16:19], v[96:99]
buffer_load_dwordx4 v142, s[20:23], s54 offen offset:2048 lds
s_add_u32 s54, s54, 458752
s_add_u32 s55, s55, 28672
s_cmp_ge_u32 s55, 86016
s_cselect_b32 s10, 86016, 0
s_sub_u32 s55, s55, s10
v_mfma_f32_16x16x32_bf16 v[100:103], a[80:83], a[20:23], v[100:103]
v_mfma_f32_16x16x32_bf16 v[104:107], a[80:83], a[24:27], v[104:107]
v_mfma_f32_16x16x32_bf16 v[108:111], a[80:83], a[28:31], v[108:111]
v_mfma_f32_16x16x32_bf16 v[112:115], a[84:87], a[16:19], v[112:115]
v_mfma_f32_16x16x32_bf16 v[116:119], a[84:87], a[20:23], v[116:119]
v_mfma_f32_16x16x32_bf16 v[120:123], a[84:87], a[24:27], v[120:123]
v_mfma_f32_16x16x32_bf16 v[124:127], a[84:87], a[28:31], v[124:127]
s_waitcnt lgkmcnt(0)
s_waitcnt vmcnt(11)
s_barrier
v_mfma_f32_16x16x32_bf16 v[16:19], a[32:35], a[0:3], v[16:19]
ds_read_b64_tr_b16 a[60:61], v6 offset:0
s_add_u32 m0, s51, 32768
s_add_u32 s11, s50, 1280
buffer_load_dwordx4 v132, s[16:19], s11 offen offset:0 lds
v_mfma_f32_16x16x32_bf16 v[20:23], a[32:35], a[4:7], v[20:23]
ds_read_b64_tr_b16 a[62:63], v6 offset:1792
v_mfma_f32_16x16x32_bf16 v[24:27], a[32:35], a[8:11], v[24:27]
ds_read_b128 a[16:19], v3 offset:49152
v_mfma_f32_16x16x32_bf16 v[28:31], a[32:35], a[12:15], v[28:31]
ds_read_b128 a[20:23], v3 offset:51200
v_mfma_f32_16x16x32_bf16 v[32:35], a[36:39], a[0:3], v[32:35]
ds_read_b128 a[24:27], v3 offset:53248
v_mfma_f32_16x16x32_bf16 v[36:39], a[36:39], a[4:7], v[36:39]
ds_read_b128 a[28:31], v3 offset:55296
buffer_load_dwordx4 v133, s[16:19], s11 offen offset:1024 lds
v_mfma_f32_16x16x32_bf16 v[40:43], a[36:39], a[8:11], v[40:43]
ds_read_b64_tr_b16 a[64:65], v7 offset:32
v_mfma_f32_16x16x32_bf16 v[44:47], a[36:39], a[12:15], v[44:47]
ds_read_b64_tr_b16 a[66:67], v7 offset:1824
v_mfma_f32_16x16x32_bf16 v[48:51], a[40:43], a[0:3], v[48:51]
ds_read_b64_tr_b16 a[68:69], v6 offset:64
v_mfma_f32_16x16x32_bf16 v[52:55], a[40:43], a[4:7], v[52:55]
ds_read_b64_tr_b16 a[70:71], v6 offset:1856
v_mfma_f32_16x16x32_bf16 v[56:59], a[40:43], a[8:11], v[56:59]
ds_read_b64_tr_b16 a[72:73], v7 offset:96
buffer_load_dwordx4 v134, s[16:19], s11 offen offset:2048 lds
v_mfma_f32_16x16x32_bf16 v[60:63], a[40:43], a[12:15], v[60:63]
ds_read_b64_tr_b16 a[74:75], v7 offset:1888
v_mfma_f32_16x16x32_bf16 v[64:67], a[44:47], a[0:3], v[64:67]
ds_read_b64_tr_b16 a[76:77], v6 offset:128
v_mfma_f32_16x16x32_bf16 v[68:71], a[44:47], a[4:7], v[68:71]
ds_read_b64_tr_b16 a[78:79], v6 offset:1920
v_mfma_f32_16x16x32_bf16 v[72:75], a[44:47], a[8:11], v[72:75]
ds_read_b64_tr_b16 a[80:81], v7 offset:160
v_mfma_f32_16x16x32_bf16 v[76:79], a[44:47], a[12:15], v[76:79]
ds_read_b64_tr_b16 a[82:83], v7 offset:1952
buffer_load_dwordx4 v135, s[16:19], s11 offen offset:3072 lds
v_mfma_f32_16x16x32_bf16 v[80:83], a[48:51], a[0:3], v[80:83]
ds_read_b64_tr_b16 a[84:85], v6 offset:192
v_mfma_f32_16x16x32_bf16 v[84:87], a[48:51], a[4:7], v[84:87]
ds_read_b64_tr_b16 a[86:87], v6 offset:1984
v_mfma_f32_16x16x32_bf16 v[88:91], a[48:51], a[8:11], v[88:91]
v_mfma_f32_16x16x32_bf16 v[92:95], a[48:51], a[12:15], v[92:95]
v_mfma_f32_16x16x32_bf16 v[96:99], a[52:55], a[0:3], v[96:99]
s_mov_b32 m0, s55
s_nop 0
buffer_load_dwordx4 v136, s[20:23], s54 offen offset:0 lds
v_mfma_f32_16x16x32_bf16 v[100:103], a[52:55], a[4:7], v[100:103]
v_mfma_f32_16x16x32_bf16 v[104:107], a[52:55], a[8:11], v[104:107]
v_mfma_f32_16x16x32_bf16 v[108:111], a[52:55], a[12:15], v[108:111]
v_mfma_f32_16x16x32_bf16 v[112:115], a[56:59], a[0:3], v[112:115]
v_mfma_f32_16x16x32_bf16 v[116:119], a[56:59], a[4:7], v[116:119]
buffer_load_dwordx4 v137, s[20:23], s54 offen offset:1024 lds
v_mfma_f32_16x16x32_bf16 v[120:123], a[56:59], a[8:11], v[120:123]
v_mfma_f32_16x16x32_bf16 v[124:127], a[56:59], a[12:15], v[124:127]
s_waitcnt lgkmcnt(0)
v_mfma_f32_16x16x32_bf16 v[16:19], a[60:63], a[16:19], v[16:19]
ds_read_b64_tr_b16 a[32:33], v6 offset:14336
buffer_load_dwordx4 v138, s[20:23], s54 offen offset:2048 lds
v_mfma_f32_16x16x32_bf16 v[20:23], a[60:63], a[20:23], v[20:23]
ds_read_b64_tr_b16 a[34:35], v6 offset:16128
v_mfma_f32_16x16x32_bf16 v[24:27], a[60:63], a[24:27], v[24:27]
ds_read_b128 a[0:3], v2 offset:0
v_mfma_f32_16x16x32_bf16 v[28:31], a[60:63], a[28:31], v[28:31]
ds_read_b128 a[4:7], v2 offset:2048
v_mfma_f32_16x16x32_bf16 v[32:35], a[64:67], a[16:19], v[32:35]
ds_read_b128 a[8:11], v2 offset:4096
v_mfma_f32_16x16x32_bf16 v[36:39], a[64:67], a[20:23], v[36:39]
ds_read_b128 a[12:15], v2 offset:6144
buffer_load_dwordx4 v139, s[20:23], s54 offen offset:3072 lds
v_mfma_f32_16x16x32_bf16 v[40:43], a[64:67], a[24:27], v[40:43]
ds_read_b64_tr_b16 a[36:37], v7 offset:14368
v_mfma_f32_16x16x32_bf16 v[44:47], a[64:67], a[28:31], v[44:47]
ds_read_b64_tr_b16 a[38:39], v7 offset:16160
v_mfma_f32_16x16x32_bf16 v[48:51], a[68:71], a[16:19], v[48:51]
ds_read_b64_tr_b16 a[40:41], v6 offset:14400
v_mfma_f32_16x16x32_bf16 v[52:55], a[68:71], a[20:23], v[52:55]
ds_read_b64_tr_b16 a[42:43], v6 offset:16192
v_mfma_f32_16x16x32_bf16 v[56:59], a[68:71], a[24:27], v[56:59]
ds_read_b64_tr_b16 a[44:45], v7 offset:14432
s_add_u32 m0, s55, 4096
s_nop 0
buffer_load_dwordx4 v140, s[20:23], s54 offen offset:0 lds
v_mfma_f32_16x16x32_bf16 v[60:63], a[68:71], a[28:31], v[60:63]
ds_read_b64_tr_b16 a[46:47], v7 offset:16224
v_mfma_f32_16x16x32_bf16 v[64:67], a[72:75], a[16:19], v[64:67]
ds_read_b64_tr_b16 a[48:49], v6 offset:14464
v_mfma_f32_16x16x32_bf16 v[68:71], a[72:75], a[20:23], v[68:71]
ds_read_b64_tr_b16 a[50:51], v6 offset:16256
v_mfma_f32_16x16x32_bf16 v[72:75], a[72:75], a[24:27], v[72:75]
ds_read_b64_tr_b16 a[52:53], v7 offset:14496
v_mfma_f32_16x16x32_bf16 v[76:79], a[72:75], a[28:31], v[76:79]
ds_read_b64_tr_b16 a[54:55], v7 offset:16288
buffer_load_dwordx4 v141, s[20:23], s54 offen offset:1024 lds
v_mfma_f32_16x16x32_bf16 v[80:83], a[76:79], a[16:19], v[80:83]
ds_read_b64_tr_b16 a[56:57], v6 offset:14528
v_mfma_f32_16x16x32_bf16 v[84:87], a[76:79], a[20:23], v[84:87]
ds_read_b64_tr_b16 a[58:59], v6 offset:16320
v_mfma_f32_16x16x32_bf16 v[88:91], a[76:79], a[24:27], v[88:91]
v_mfma_f32_16x16x32_bf16 v[92:95], a[76:79], a[28:31], v[92:95]
v_mfma_f32_16x16x32_bf16 v[96:99], a[80:83], a[16:19], v[96:99]
buffer_load_dwordx4 v142, s[20:23], s54 offen offset:2048 lds
s_add_u32 s54, s54, 458752
s_add_u32 s55, s55, 28672
s_cmp_ge_u32 s55, 86016
s_cselect_b32 s10, 86016, 0
s_sub_u32 s55, s55, s10
v_mfma_f32_16x16x32_bf16 v[100:103], a[80:83], a[20:23], v[100:103]
v_mfma_f32_16x16x32_bf16 v[104:107], a[80:83], a[24:27], v[104:107]
v_mfma_f32_16x16x32_bf16 v[108:111], a[80:83], a[28:31], v[108:111]
v_mfma_f32_16x16x32_bf16 v[112:115], a[84:87], a[16:19], v[112:115]
v_mfma_f32_16x16x32_bf16 v[116:119], a[84:87], a[20:23], v[116:119]
v_mfma_f32_16x16x32_bf16 v[120:123], a[84:87], a[24:27], v[120:123]
v_mfma_f32_16x16x32_bf16 v[124:127], a[84:87], a[28:31], v[124:127]
s_waitcnt lgkmcnt(0)
s_waitcnt vmcnt(11)
s_barrier
v_mfma_f32_16x16x32_bf16 v[16:19], a[32:35], a[0:3], v[16:19]
ds_read_b64_tr_b16 a[60:61], v6 offset:28672
s_add_u32 m0, s51, 49152
s_add_u32 s11, s50, 1408
buffer_load_dwordx4 v132, s[16:19], s11 offen offset:0 lds
v_mfma_f32_16x16x32_bf16 v[20:23], a[32:35], a[4:7], v[20:23]
ds_read_b64_tr_b16 a[62:63], v6 offset:30464
v_mfma_f32_16x16x32_bf16 v[24:27], a[32:35], a[8:11], v[24:27]
ds_read_b128 a[16:19], v3 offset:0
v_mfma_f32_16x16x32_bf16 v[28:31], a[32:35], a[12:15], v[28:31]
ds_read_b128 a[20:23], v3 offset:2048
v_mfma_f32_16x16x32_bf16 v[32:35], a[36:39], a[0:3], v[32:35]
ds_read_b128 a[24:27], v3 offset:4096
v_mfma_f32_16x16x32_bf16 v[36:39], a[36:39], a[4:7], v[36:39]
ds_read_b128 a[28:31], v3 offset:6144
buffer_load_dwordx4 v133, s[16:19], s11 offen offset:1024 lds
v_mfma_f32_16x16x32_bf16 v[40:43], a[36:39], a[8:11], v[40:43]
ds_read_b64_tr_b16 a[64:65], v7 offset:28704
v_mfma_f32_16x16x32_bf16 v[44:47], a[36:39], a[12:15], v[44:47]
ds_read_b64_tr_b16 a[66:67], v7 offset:30496
v_mfma_f32_16x16x32_bf16 v[48:51], a[40:43], a[0:3], v[48:51]
ds_read_b64_tr_b16 a[68:69], v6 offset:28736
v_mfma_f32_16x16x32_bf16 v[52:55], a[40:43], a[4:7], v[52:55]
ds_read_b64_tr_b16 a[70:71], v6 offset:30528
v_mfma_f32_16x16x32_bf16 v[56:59], a[40:43], a[8:11], v[56:59]
ds_read_b64_tr_b16 a[72:73], v7 offset:28768
buffer_load_dwordx4 v134, s[16:19], s11 offen offset:2048 lds
v_mfma_f32_16x16x32_bf16 v[60:63], a[40:43], a[12:15], v[60:63]
ds_read_b64_tr_b16 a[74:75], v7 offset:30560
v_mfma_f32_16x16x32_bf16 v[64:67], a[44:47], a[0:3], v[64:67]
ds_read_b64_tr_b16 a[76:77], v6 offset:28800
v_mfma_f32_16x16x32_bf16 v[68:71], a[44:47], a[4:7], v[68:71]
ds_read_b64_tr_b16 a[78:79], v6 offset:30592
v_mfma_f32_16x16x32_bf16 v[72:75], a[44:47], a[8:11], v[72:75]
ds_read_b64_tr_b16 a[80:81], v7 offset:28832
v_mfma_f32_16x16x32_bf16 v[76:79], a[44:47], a[12:15], v[76:79]
ds_read_b64_tr_b16 a[82:83], v7 offset:30624
buffer_load_dwordx4 v135, s[16:19], s11 offen offset:3072 lds
v_mfma_f32_16x16x32_bf16 v[80:83], a[48:51], a[0:3], v[80:83]
ds_read_b64_tr_b16 a[84:85], v6 offset:28864
v_mfma_f32_16x16x32_bf16 v[84:87], a[48:51], a[4:7], v[84:87]
ds_read_b64_tr_b16 a[86:87], v6 offset:30656
v_mfma_f32_16x16x32_bf16 v[88:91], a[48:51], a[8:11], v[88:91]
v_mfma_f32_16x16x32_bf16 v[92:95], a[48:51], a[12:15], v[92:95]
v_mfma_f32_16x16x32_bf16 v[96:99], a[52:55], a[0:3], v[96:99]
s_mov_b32 m0, s55
s_nop 0
buffer_load_dwordx4 v136, s[20:23], s54 offen offset:0 lds
v_mfma_f32_16x16x32_bf16 v[100:103], a[52:55], a[4:7], v[100:103]
v_mfma_f32_16x16x32_bf16 v[104:107], a[52:55], a[8:11], v[104:107]
v_mfma_f32_16x16x32_bf16 v[108:111], a[52:55], a[12:15], v[108:111]
v_mfma_f32_16x16x32_bf16 v[112:115], a[56:59], a[0:3], v[112:115]
v_mfma_f32_16x16x32_bf16 v[116:119], a[56:59], a[4:7], v[116:119]
buffer_load_dwordx4 v137, s[20:23], s54 offen offset:1024 lds
v_mfma_f32_16x16x32_bf16 v[120:123], a[56:59], a[8:11], v[120:123]
v_mfma_f32_16x16x32_bf16 v[124:127], a[56:59], a[12:15], v[124:127]
s_waitcnt lgkmcnt(0)
v_mfma_f32_16x16x32_bf16 v[16:19], a[60:63], a[16:19], v[16:19]
ds_read_b64_tr_b16 a[32:33], v4 offset:0
buffer_load_dwordx4 v138, s[20:23], s54 offen offset:2048 lds
v_mfma_f32_16x16x32_bf16 v[20:23], a[60:63], a[20:23], v[20:23]
ds_read_b64_tr_b16 a[34:35], v4 offset:1792
v_mfma_f32_16x16x32_bf16 v[24:27], a[60:63], a[24:27], v[24:27]
ds_read_b128 a[0:3], v2 offset:16384
v_mfma_f32_16x16x32_bf16 v[28:31], a[60:63], a[28:31], v[28:31]
ds_read_b128 a[4:7], v2 offset:18432
v_mfma_f32_16x16x32_bf16 v[32:35], a[64:67], a[16:19], v[32:35]
ds_read_b128 a[8:11], v2 offset:20480
v_mfma_f32_16x16x32_bf16 v[36:39], a[64:67], a[20:23], v[36:39]
ds_read_b128 a[12:15], v2 offset:22528
buffer_load_dwordx4 v139, s[20:23], s54 offen offset:3072 lds
v_mfma_f32_16x16x32_bf16 v[40:43], a[64:67], a[24:27], v[40:43]
ds_read_b64_tr_b16 a[36:37], v5 offset:32
v_mfma_f32_16x16x32_bf16 v[44:47], a[64:67], a[28:31], v[44:47]
ds_read_b64_tr_b16 a[38:39], v5 offset:1824
v_mfma_f32_16x16x32_bf16 v[48:51], a[68:71], a[16:19], v[48:51]
ds_read_b64_tr_b16 a[40:41], v4 offset:64
v_mfma_f32_16x16x32_bf16 v[52:55], a[68:71], a[20:23], v[52:55]
ds_read_b64_tr_b16 a[42:43], v4 offset:1856
v_mfma_f32_16x16x32_bf16 v[56:59], a[68:71], a[24:27], v[56:59]
ds_read_b64_tr_b16 a[44:45], v5 offset:96
s_add_u32 m0, s55, 4096
s_nop 0
buffer_load_dwordx4 v140, s[20:23], s54 offen offset:0 lds
v_mfma_f32_16x16x32_bf16 v[60:63], a[68:71], a[28:31], v[60:63]
ds_read_b64_tr_b16 a[46:47], v5 offset:1888
v_mfma_f32_16x16x32_bf16 v[64:67], a[72:75], a[16:19], v[64:67]
ds_read_b64_tr_b16 a[48:49], v4 offset:128
v_mfma_f32_16x16x32_bf16 v[68:71], a[72:75], a[20:23], v[68:71]
ds_read_b64_tr_b16 a[50:51], v4 offset:1920
v_mfma_f32_16x16x32_bf16 v[72:75], a[72:75], a[24:27], v[72:75]
ds_read_b64_tr_b16 a[52:53], v5 offset:160
v_mfma_f32_16x16x32_bf16 v[76:79], a[72:75], a[28:31], v[76:79]
ds_read_b64_tr_b16 a[54:55], v5 offset:1952
buffer_load_dwordx4 v141, s[20:23], s54 offen offset:1024 lds
v_mfma_f32_16x16x32_bf16 v[80:83], a[76:79], a[16:19], v[80:83]
ds_read_b64_tr_b16 a[56:57], v4 offset:192
v_mfma_f32_16x16x32_bf16 v[84:87], a[76:79], a[20:23], v[84:87]
ds_read_b64_tr_b16 a[58:59], v4 offset:1984
v_mfma_f32_16x16x32_bf16 v[88:91], a[76:79], a[24:27], v[88:91]
v_mfma_f32_16x16x32_bf16 v[92:95], a[76:79], a[28:31], v[92:95]
v_mfma_f32_16x16x32_bf16 v[96:99], a[80:83], a[16:19], v[96:99]
buffer_load_dwordx4 v142, s[20:23], s54 offen offset:2048 lds
s_add_u32 s54, s54, 458752
s_add_u32 s55, s55, 28672
s_cmp_ge_u32 s55, 86016
s_cselect_b32 s10, 86016, 0
s_sub_u32 s55, s55, s10
v_mfma_f32_16x16x32_bf16 v[100:103], a[80:83], a[20:23], v[100:103]
v_mfma_f32_16x16x32_bf16 v[104:107], a[80:83], a[24:27], v[104:107]
v_mfma_f32_16x16x32_bf16 v[108:111], a[80:83], a[28:31], v[108:111]
v_mfma_f32_16x16x32_bf16 v[112:115], a[84:87], a[16:19], v[112:115]
v_mfma_f32_16x16x32_bf16 v[116:119], a[84:87], a[20:23], v[116:119]
v_mfma_f32_16x16x32_bf16 v[120:123], a[84:87], a[24:27], v[120:123]
v_mfma_f32_16x16x32_bf16 v[124:127], a[84:87], a[28:31], v[124:127]
s_waitcnt lgkmcnt(0)
s_waitcnt vmcnt(11)
s_barrier
v_mfma_f32_16x16x32_bf16 v[16:19], a[32:35], a[0:3], v[16:19]
ds_read_b64_tr_b16 a[60:61], v4 offset:14336
s_add_u32 m0, s51, 0
s_add_u32 s11, s50, 1536
buffer_load_dwordx4 v132, s[16:19], s11 offen offset:0 lds
v_mfma_f32_16x16x32_bf16 v[20:23], a[32:35], a[4:7], v[20:23]
ds_read_b64_tr_b16 a[62:63], v4 offset:16128
v_mfma_f32_16x16x32_bf16 v[24:27], a[32:35], a[8:11], v[24:27]
ds_read_b128 a[16:19], v3 offset:16384
v_mfma_f32_16x16x32_bf16 v[28:31], a[32:35], a[12:15], v[28:31]
ds_read_b128 a[20:23], v3 offset:18432
v_mfma_f32_16x16x32_bf16 v[32:35], a[36:39], a[0:3], v[32:35]
ds_read_b128 a[24:27], v3 offset:20480
v_mfma_f32_16x16x32_bf16 v[36:39], a[36:39], a[4:7], v[36:39]
ds_read_b128 a[28:31], v3 offset:22528
buffer_load_dwordx4 v133, s[16:19], s11 offen offset:1024 lds
v_mfma_f32_16x16x32_bf16 v[40:43], a[36:39], a[8:11], v[40:43]
ds_read_b64_tr_b16 a[64:65], v5 offset:14368
v_mfma_f32_16x16x32_bf16 v[44:47], a[36:39], a[12:15], v[44:47]
ds_read_b64_tr_b16 a[66:67], v5 offset:16160
v_mfma_f32_16x16x32_bf16 v[48:51], a[40:43], a[0:3], v[48:51]
ds_read_b64_tr_b16 a[68:69], v4 offset:14400
v_mfma_f32_16x16x32_bf16 v[52:55], a[40:43], a[4:7], v[52:55]
ds_read_b64_tr_b16 a[70:71], v4 offset:16192
v_mfma_f32_16x16x32_bf16 v[56:59], a[40:43], a[8:11], v[56:59]
ds_read_b64_tr_b16 a[72:73], v5 offset:14432
buffer_load_dwordx4 v134, s[16:19], s11 offen offset:2048 lds
v_mfma_f32_16x16x32_bf16 v[60:63], a[40:43], a[12:15], v[60:63]
ds_read_b64_tr_b16 a[74:75], v5 offset:16224
v_mfma_f32_16x16x32_bf16 v[64:67], a[44:47], a[0:3], v[64:67]
ds_read_b64_tr_b16 a[76:77], v4 offset:14464
v_mfma_f32_16x16x32_bf16 v[68:71], a[44:47], a[4:7], v[68:71]
ds_read_b64_tr_b16 a[78:79], v4 offset:16256
v_mfma_f32_16x16x32_bf16 v[72:75], a[44:47], a[8:11], v[72:75]
ds_read_b64_tr_b16 a[80:81], v5 offset:14496
v_mfma_f32_16x16x32_bf16 v[76:79], a[44:47], a[12:15], v[76:79]
ds_read_b64_tr_b16 a[82:83], v5 offset:16288
buffer_load_dwordx4 v135, s[16:19], s11 offen offset:3072 lds
v_mfma_f32_16x16x32_bf16 v[80:83], a[48:51], a[0:3], v[80:83]
ds_read_b64_tr_b16 a[84:85], v4 offset:14528
v_mfma_f32_16x16x32_bf16 v[84:87], a[48:51], a[4:7], v[84:87]
ds_read_b64_tr_b16 a[86:87], v4 offset:16320
v_mfma_f32_16x16x32_bf16 v[88:91], a[48:51], a[8:11], v[88:91]
v_mfma_f32_16x16x32_bf16 v[92:95], a[48:51], a[12:15], v[92:95]
v_mfma_f32_16x16x32_bf16 v[96:99], a[52:55], a[0:3], v[96:99]
s_mov_b32 m0, s55
s_nop 0
buffer_load_dwordx4 v136, s[20:23], s54 offen offset:0 lds
v_mfma_f32_16x16x32_bf16 v[100:103], a[52:55], a[4:7], v[100:103]
v_mfma_f32_16x16x32_bf16 v[104:107], a[52:55], a[8:11], v[104:107]
v_mfma_f32_16x16x32_bf16 v[108:111], a[52:55], a[12:15], v[108:111]
v_mfma_f32_16x16x32_bf16 v[112:115], a[56:59], a[0:3], v[112:115]
v_mfma_f32_16x16x32_bf16 v[116:119], a[56:59], a[4:7], v[116:119]
buffer_load_dwordx4 v137, s[20:23], s54 offen offset:1024 lds
v_mfma_f32_16x16x32_bf16 v[120:123], a[56:59], a[8:11], v[120:123]
v_mfma_f32_16x16x32_bf16 v[124:127], a[56:59], a[12:15], v[124:127]
s_waitcnt lgkmcnt(0)
v_mfma_f32_16x16x32_bf16 v[16:19], a[60:63], a[16:19], v[16:19]
ds_read_b64_tr_b16 a[32:33], v4 offset:28672
buffer_load_dwordx4 v138, s[20:23], s54 offen offset:2048 lds
v_mfma_f32_16x16x32_bf16 v[20:23], a[60:63], a[20:23], v[20:23]
ds_read_b64_tr_b16 a[34:35], v4 offset:30464
v_mfma_f32_16x16x32_bf16 v[24:27], a[60:63], a[24:27], v[24:27]
ds_read_b128 a[0:3], v2 offset:32768
v_mfma_f32_16x16x32_bf16 v[28:31], a[60:63], a[28:31], v[28:31]
ds_read_b128 a[4:7], v2 offset:34816
v_mfma_f32_16x16x32_bf16 v[32:35], a[64:67], a[16:19], v[32:35]
ds_read_b128 a[8:11], v2 offset:36864
v_mfma_f32_16x16x32_bf16 v[36:39], a[64:67], a[20:23], v[36:39]
ds_read_b128 a[12:15], v2 offset:38912
buffer_load_dwordx4 v139, s[20:23], s54 offen offset:3072 lds
v_mfma_f32_16x16x32_bf16 v[40:43], a[64:67], a[24:27], v[40:43]
ds_read_b64_tr_b16 a[36:37], v5 offset:28704
v_mfma_f32_16x16x32_bf16 v[44:47], a[64:67], a[28:31], v[44:47]
ds_read_b64_tr_b16 a[38:39], v5 offset:30496
v_mfma_f32_16x16x32_bf16 v[48:51], a[68:71], a[16:19], v[48:51]
ds_read_b64_tr_b16 a[40:41], v4 offset:28736
v_mfma_f32_16x16x32_bf16 v[52:55], a[68:71], a[20:23], v[52:55]
ds_read_b64_tr_b16 a[42:43], v4 offset:30528
v_mfma_f32_16x16x32_bf16 v[56:59], a[68:71], a[24:27], v[56:59]
ds_read_b64_tr_b16 a[44:45], v5 offset:28768
s_add_u32 m0, s55, 4096
s_nop 0
buffer_load_dwordx4 v140, s[20:23], s54 offen offset:0 lds
v_mfma_f32_16x16x32_bf16 v[60:63], a[68:71], a[28:31], v[60:63]
ds_read_b64_tr_b16 a[46:47], v5 offset:30560
v_mfma_f32_16x16x32_bf16 v[64:67], a[72:75], a[16:19], v[64:67]
ds_read_b64_tr_b16 a[48:49], v4 offset:28800
v_mfma_f32_16x16x32_bf16 v[68:71], a[72:75], a[20:23], v[68:71]
ds_read_b64_tr_b16 a[50:51], v4 offset:30592
v_mfma_f32_16x16x32_bf16 v[72:75], a[72:75], a[24:27], v[72:75]
ds_read_b64_tr_b16 a[52:53], v5 offset:28832
v_mfma_f32_16x16x32_bf16 v[76:79], a[72:75], a[28:31], v[76:79]
ds_read_b64_tr_b16 a[54:55], v5 offset:30624
buffer_load_dwordx4 v141, s[20:23], s54 offen offset:1024 lds
v_mfma_f32_16x16x32_bf16 v[80:83], a[76:79], a[16:19], v[80:83]
ds_read_b64_tr_b16 a[56:57], v4 offset:28864
v_mfma_f32_16x16x32_bf16 v[84:87], a[76:79], a[20:23], v[84:87]
ds_read_b64_tr_b16 a[58:59], v4 offset:30656
v_mfma_f32_16x16x32_bf16 v[88:91], a[76:79], a[24:27], v[88:91]
v_mfma_f32_16x16x32_bf16 v[92:95], a[76:79], a[28:31], v[92:95]
v_mfma_f32_16x16x32_bf16 v[96:99], a[80:83], a[16:19], v[96:99]
buffer_load_dwordx4 v142, s[20:23], s54 offen offset:2048 lds
s_add_u32 s54, s54, 458752
s_add_u32 s55, s55, 28672
s_cmp_ge_u32 s55, 86016
s_cselect_b32 s10, 86016, 0
s_sub_u32 s55, s55, s10
v_mfma_f32_16x16x32_bf16 v[100:103], a[80:83], a[20:23], v[100:103]
v_mfma_f32_16x16x32_bf16 v[104:107], a[80:83], a[24:27], v[104:107]
v_mfma_f32_16x16x32_bf16 v[108:111], a[80:83], a[28:31], v[108:111]
v_mfma_f32_16x16x32_bf16 v[112:115], a[84:87], a[16:19], v[112:115]
v_mfma_f32_16x16x32_bf16 v[116:119], a[84:87], a[20:23], v[116:119]
v_mfma_f32_16x16x32_bf16 v[120:123], a[84:87], a[24:27], v[120:123]
v_mfma_f32_16x16x32_bf16 v[124:127], a[84:87], a[28:31], v[124:127]
s_waitcnt lgkmcnt(0)
s_waitcnt vmcnt(11)
s_barrier
v_mfma_f32_16x16x32_bf16 v[16:19], a[32:35], a[0:3], v[16:19]
ds_read_b64_tr_b16 a[60:61], v6 offset:0
s_add_u32 m0, s51, 16384
s_add_u32 s11, s50, 1664
buffer_load_dwordx4 v132, s[16:19], s11 offen offset:0 lds
v_mfma_f32_16x16x32_bf16 v[20:23], a[32:35], a[4:7], v[20:23]
ds_read_b64_tr_b16 a[62:63], v6 offset:1792
v_mfma_f32_16x16x32_bf16 v[24:27], a[32:35], a[8:11], v[24:27]
ds_read_b128 a[16:19], v3 offset:32768
v_mfma_f32_16x16x32_bf16 v[28:31], a[32:35], a[12:15], v[28:31]
ds_read_b128 a[20:23], v3 offset:34816
v_mfma_f32_16x16x32_bf16 v[32:35], a[36:39], a[0:3], v[32:35]
ds_read_b128 a[24:27], v3 offset:36864
v_mfma_f32_16x16x32_bf16 v[36:39], a[36:39], a[4:7], v[36:39]
ds_read_b128 a[28:31], v3 offset:38912
buffer_load_dwordx4 v133, s[16:19], s11 offen offset:1024 lds
v_mfma_f32_16x16x32_bf16 v[40:43], a[36:39], a[8:11], v[40:43]
ds_read_b64_tr_b16 a[64:65], v7 offset:32
v_mfma_f32_16x16x32_bf16 v[44:47], a[36:39], a[12:15], v[44:47]
ds_read_b64_tr_b16 a[66:67], v7 offset:1824
v_mfma_f32_16x16x32_bf16 v[48:51], a[40:43], a[0:3], v[48:51]
ds_read_b64_tr_b16 a[68:69], v6 offset:64
v_mfma_f32_16x16x32_bf16 v[52:55], a[40:43], a[4:7], v[52:55]
ds_read_b64_tr_b16 a[70:71], v6 offset:1856
v_mfma_f32_16x16x32_bf16 v[56:59], a[40:43], a[8:11], v[56:59]
ds_read_b64_tr_b16 a[72:73], v7 offset:96
buffer_load_dwordx4 v134, s[16:19], s11 offen offset:2048 lds
v_mfma_f32_16x16x32_bf16 v[60:63], a[40:43], a[12:15], v[60:63]
ds_read_b64_tr_b16 a[74:75], v7 offset:1888
v_mfma_f32_16x16x32_bf16 v[64:67], a[44:47], a[0:3], v[64:67]
ds_read_b64_tr_b16 a[76:77], v6 offset:128
v_mfma_f32_16x16x32_bf16 v[68:71], a[44:47], a[4:7], v[68:71]
ds_read_b64_tr_b16 a[78:79], v6 offset:1920
v_mfma_f32_16x16x32_bf16 v[72:75], a[44:47], a[8:11], v[72:75]
ds_read_b64_tr_b16 a[80:81], v7 offset:160
v_mfma_f32_16x16x32_bf16 v[76:79], a[44:47], a[12:15], v[76:79]
ds_read_b64_tr_b16 a[82:83], v7 offset:1952
buffer_load_dwordx4 v135, s[16:19], s11 offen offset:3072 lds
v_mfma_f32_16x16x32_bf16 v[80:83], a[48:51], a[0:3], v[80:83]
ds_read_b64_tr_b16 a[84:85], v6 offset:192
v_mfma_f32_16x16x32_bf16 v[84:87], a[48:51], a[4:7], v[84:87]
ds_read_b64_tr_b16 a[86:87], v6 offset:1984
v_mfma_f32_16x16x32_bf16 v[88:91], a[48:51], a[8:11], v[88:91]
v_mfma_f32_16x16x32_bf16 v[92:95], a[48:51], a[12:15], v[92:95]
v_mfma_f32_16x16x32_bf16 v[96:99], a[52:55], a[0:3], v[96:99]
s_mov_b32 m0, s55
s_nop 0
buffer_load_dwordx4 v136, s[20:23], s54 offen offset:0 lds
v_mfma_f32_16x16x32_bf16 v[100:103], a[52:55], a[4:7], v[100:103]
v_mfma_f32_16x16x32_bf16 v[104:107], a[52:55], a[8:11], v[104:107]
v_mfma_f32_16x16x32_bf16 v[108:111], a[52:55], a[12:15], v[108:111]
v_mfma_f32_16x16x32_bf16 v[112:115], a[56:59], a[0:3], v[112:115]
v_mfma_f32_16x16x32_bf16 v[116:119], a[56:59], a[4:7], v[116:119]
buffer_load_dwordx4 v137, s[20:23], s54 offen offset:1024 lds
v_mfma_f32_16x16x32_bf16 v[120:123], a[56:59], a[8:11], v[120:123]
v_mfma_f32_16x16x32_bf16 v[124:127], a[56:59], a[12:15], v[124:127]
s_waitcnt lgkmcnt(0)
v_mfma_f32_16x16x32_bf16 v[16:19], a[60:63], a[16:19], v[16:19]
ds_read_b64_tr_b16 a[32:33], v6 offset:14336
buffer_load_dwordx4 v138, s[20:23], s54 offen offset:2048 lds
v_mfma_f32_16x16x32_bf16 v[20:23], a[60:63], a[20:23], v[20:23]
ds_read_b64_tr_b16 a[34:35], v6 offset:16128
v_mfma_f32_16x16x32_bf16 v[24:27], a[60:63], a[24:27], v[24:27]
ds_read_b128 a[0:3], v2 offset:49152
v_mfma_f32_16x16x32_bf16 v[28:31], a[60:63], a[28:31], v[28:31]
ds_read_b128 a[4:7], v2 offset:51200
v_mfma_f32_16x16x32_bf16 v[32:35], a[64:67], a[16:19], v[32:35]
ds_read_b128 a[8:11], v2 offset:53248
v_mfma_f32_16x16x32_bf16 v[36:39], a[64:67], a[20:23], v[36:39]
ds_read_b128 a[12:15], v2 offset:55296
buffer_load_dwordx4 v139, s[20:23], s54 offen offset:3072 lds
v_mfma_f32_16x16x32_bf16 v[40:43], a[64:67], a[24:27], v[40:43]
ds_read_b64_tr_b16 a[36:37], v7 offset:14368
v_mfma_f32_16x16x32_bf16 v[44:47], a[64:67], a[28:31], v[44:47]
ds_read_b64_tr_b16 a[38:39], v7 offset:16160
v_mfma_f32_16x16x32_bf16 v[48:51], a[68:71], a[16:19], v[48:51]
ds_read_b64_tr_b16 a[40:41], v6 offset:14400
v_mfma_f32_16x16x32_bf16 v[52:55], a[68:71], a[20:23], v[52:55]
ds_read_b64_tr_b16 a[42:43], v6 offset:16192
v_mfma_f32_16x16x32_bf16 v[56:59], a[68:71], a[24:27], v[56:59]
ds_read_b64_tr_b16 a[44:45], v7 offset:14432
s_add_u32 m0, s55, 4096
s_nop 0
buffer_load_dwordx4 v140, s[20:23], s54 offen offset:0 lds
v_mfma_f32_16x16x32_bf16 v[60:63], a[68:71], a[28:31], v[60:63]
ds_read_b64_tr_b16 a[46:47], v7 offset:16224
v_mfma_f32_16x16x32_bf16 v[64:67], a[72:75], a[16:19], v[64:67]
ds_read_b64_tr_b16 a[48:49], v6 offset:14464
v_mfma_f32_16x16x32_bf16 v[68:71], a[72:75], a[20:23], v[68:71]
ds_read_b64_tr_b16 a[50:51], v6 offset:16256
v_mfma_f32_16x16x32_bf16 v[72:75], a[72:75], a[24:27], v[72:75]
ds_read_b64_tr_b16 a[52:53], v7 offset:14496
v_mfma_f32_16x16x32_bf16 v[76:79], a[72:75], a[28:31], v[76:79]
ds_read_b64_tr_b16 a[54:55], v7 offset:16288
buffer_load_dwordx4 v141, s[20:23], s54 offen offset:1024 lds
v_mfma_f32_16x16x32_bf16 v[80:83], a[76:79], a[16:19], v[80:83]
ds_read_b64_tr_b16 a[56:57], v6 offset:14528
v_mfma_f32_16x16x32_bf16 v[84:87], a[76:79], a[20:23], v[84:87]
ds_read_b64_tr_b16 a[58:59], v6 offset:16320
v_mfma_f32_16x16x32_bf16 v[88:91], a[76:79], a[24:27], v[88:91]
v_mfma_f32_16x16x32_bf16 v[92:95], a[76:79], a[28:31], v[92:95]
v_mfma_f32_16x16x32_bf16 v[96:99], a[80:83], a[16:19], v[96:99]
buffer_load_dwordx4 v142, s[20:23], s54 offen offset:2048 lds
s_add_u32 s54, s54, 458752
s_add_u32 s55, s55, 28672
s_cmp_ge_u32 s55, 86016
s_cselect_b32 s10, 86016, 0
s_sub_u32 s55, s55, s10
v_mfma_f32_16x16x32_bf16 v[100:103], a[80:83], a[20:23], v[100:103]
v_mfma_f32_16x16x32_bf16 v[104:107], a[80:83], a[24:27], v[104:107]
v_mfma_f32_16x16x32_bf16 v[108:111], a[80:83], a[28:31], v[108:111]
v_mfma_f32_16x16x32_bf16 v[112:115], a[84:87], a[16:19], v[112:115]
v_mfma_f32_16x16x32_bf16 v[116:119], a[84:87], a[20:23], v[116:119]
v_mfma_f32_16x16x32_bf16 v[120:123], a[84:87], a[24:27], v[120:123]
v_mfma_f32_16x16x32_bf16 v[124:127], a[84:87], a[28:31], v[124:127]
s_waitcnt lgkmcnt(0)
s_waitcnt vmcnt(11)
s_barrier
v_mfma_f32_16x16x32_bf16 v[16:19], a[32:35], a[0:3], v[16:19]
ds_read_b64_tr_b16 a[60:61], v6 offset:28672
s_add_u32 m0, s51, 32768
s_add_u32 s11, s50, 1792
buffer_load_dwordx4 v132, s[16:19], s11 offen offset:0 lds
v_mfma_f32_16x16x32_bf16 v[20:23], a[32:35], a[4:7], v[20:23]
ds_read_b64_tr_b16 a[62:63], v6 offset:30464
v_mfma_f32_16x16x32_bf16 v[24:27], a[32:35], a[8:11], v[24:27]
ds_read_b128 a[16:19], v3 offset:49152
v_mfma_f32_16x16x32_bf16 v[28:31], a[32:35], a[12:15], v[28:31]
ds_read_b128 a[20:23], v3 offset:51200
v_mfma_f32_16x16x32_bf16 v[32:35], a[36:39], a[0:3], v[32:35]
ds_read_b128 a[24:27], v3 offset:53248
v_mfma_f32_16x16x32_bf16 v[36:39], a[36:39], a[4:7], v[36:39]
ds_read_b128 a[28:31], v3 offset:55296
buffer_load_dwordx4 v133, s[16:19], s11 offen offset:1024 lds
v_mfma_f32_16x16x32_bf16 v[40:43], a[36:39], a[8:11], v[40:43]
ds_read_b64_tr_b16 a[64:65], v7 offset:28704
v_mfma_f32_16x16x32_bf16 v[44:47], a[36:39], a[12:15], v[44:47]
ds_read_b64_tr_b16 a[66:67], v7 offset:30496
v_mfma_f32_16x16x32_bf16 v[48:51], a[40:43], a[0:3], v[48:51]
ds_read_b64_tr_b16 a[68:69], v6 offset:28736
v_mfma_f32_16x16x32_bf16 v[52:55], a[40:43], a[4:7], v[52:55]
ds_read_b64_tr_b16 a[70:71], v6 offset:30528
v_mfma_f32_16x16x32_bf16 v[56:59], a[40:43], a[8:11], v[56:59]
ds_read_b64_tr_b16 a[72:73], v7 offset:28768
buffer_load_dwordx4 v134, s[16:19], s11 offen offset:2048 lds
v_mfma_f32_16x16x32_bf16 v[60:63], a[40:43], a[12:15], v[60:63]
ds_read_b64_tr_b16 a[74:75], v7 offset:30560
v_mfma_f32_16x16x32_bf16 v[64:67], a[44:47], a[0:3], v[64:67]
ds_read_b64_tr_b16 a[76:77], v6 offset:28800
v_mfma_f32_16x16x32_bf16 v[68:71], a[44:47], a[4:7], v[68:71]
ds_read_b64_tr_b16 a[78:79], v6 offset:30592
v_mfma_f32_16x16x32_bf16 v[72:75], a[44:47], a[8:11], v[72:75]
ds_read_b64_tr_b16 a[80:81], v7 offset:28832
v_mfma_f32_16x16x32_bf16 v[76:79], a[44:47], a[12:15], v[76:79]
ds_read_b64_tr_b16 a[82:83], v7 offset:30624
buffer_load_dwordx4 v135, s[16:19], s11 offen offset:3072 lds
v_mfma_f32_16x16x32_bf16 v[80:83], a[48:51], a[0:3], v[80:83]
ds_read_b64_tr_b16 a[84:85], v6 offset:28864
v_mfma_f32_16x16x32_bf16 v[84:87], a[48:51], a[4:7], v[84:87]
ds_read_b64_tr_b16 a[86:87], v6 offset:30656
v_mfma_f32_16x16x32_bf16 v[88:91], a[48:51], a[8:11], v[88:91]
v_mfma_f32_16x16x32_bf16 v[92:95], a[48:51], a[12:15], v[92:95]
v_mfma_f32_16x16x32_bf16 v[96:99], a[52:55], a[0:3], v[96:99]
s_mov_b32 m0, s55
s_nop 0
buffer_load_dwordx4 v136, s[20:23], s54 offen offset:0 lds
v_mfma_f32_16x16x32_bf16 v[100:103], a[52:55], a[4:7], v[100:103]
v_mfma_f32_16x16x32_bf16 v[104:107], a[52:55], a[8:11], v[104:107]
v_mfma_f32_16x16x32_bf16 v[108:111], a[52:55], a[12:15], v[108:111]
v_mfma_f32_16x16x32_bf16 v[112:115], a[56:59], a[0:3], v[112:115]
v_mfma_f32_16x16x32_bf16 v[116:119], a[56:59], a[4:7], v[116:119]
buffer_load_dwordx4 v137, s[20:23], s54 offen offset:1024 lds
v_mfma_f32_16x16x32_bf16 v[120:123], a[56:59], a[8:11], v[120:123]
v_mfma_f32_16x16x32_bf16 v[124:127], a[56:59], a[12:15], v[124:127]
s_waitcnt lgkmcnt(0)
v_mfma_f32_16x16x32_bf16 v[16:19], a[60:63], a[16:19], v[16:19]
ds_read_b64_tr_b16 a[32:33], v4 offset:0
buffer_load_dwordx4 v138, s[20:23], s54 offen offset:2048 lds
v_mfma_f32_16x16x32_bf16 v[20:23], a[60:63], a[20:23], v[20:23]
ds_read_b64_tr_b16 a[34:35], v4 offset:1792
v_mfma_f32_16x16x32_bf16 v[24:27], a[60:63], a[24:27], v[24:27]
ds_read_b128 a[0:3], v2 offset:0
v_mfma_f32_16x16x32_bf16 v[28:31], a[60:63], a[28:31], v[28:31]
ds_read_b128 a[4:7], v2 offset:2048
v_mfma_f32_16x16x32_bf16 v[32:35], a[64:67], a[16:19], v[32:35]
ds_read_b128 a[8:11], v2 offset:4096
v_mfma_f32_16x16x32_bf16 v[36:39], a[64:67], a[20:23], v[36:39]
ds_read_b128 a[12:15], v2 offset:6144
buffer_load_dwordx4 v139, s[20:23], s54 offen offset:3072 lds
v_mfma_f32_16x16x32_bf16 v[40:43], a[64:67], a[24:27], v[40:43]
ds_read_b64_tr_b16 a[36:37], v5 offset:32
v_mfma_f32_16x16x32_bf16 v[44:47], a[64:67], a[28:31], v[44:47]
ds_read_b64_tr_b16 a[38:39], v5 offset:1824
v_mfma_f32_16x16x32_bf16 v[48:51], a[68:71], a[16:19], v[48:51]
ds_read_b64_tr_b16 a[40:41], v4 offset:64
v_mfma_f32_16x16x32_bf16 v[52:55], a[68:71], a[20:23], v[52:55]
ds_read_b64_tr_b16 a[42:43], v4 offset:1856
v_mfma_f32_16x16x32_bf16 v[56:59], a[68:71], a[24:27], v[56:59]
ds_read_b64_tr_b16 a[44:45], v5 offset:96
s_add_u32 m0, s55, 4096
s_nop 0
buffer_load_dwordx4 v140, s[20:23], s54 offen offset:0 lds
v_mfma_f32_16x16x32_bf16 v[60:63], a[68:71], a[28:31], v[60:63]
ds_read_b64_tr_b16 a[46:47], v5 offset:1888
v_mfma_f32_16x16x32_bf16 v[64:67], a[72:75], a[16:19], v[64:67]
ds_read_b64_tr_b16 a[48:49], v4 offset:128
v_mfma_f32_16x16x32_bf16 v[68:71], a[72:75], a[20:23], v[68:71]
ds_read_b64_tr_b16 a[50:51], v4 offset:1920
v_mfma_f32_16x16x32_bf16 v[72:75], a[72:75], a[24:27], v[72:75]
ds_read_b64_tr_b16 a[52:53], v5 offset:160
v_mfma_f32_16x16x32_bf16 v[76:79], a[72:75], a[28:31], v[76:79]
ds_read_b64_tr_b16 a[54:55], v5 offset:1952
buffer_load_dwordx4 v141, s[20:23], s54 offen offset:1024 lds
v_mfma_f32_16x16x32_bf16 v[80:83], a[76:79], a[16:19], v[80:83]
ds_read_b64_tr_b16 a[56:57], v4 offset:192
v_mfma_f32_16x16x32_bf16 v[84:87], a[76:79], a[20:23], v[84:87]
ds_read_b64_tr_b16 a[58:59], v4 offset:1984
v_mfma_f32_16x16x32_bf16 v[88:91], a[76:79], a[24:27], v[88:91]
v_mfma_f32_16x16x32_bf16 v[92:95], a[76:79], a[28:31], v[92:95]
v_mfma_f32_16x16x32_bf16 v[96:99], a[80:83], a[16:19], v[96:99]
buffer_load_dwordx4 v142, s[20:23], s54 offen offset:2048 lds
s_add_u32 s54, s54, 458752
s_add_u32 s55, s55, 28672
s_cmp_ge_u32 s55, 86016
s_cselect_b32 s10, 86016, 0
s_sub_u32 s55, s55, s10
v_mfma_f32_16x16x32_bf16 v[100:103], a[80:83], a[20:23], v[100:103]
v_mfma_f32_16x16x32_bf16 v[104:107], a[80:83], a[24:27], v[104:107]
v_mfma_f32_16x16x32_bf16 v[108:111], a[80:83], a[28:31], v[108:111]
v_mfma_f32_16x16x32_bf16 v[112:115], a[84:87], a[16:19], v[112:115]
v_mfma_f32_16x16x32_bf16 v[116:119], a[84:87], a[20:23], v[116:119]
v_mfma_f32_16x16x32_bf16 v[120:123], a[84:87], a[24:27], v[120:123]
v_mfma_f32_16x16x32_bf16 v[124:127], a[84:87], a[28:31], v[124:127]
s_waitcnt lgkmcnt(0)
s_waitcnt vmcnt(11)
s_barrier
v_mfma_f32_16x16x32_bf16 v[16:19], a[32:35], a[0:3], v[16:19]
ds_read_b64_tr_b16 a[60:61], v4 offset:14336
s_add_u32 m0, s51, 49152
s_add_u32 s11, s50, 1920
buffer_load_dwordx4 v132, s[16:19], s11 offen offset:0 lds
v_mfma_f32_16x16x32_bf16 v[20:23], a[32:35], a[4:7], v[20:23]
ds_read_b64_tr_b16 a[62:63], v4 offset:16128
v_mfma_f32_16x16x32_bf16 v[24:27], a[32:35], a[8:11], v[24:27]
ds_read_b128 a[16:19], v3 offset:0
v_mfma_f32_16x16x32_bf16 v[28:31], a[32:35], a[12:15], v[28:31]
ds_read_b128 a[20:23], v3 offset:2048
v_mfma_f32_16x16x32_bf16 v[32:35], a[36:39], a[0:3], v[32:35]
ds_read_b128 a[24:27], v3 offset:4096
v_mfma_f32_16x16x32_bf16 v[36:39], a[36:39], a[4:7], v[36:39]
ds_read_b128 a[28:31], v3 offset:6144
buffer_load_dwordx4 v133, s[16:19], s11 offen offset:1024 lds
v_mfma_f32_16x16x32_bf16 v[40:43], a[36:39], a[8:11], v[40:43]
ds_read_b64_tr_b16 a[64:65], v5 offset:14368
v_mfma_f32_16x16x32_bf16 v[44:47], a[36:39], a[12:15], v[44:47]
ds_read_b64_tr_b16 a[66:67], v5 offset:16160
v_mfma_f32_16x16x32_bf16 v[48:51], a[40:43], a[0:3], v[48:51]
ds_read_b64_tr_b16 a[68:69], v4 offset:14400
v_mfma_f32_16x16x32_bf16 v[52:55], a[40:43], a[4:7], v[52:55]
ds_read_b64_tr_b16 a[70:71], v4 offset:16192
v_mfma_f32_16x16x32_bf16 v[56:59], a[40:43], a[8:11], v[56:59]
ds_read_b64_tr_b16 a[72:73], v5 offset:14432
buffer_load_dwordx4 v134, s[16:19], s11 offen offset:2048 lds
v_mfma_f32_16x16x32_bf16 v[60:63], a[40:43], a[12:15], v[60:63]
ds_read_b64_tr_b16 a[74:75], v5 offset:16224
v_mfma_f32_16x16x32_bf16 v[64:67], a[44:47], a[0:3], v[64:67]
ds_read_b64_tr_b16 a[76:77], v4 offset:14464
v_mfma_f32_16x16x32_bf16 v[68:71], a[44:47], a[4:7], v[68:71]
ds_read_b64_tr_b16 a[78:79], v4 offset:16256
v_mfma_f32_16x16x32_bf16 v[72:75], a[44:47], a[8:11], v[72:75]
ds_read_b64_tr_b16 a[80:81], v5 offset:14496
v_mfma_f32_16x16x32_bf16 v[76:79], a[44:47], a[12:15], v[76:79]
ds_read_b64_tr_b16 a[82:83], v5 offset:16288
buffer_load_dwordx4 v135, s[16:19], s11 offen offset:3072 lds
v_mfma_f32_16x16x32_bf16 v[80:83], a[48:51], a[0:3], v[80:83]
ds_read_b64_tr_b16 a[84:85], v4 offset:14528
v_mfma_f32_16x16x32_bf16 v[84:87], a[48:51], a[4:7], v[84:87]
ds_read_b64_tr_b16 a[86:87], v4 offset:16320
v_mfma_f32_16x16x32_bf16 v[88:91], a[48:51], a[8:11], v[88:91]
v_mfma_f32_16x16x32_bf16 v[92:95], a[48:51], a[12:15], v[92:95]
v_mfma_f32_16x16x32_bf16 v[96:99], a[52:55], a[0:3], v[96:99]
s_mov_b32 m0, s55
s_nop 0
buffer_load_dwordx4 v136, s[20:23], s54 offen offset:0 lds
v_mfma_f32_16x16x32_bf16 v[100:103], a[52:55], a[4:7], v[100:103]
v_mfma_f32_16x16x32_bf16 v[104:107], a[52:55], a[8:11], v[104:107]
v_mfma_f32_16x16x32_bf16 v[108:111], a[52:55], a[12:15], v[108:111]
v_mfma_f32_16x16x32_bf16 v[112:115], a[56:59], a[0:3], v[112:115]
v_mfma_f32_16x16x32_bf16 v[116:119], a[56:59], a[4:7], v[116:119]
buffer_load_dwordx4 v137, s[20:23], s54 offen offset:1024 lds
v_mfma_f32_16x16x32_bf16 v[120:123], a[56:59], a[8:11], v[120:123]
v_mfma_f32_16x16x32_bf16 v[124:127], a[56:59], a[12:15], v[124:127]
s_waitcnt lgkmcnt(0)
v_mfma_f32_16x16x32_bf16 v[16:19], a[60:63], a[16:19], v[16:19]
ds_read_b64_tr_b16 a[32:33], v4 offset:28672
buffer_load_dwordx4 v138, s[20:23], s54 offen offset:2048 lds
v_mfma_f32_16x16x32_bf16 v[20:23], a[60:63], a[20:23], v[20:23]
ds_read_b64_tr_b16 a[34:35], v4 offset:30464
v_mfma_f32_16x16x32_bf16 v[24:27], a[60:63], a[24:27], v[24:27]
ds_read_b128 a[0:3], v2 offset:16384
v_mfma_f32_16x16x32_bf16 v[28:31], a[60:63], a[28:31], v[28:31]
ds_read_b128 a[4:7], v2 offset:18432
v_mfma_f32_16x16x32_bf16 v[32:35], a[64:67], a[16:19], v[32:35]
ds_read_b128 a[8:11], v2 offset:20480
v_mfma_f32_16x16x32_bf16 v[36:39], a[64:67], a[20:23], v[36:39]
ds_read_b128 a[12:15], v2 offset:22528
buffer_load_dwordx4 v139, s[20:23], s54 offen offset:3072 lds
v_mfma_f32_16x16x32_bf16 v[40:43], a[64:67], a[24:27], v[40:43]
ds_read_b64_tr_b16 a[36:37], v5 offset:28704
v_mfma_f32_16x16x32_bf16 v[44:47], a[64:67], a[28:31], v[44:47]
ds_read_b64_tr_b16 a[38:39], v5 offset:30496
v_mfma_f32_16x16x32_bf16 v[48:51], a[68:71], a[16:19], v[48:51]
ds_read_b64_tr_b16 a[40:41], v4 offset:28736
v_mfma_f32_16x16x32_bf16 v[52:55], a[68:71], a[20:23], v[52:55]
ds_read_b64_tr_b16 a[42:43], v4 offset:30528
v_mfma_f32_16x16x32_bf16 v[56:59], a[68:71], a[24:27], v[56:59]
ds_read_b64_tr_b16 a[44:45], v5 offset:28768
s_add_u32 m0, s55, 4096
s_nop 0
buffer_load_dwordx4 v140, s[20:23], s54 offen offset:0 lds
v_mfma_f32_16x16x32_bf16 v[60:63], a[68:71], a[28:31], v[60:63]
ds_read_b64_tr_b16 a[46:47], v5 offset:30560
v_mfma_f32_16x16x32_bf16 v[64:67], a[72:75], a[16:19], v[64:67]
ds_read_b64_tr_b16 a[48:49], v4 offset:28800
v_mfma_f32_16x16x32_bf16 v[68:71], a[72:75], a[20:23], v[68:71]
ds_read_b64_tr_b16 a[50:51], v4 offset:30592
v_mfma_f32_16x16x32_bf16 v[72:75], a[72:75], a[24:27], v[72:75]
ds_read_b64_tr_b16 a[52:53], v5 offset:28832
v_mfma_f32_16x16x32_bf16 v[76:79], a[72:75], a[28:31], v[76:79]
ds_read_b64_tr_b16 a[54:55], v5 offset:30624
buffer_load_dwordx4 v141, s[20:23], s54 offen offset:1024 lds
v_mfma_f32_16x16x32_bf16 v[80:83], a[76:79], a[16:19], v[80:83]
ds_read_b64_tr_b16 a[56:57], v4 offset:28864
v_mfma_f32_16x16x32_bf16 v[84:87], a[76:79], a[20:23], v[84:87]
ds_read_b64_tr_b16 a[58:59], v4 offset:30656
v_mfma_f32_16x16x32_bf16 v[88:91], a[76:79], a[24:27], v[88:91]
v_mfma_f32_16x16x32_bf16 v[92:95], a[76:79], a[28:31], v[92:95]
v_mfma_f32_16x16x32_bf16 v[96:99], a[80:83], a[16:19], v[96:99]
buffer_load_dwordx4 v142, s[20:23], s54 offen offset:2048 lds
s_add_u32 s54, s54, 458752
s_add_u32 s55, s55, 28672
s_cmp_ge_u32 s55, 86016
s_cselect_b32 s10, 86016, 0
s_sub_u32 s55, s55, s10
v_mfma_f32_16x16x32_bf16 v[100:103], a[80:83], a[20:23], v[100:103]
v_mfma_f32_16x16x32_bf16 v[104:107], a[80:83], a[24:27], v[104:107]
v_mfma_f32_16x16x32_bf16 v[108:111], a[80:83], a[28:31], v[108:111]
v_mfma_f32_16x16x32_bf16 v[112:115], a[84:87], a[16:19], v[112:115]
v_mfma_f32_16x16x32_bf16 v[116:119], a[84:87], a[20:23], v[116:119]
v_mfma_f32_16x16x32_bf16 v[120:123], a[84:87], a[24:27], v[120:123]
v_mfma_f32_16x16x32_bf16 v[124:127], a[84:87], a[28:31], v[124:127]
s_waitcnt lgkmcnt(0)
s_waitcnt vmcnt(11)
s_barrier
s_cmp_eq_u32 s52, 0
s_cbranch_scc1 L_s13_2
s_mov_b32 m0, s55
s_nop 0
buffer_load_dwordx4 v136, s[20:23], s54 offen offset:0 lds
buffer_load_dwordx4 v137, s[20:23], s54 offen offset:1024 lds
buffer_load_dwordx4 v138, s[20:23], s54 offen offset:2048 lds
buffer_load_dwordx4 v139, s[20:23], s54 offen offset:3072 lds
s_add_u32 m0, s55, 4096
s_nop 0
buffer_load_dwordx4 v140, s[20:23], s54 offen offset:0 lds
buffer_load_dwordx4 v141, s[20:23], s54 offen offset:1024 lds
buffer_load_dwordx4 v142, s[20:23], s54 offen offset:2048 lds
L_s13_2:
v_mfma_f32_16x16x32_bf16 v[16:19], a[32:35], a[0:3], v[16:19]
ds_read_b64_tr_b16 a[60:61], v6 offset:0
v_mfma_f32_16x16x32_bf16 v[20:23], a[32:35], a[4:7], v[20:23]
ds_read_b64_tr_b16 a[62:63], v6 offset:1792
v_mfma_f32_16x16x32_bf16 v[24:27], a[32:35], a[8:11], v[24:27]
ds_read_b128 a[16:19], v3 offset:16384
v_mfma_f32_16x16x32_bf16 v[28:31], a[32:35], a[12:15], v[28:31]
ds_read_b128 a[20:23], v3 offset:18432
v_mfma_f32_16x16x32_bf16 v[32:35], a[36:39], a[0:3], v[32:35]
ds_read_b128 a[24:27], v3 offset:20480
v_mfma_f32_16x16x32_bf16 v[36:39], a[36:39], a[4:7], v[36:39]
ds_read_b128 a[28:31], v3 offset:22528
v_mfma_f32_16x16x32_bf16 v[40:43], a[36:39], a[8:11], v[40:43]
ds_read_b64_tr_b16 a[64:65], v7 offset:32
v_mfma_f32_16x16x32_bf16 v[44:47], a[36:39], a[12:15], v[44:47]
ds_read_b64_tr_b16 a[66:67], v7 offset:1824
v_mfma_f32_16x16x32_bf16 v[48:51], a[40:43], a[0:3], v[48:51]
ds_read_b64_tr_b16 a[68:69], v6 offset:64
v_mfma_f32_16x16x32_bf16 v[52:55], a[40:43], a[4:7], v[52:55]
ds_read_b64_tr_b16 a[70:71], v6 offset:1856
v_mfma_f32_16x16x32_bf16 v[56:59], a[40:43], a[8:11], v[56:59]
ds_read_b64_tr_b16 a[72:73], v7 offset:96
v_mfma_f32_16x16x32_bf16 v[60:63], a[40:43], a[12:15], v[60:63]
ds_read_b64_tr_b16 a[74:75], v7 offset:1888
v_mfma_f32_16x16x32_bf16 v[64:67], a[44:47], a[0:3], v[64:67]
ds_read_b64_tr_b16 a[76:77], v6 offset:128
v_mfma_f32_16x16x32_bf16 v[68:71], a[44:47], a[4:7], v[68:71]
ds_read_b64_tr_b16 a[78:79], v6 offset:1920
v_mfma_f32_16x16x32_bf16 v[72:75], a[44:47], a[8:11], v[72:75]
ds_read_b64_tr_b16 a[80:81], v7 offset:160
v_mfma_f32_16x16x32_bf16 v[76:79], a[44:47], a[12:15], v[76:79]
ds_read_b64_tr_b16 a[82:83], v7 offset:1952
v_mfma_f32_16x16x32_bf16 v[80:83], a[48:51], a[0:3], v[80:83]
ds_read_b64_tr_b16 a[84:85], v6 offset:192
v_mfma_f32_16x16x32_bf16 v[84:87], a[48:51], a[4:7], v[84:87]
ds_read_b64_tr_b16 a[86:87], v6 offset:1984
v_mfma_f32_16x16x32_bf16 v[88:91], a[48:51], a[8:11], v[88:91]
v_mfma_f32_16x16x32_bf16 v[92:95], a[48:51], a[12:15], v[92:95]
v_mfma_f32_16x16x32_bf16 v[96:99], a[52:55], a[0:3], v[96:99]
v_mfma_f32_16x16x32_bf16 v[100:103], a[52:55], a[4:7], v[100:103]
v_mfma_f32_16x16x32_bf16 v[104:107], a[52:55], a[8:11], v[104:107]
v_mfma_f32_16x16x32_bf16 v[108:111], a[52:55], a[12:15], v[108:111]
v_mfma_f32_16x16x32_bf16 v[112:115], a[56:59], a[0:3], v[112:115]
v_mfma_f32_16x16x32_bf16 v[116:119], a[56:59], a[4:7], v[116:119]
v_mfma_f32_16x16x32_bf16 v[120:123], a[56:59], a[8:11], v[120:123]
v_mfma_f32_16x16x32_bf16 v[124:127], a[56:59], a[12:15], v[124:127]
s_waitcnt lgkmcnt(0)
v_mfma_f32_16x16x32_bf16 v[16:19], a[60:63], a[16:19], v[16:19]
ds_read_b64_tr_b16 a[32:33], v6 offset:14336
v_mfma_f32_16x16x32_bf16 v[20:23], a[60:63], a[20:23], v[20:23]
ds_read_b64_tr_b16 a[34:35], v6 offset:16128
v_mfma_f32_16x16x32_bf16 v[24:27], a[60:63], a[24:27], v[24:27]
ds_read_b128 a[0:3], v2 offset:32768
v_mfma_f32_16x16x32_bf16 v[28:31], a[60:63], a[28:31], v[28:31]
ds_read_b128 a[4:7], v2 offset:34816
v_mfma_f32_16x16x32_bf16 v[32:35], a[64:67], a[16:19], v[32:35]
ds_read_b128 a[8:11], v2 offset:36864
v_mfma_f32_16x16x32_bf16 v[36:39], a[64:67], a[20:23], v[36:39]
ds_read_b128 a[12:15], v2 offset:38912
v_mfma_f32_16x16x32_bf16 v[40:43], a[64:67], a[24:27], v[40:43]
ds_read_b64_tr_b16 a[36:37], v7 offset:14368
v_mfma_f32_16x16x32_bf16 v[44:47], a[64:67], a[28:31], v[44:47]
ds_read_b64_tr_b16 a[38:39], v7 offset:16160
v_mfma_f32_16x16x32_bf16 v[48:51], a[68:71], a[16:19], v[48:51]
ds_read_b64_tr_b16 a[40:41], v6 offset:14400
v_mfma_f32_16x16x32_bf16 v[52:55], a[68:71], a[20:23], v[52:55]
ds_read_b64_tr_b16 a[42:43], v6 offset:16192
v_mfma_f32_16x16x32_bf16 v[56:59], a[68:71], a[24:27], v[56:59]
ds_read_b64_tr_b16 a[44:45], v7 offset:14432
v_mfma_f32_16x16x32_bf16 v[60:63], a[68:71], a[28:31], v[60:63]
ds_read_b64_tr_b16 a[46:47], v7 offset:16224
v_mfma_f32_16x16x32_bf16 v[64:67], a[72:75], a[16:19], v[64:67]
ds_read_b64_tr_b16 a[48:49], v6 offset:14464
v_mfma_f32_16x16x32_bf16 v[68:71], a[72:75], a[20:23], v[68:71]
ds_read_b64_tr_b16 a[50:51], v6 offset:16256
v_mfma_f32_16x16x32_bf16 v[72:75], a[72:75], a[24:27], v[72:75]
ds_read_b64_tr_b16 a[52:53], v7 offset:14496
v_mfma_f32_16x16x32_bf16 v[76:79], a[72:75], a[28:31], v[76:79]
ds_read_b64_tr_b16 a[54:55], v7 offset:16288
v_mfma_f32_16x16x32_bf16 v[80:83], a[76:79], a[16:19], v[80:83]
ds_read_b64_tr_b16 a[56:57], v6 offset:14528
v_mfma_f32_16x16x32_bf16 v[84:87], a[76:79], a[20:23], v[84:87]
ds_read_b64_tr_b16 a[58:59], v6 offset:16320
v_mfma_f32_16x16x32_bf16 v[88:91], a[76:79], a[24:27], v[88:91]
v_mfma_f32_16x16x32_bf16 v[92:95], a[76:79], a[28:31], v[92:95]
v_mfma_f32_16x16x32_bf16 v[96:99], a[80:83], a[16:19], v[96:99]
v_mfma_f32_16x16x32_bf16 v[100:103], a[80:83], a[20:23], v[100:103]
v_mfma_f32_16x16x32_bf16 v[104:107], a[80:83], a[24:27], v[104:107]
v_mfma_f32_16x16x32_bf16 v[108:111], a[80:83], a[28:31], v[108:111]
v_mfma_f32_16x16x32_bf16 v[112:115], a[84:87], a[16:19], v[112:115]
v_mfma_f32_16x16x32_bf16 v[116:119], a[84:87], a[20:23], v[116:119]
v_mfma_f32_16x16x32_bf16 v[120:123], a[84:87], a[24:27], v[120:123]
v_mfma_f32_16x16x32_bf16 v[124:127], a[84:87], a[28:31], v[124:127]
s_waitcnt lgkmcnt(0)
s_cmp_eq_u32 s52, 0
s_cbranch_scc1 L_w13_3
s_waitcnt vmcnt(7)
s_branch L_w13j_4
L_w13_3:
s_waitcnt vmcnt(0)
L_w13j_4:
s_barrier
v_and_b32 v128, 15, v1
s_lshl_b32 s10, s6, 7
s_lshl_b32 s11, s44, 6
s_add_u32 s10, s10, s11
v_add_u32 v128, s10, v128
v_lshlrev_b32 v128, 4, v128
v_add_u32 v128, 27262984, v128
v_lshrrev_b32 v129, 4, v1
v_lshlrev_b32 v129, 4, v129
s_mul_i32 s10, s45, 448
s_add_u32 s10, s10, 75264
v_add_u32 v129, s10, v129
s_lshl_b32 s46, s6, 3
s_lshl_b32 s11, s44, 2
s_add_u32 s46, s46, s11
s_mul_i32 s46, s46, 114688
s_mul_i32 s11, s7, 7168
s_add_u32 s46, s46, s11
v_lshlrev_b32 v130, 4, v1
s_mov_b32 s48, 0xbdd2d3e8
s_mov_b32 s49, 0xbdd2d3e8
v_mov_b32 v156, 0xc0135761
v_mov_b32 v157, 0xc0135761
v_mov_b32 v143, 163328
ds_read_b32 v144, v143
s_waitcnt lgkmcnt(0)
v_readfirstlane_b32 s97, v144
v_mfma_f32_16x16x32_bf16 v[16:19], a[32:35], a[0:3], v[16:19]
ds_read_b64_tr_b16 a[60:61], v6 offset:28672
v_mfma_f32_16x16x32_bf16 v[20:23], a[32:35], a[4:7], v[20:23]
ds_read_b64_tr_b16 a[62:63], v6 offset:30464
v_mfma_f32_16x16x32_bf16 v[24:27], a[32:35], a[8:11], v[24:27]
ds_read_b128 a[16:19], v3 offset:32768
v_mfma_f32_16x16x32_bf16 v[28:31], a[32:35], a[12:15], v[28:31]
ds_read_b128 a[20:23], v3 offset:34816
v_mfma_f32_16x16x32_bf16 v[32:35], a[36:39], a[0:3], v[32:35]
ds_read_b128 a[24:27], v3 offset:36864
v_mfma_f32_16x16x32_bf16 v[36:39], a[36:39], a[4:7], v[36:39]
ds_read_b128 a[28:31], v3 offset:38912
v_mfma_f32_16x16x32_bf16 v[40:43], a[36:39], a[8:11], v[40:43]
ds_read_b64_tr_b16 a[64:65], v7 offset:28704
v_mfma_f32_16x16x32_bf16 v[44:47], a[36:39], a[12:15], v[44:47]
ds_read_b64_tr_b16 a[66:67], v7 offset:30496
v_mfma_f32_16x16x32_bf16 v[48:51], a[40:43], a[0:3], v[48:51]
ds_read_b64_tr_b16 a[68:69], v6 offset:28736
v_mfma_f32_16x16x32_bf16 v[52:55], a[40:43], a[4:7], v[52:55]
ds_read_b64_tr_b16 a[70:71], v6 offset:30528
v_mfma_f32_16x16x32_bf16 v[56:59], a[40:43], a[8:11], v[56:59]
ds_read_b64_tr_b16 a[72:73], v7 offset:28768
v_mfma_f32_16x16x32_bf16 v[60:63], a[40:43], a[12:15], v[60:63]
ds_read_b64_tr_b16 a[74:75], v7 offset:30560
v_mfma_f32_16x16x32_bf16 v[64:67], a[44:47], a[0:3], v[64:67]
ds_read_b64_tr_b16 a[76:77], v6 offset:28800
v_mfma_f32_16x16x32_bf16 v[68:71], a[44:47], a[4:7], v[68:71]
ds_read_b64_tr_b16 a[78:79], v6 offset:30592
v_mfma_f32_16x16x32_bf16 v[72:75], a[44:47], a[8:11], v[72:75]
ds_read_b64_tr_b16 a[80:81], v7 offset:28832
v_mfma_f32_16x16x32_bf16 v[76:79], a[44:47], a[12:15], v[76:79]
ds_read_b64_tr_b16 a[82:83], v7 offset:30624
v_mfma_f32_16x16x32_bf16 v[80:83], a[48:51], a[0:3], v[80:83]
ds_read_b64_tr_b16 a[84:85], v6 offset:28864
v_mfma_f32_16x16x32_bf16 v[84:87], a[48:51], a[4:7], v[84:87]
ds_read_b64_tr_b16 a[86:87], v6 offset:30656
v_mfma_f32_16x16x32_bf16 v[88:91], a[48:51], a[8:11], v[88:91]
v_mfma_f32_16x16x32_bf16 v[92:95], a[48:51], a[12:15], v[92:95]
v_mfma_f32_16x16x32_bf16 v[96:99], a[52:55], a[0:3], v[96:99]
v_mfma_f32_16x16x32_bf16 v[100:103], a[52:55], a[4:7], v[100:103]
v_mfma_f32_16x16x32_bf16 v[104:107], a[52:55], a[8:11], v[104:107]
v_mfma_f32_16x16x32_bf16 v[108:111], a[52:55], a[12:15], v[108:111]
v_mfma_f32_16x16x32_bf16 v[112:115], a[56:59], a[0:3], v[112:115]
v_mfma_f32_16x16x32_bf16 v[116:119], a[56:59], a[4:7], v[116:119]
v_mfma_f32_16x16x32_bf16 v[120:123], a[56:59], a[8:11], v[120:123]
v_mfma_f32_16x16x32_bf16 v[124:127], a[56:59], a[12:15], v[124:127]
s_waitcnt lgkmcnt(0)
v_mfma_f32_16x16x32_bf16 v[16:19], a[60:63], a[16:19], v[16:19]
ds_read_b64_tr_b16 a[32:33], v4 offset:0
v_mfma_f32_16x16x32_bf16 v[20:23], a[60:63], a[20:23], v[20:23]
ds_read_b64_tr_b16 a[34:35], v4 offset:1792
v_mfma_f32_16x16x32_bf16 v[24:27], a[60:63], a[24:27], v[24:27]
ds_read_b128 a[0:3], v2 offset:49152
v_mfma_f32_16x16x32_bf16 v[28:31], a[60:63], a[28:31], v[28:31]
ds_read_b128 a[4:7], v2 offset:51200
v_mfma_f32_16x16x32_bf16 v[32:35], a[64:67], a[16:19], v[32:35]
ds_read_b128 a[8:11], v2 offset:53248
v_mfma_f32_16x16x32_bf16 v[36:39], a[64:67], a[20:23], v[36:39]
ds_read_b128 a[12:15], v2 offset:55296
v_mfma_f32_16x16x32_bf16 v[40:43], a[64:67], a[24:27], v[40:43]
ds_read_b64_tr_b16 a[36:37], v5 offset:32
v_mfma_f32_16x16x32_bf16 v[44:47], a[64:67], a[28:31], v[44:47]
ds_read_b64_tr_b16 a[38:39], v5 offset:1824
v_mfma_f32_16x16x32_bf16 v[48:51], a[68:71], a[16:19], v[48:51]
ds_read_b64_tr_b16 a[40:41], v4 offset:64
v_mfma_f32_16x16x32_bf16 v[52:55], a[68:71], a[20:23], v[52:55]
ds_read_b64_tr_b16 a[42:43], v4 offset:1856
v_mfma_f32_16x16x32_bf16 v[56:59], a[68:71], a[24:27], v[56:59]
ds_read_b64_tr_b16 a[44:45], v5 offset:96
v_mfma_f32_16x16x32_bf16 v[60:63], a[68:71], a[28:31], v[60:63]
ds_read_b64_tr_b16 a[46:47], v5 offset:1888
v_mfma_f32_16x16x32_bf16 v[64:67], a[72:75], a[16:19], v[64:67]
ds_read_b64_tr_b16 a[48:49], v4 offset:128
v_mfma_f32_16x16x32_bf16 v[68:71], a[72:75], a[20:23], v[68:71]
ds_read_b64_tr_b16 a[50:51], v4 offset:1920
v_mfma_f32_16x16x32_bf16 v[72:75], a[72:75], a[24:27], v[72:75]
ds_read_b64_tr_b16 a[52:53], v5 offset:160
v_mfma_f32_16x16x32_bf16 v[76:79], a[72:75], a[28:31], v[76:79]
ds_read_b64_tr_b16 a[54:55], v5 offset:1952
v_mfma_f32_16x16x32_bf16 v[80:83], a[76:79], a[16:19], v[80:83]
ds_read_b64_tr_b16 a[56:57], v4 offset:192
v_mfma_f32_16x16x32_bf16 v[84:87], a[76:79], a[20:23], v[84:87]
ds_read_b64_tr_b16 a[58:59], v4 offset:1984
v_mfma_f32_16x16x32_bf16 v[88:91], a[76:79], a[24:27], v[88:91]
v_mfma_f32_16x16x32_bf16 v[92:95], a[76:79], a[28:31], v[92:95]
v_mfma_f32_16x16x32_bf16 v[96:99], a[80:83], a[16:19], v[96:99]
v_mfma_f32_16x16x32_bf16 v[100:103], a[80:83], a[20:23], v[100:103]
v_mfma_f32_16x16x32_bf16 v[104:107], a[80:83], a[24:27], v[104:107]
v_mfma_f32_16x16x32_bf16 v[108:111], a[80:83], a[28:31], v[108:111]
v_mfma_f32_16x16x32_bf16 v[112:115], a[84:87], a[16:19], v[112:115]
v_mfma_f32_16x16x32_bf16 v[116:119], a[84:87], a[20:23], v[116:119]
v_mfma_f32_16x16x32_bf16 v[120:123], a[84:87], a[24:27], v[120:123]
v_mfma_f32_16x16x32_bf16 v[124:127], a[84:87], a[28:31], v[124:127]
s_waitcnt lgkmcnt(0)
s_waitcnt vmcnt(0)
s_barrier
buffer_load_dwordx2 v[8:9], v128, s[24:27], 0 offen offset:0 sc1
buffer_load_dwordx2 v[10:11], v128, s[24:27], 0 offen offset:256 sc1
buffer_load_dwordx2 v[12:13], v128, s[24:27], 0 offen offset:512 sc1
buffer_load_dwordx2 v[14:15], v128, s[24:27], 0 offen offset:768 sc1
v_mfma_f32_16x16x32_bf16 v[16:19], a[32:35], a[0:3], v[16:19]
ds_read_b64_tr_b16 a[60:61], v4 offset:14336
v_mfma_f32_16x16x32_bf16 v[20:23], a[32:35], a[4:7], v[20:23]
ds_read_b64_tr_b16 a[62:63], v4 offset:16128
v_mfma_f32_16x16x32_bf16 v[24:27], a[32:35], a[8:11], v[24:27]
ds_read_b128 a[16:19], v3 offset:49152
v_mfma_f32_16x16x32_bf16 v[28:31], a[32:35], a[12:15], v[28:31]
ds_read_b128 a[20:23], v3 offset:51200
v_mfma_f32_16x16x32_bf16 v[32:35], a[36:39], a[0:3], v[32:35]
ds_read_b128 a[24:27], v3 offset:53248
v_mfma_f32_16x16x32_bf16 v[36:39], a[36:39], a[4:7], v[36:39]
ds_read_b128 a[28:31], v3 offset:55296
v_mfma_f32_16x16x32_bf16 v[40:43], a[36:39], a[8:11], v[40:43]
ds_read_b64_tr_b16 a[64:65], v5 offset:14368
v_mfma_f32_16x16x32_bf16 v[44:47], a[36:39], a[12:15], v[44:47]
ds_read_b64_tr_b16 a[66:67], v5 offset:16160
v_mfma_f32_16x16x32_bf16 v[48:51], a[40:43], a[0:3], v[48:51]
ds_read_b64_tr_b16 a[68:69], v4 offset:14400
v_mfma_f32_16x16x32_bf16 v[52:55], a[40:43], a[4:7], v[52:55]
ds_read_b64_tr_b16 a[70:71], v4 offset:16192
v_mfma_f32_16x16x32_bf16 v[56:59], a[40:43], a[8:11], v[56:59]
ds_read_b64_tr_b16 a[72:73], v5 offset:14432
v_mfma_f32_16x16x32_bf16 v[60:63], a[40:43], a[12:15], v[60:63]
ds_read_b64_tr_b16 a[74:75], v5 offset:16224
v_mfma_f32_16x16x32_bf16 v[64:67], a[44:47], a[0:3], v[64:67]
ds_read_b64_tr_b16 a[76:77], v4 offset:14464
v_mfma_f32_16x16x32_bf16 v[68:71], a[44:47], a[4:7], v[68:71]
ds_read_b64_tr_b16 a[78:79], v4 offset:16256
v_mfma_f32_16x16x32_bf16 v[72:75], a[44:47], a[8:11], v[72:75]
ds_read_b64_tr_b16 a[80:81], v5 offset:14496
v_mfma_f32_16x16x32_bf16 v[76:79], a[44:47], a[12:15], v[76:79]
ds_read_b64_tr_b16 a[82:83], v5 offset:16288
v_mfma_f32_16x16x32_bf16 v[80:83], a[48:51], a[0:3], v[80:83]
ds_read_b64_tr_b16 a[84:85], v4 offset:14528
v_mfma_f32_16x16x32_bf16 v[84:87], a[48:51], a[4:7], v[84:87]
ds_read_b64_tr_b16 a[86:87], v4 offset:16320
v_mfma_f32_16x16x32_bf16 v[88:91], a[48:51], a[8:11], v[88:91]
v_mfma_f32_16x16x32_bf16 v[92:95], a[48:51], a[12:15], v[92:95]
v_mfma_f32_16x16x32_bf16 v[96:99], a[52:55], a[0:3], v[96:99]
v_mfma_f32_16x16x32_bf16 v[100:103], a[52:55], a[4:7], v[100:103]
v_mfma_f32_16x16x32_bf16 v[104:107], a[52:55], a[8:11], v[104:107]
v_mfma_f32_16x16x32_bf16 v[108:111], a[52:55], a[12:15], v[108:111]
v_mfma_f32_16x16x32_bf16 v[112:115], a[56:59], a[0:3], v[112:115]
v_mfma_f32_16x16x32_bf16 v[116:119], a[56:59], a[4:7], v[116:119]
v_mfma_f32_16x16x32_bf16 v[120:123], a[56:59], a[8:11], v[120:123]
v_mfma_f32_16x16x32_bf16 v[124:127], a[56:59], a[12:15], v[124:127]
s_waitcnt lgkmcnt(0)
v_mfma_f32_16x16x32_bf16 v[16:19], a[60:63], a[16:19], v[16:19]
v_mfma_f32_16x16x32_bf16 v[20:23], a[60:63], a[20:23], v[20:23]
v_mfma_f32_16x16x32_bf16 v[24:27], a[60:63], a[24:27], v[24:27]
v_mfma_f32_16x16x32_bf16 v[28:31], a[60:63], a[28:31], v[28:31]
v_mfma_f32_16x16x32_bf16 v[32:35], a[64:67], a[16:19], v[32:35]
v_mfma_f32_16x16x32_bf16 v[36:39], a[64:67], a[20:23], v[36:39]
v_mfma_f32_16x16x32_bf16 v[40:43], a[64:67], a[24:27], v[40:43]
v_mfma_f32_16x16x32_bf16 v[44:47], a[64:67], a[28:31], v[44:47]
v_mfma_f32_16x16x32_bf16 v[48:51], a[68:71], a[16:19], v[48:51]
v_mfma_f32_16x16x32_bf16 v[52:55], a[68:71], a[20:23], v[52:55]
v_mfma_f32_16x16x32_bf16 v[56:59], a[68:71], a[24:27], v[56:59]
v_mfma_f32_16x16x32_bf16 v[60:63], a[68:71], a[28:31], v[60:63]
v_mfma_f32_16x16x32_bf16 v[64:67], a[72:75], a[16:19], v[64:67]
v_mfma_f32_16x16x32_bf16 v[68:71], a[72:75], a[20:23], v[68:71]
v_mfma_f32_16x16x32_bf16 v[72:75], a[72:75], a[24:27], v[72:75]
v_mfma_f32_16x16x32_bf16 v[76:79], a[72:75], a[28:31], v[76:79]
v_mfma_f32_16x16x32_bf16 v[80:83], a[76:79], a[16:19], v[80:83]
v_mfma_f32_16x16x32_bf16 v[84:87], a[76:79], a[20:23], v[84:87]
v_mfma_f32_16x16x32_bf16 v[88:91], a[76:79], a[24:27], v[88:91]
v_mfma_f32_16x16x32_bf16 v[92:95], a[76:79], a[28:31], v[92:95]
v_mfma_f32_16x16x32_bf16 v[96:99], a[80:83], a[16:19], v[96:99]
v_mfma_f32_16x16x32_bf16 v[100:103], a[80:83], a[20:23], v[100:103]
v_mfma_f32_16x16x32_bf16 v[104:107], a[80:83], a[24:27], v[104:107]
v_mfma_f32_16x16x32_bf16 v[108:111], a[80:83], a[28:31], v[108:111]
v_mfma_f32_16x16x32_bf16 v[112:115], a[84:87], a[16:19], v[112:115]
v_mfma_f32_16x16x32_bf16 v[116:119], a[84:87], a[20:23], v[116:119]
v_mfma_f32_16x16x32_bf16 v[120:123], a[84:87], a[24:27], v[120:123]
v_mfma_f32_16x16x32_bf16 v[124:127], a[84:87], a[28:31], v[124:127]
s_waitcnt lgkmcnt(0)
s_barrier
ds_read_b128 v[132:135], v129
ds_read_b128 v[136:139], v129 offset:896
s_waitcnt vmcnt(0)
v_sub_f32 v9, 0, v9
v_sub_f32 v11, 0, v11
v_sub_f32 v13, 0, v13
v_sub_f32 v15, 0, v15
v_mov_b32 v128, 1.0
v_lshlrev_b32 v131, 3, v1
s_lshl_b32 s10, s44, 11
s_add_u32 s10, s10, 77312
v_add_u32 v131, s10, v131
s_cmp_eq_u32 s45, 1
s_cbranch_scc1 L_wn1_5
s_waitcnt lgkmcnt(0)
ds_read_b128 v[140:143], v129 offset:64
ds_read_b128 v[144:147], v129 offset:960
v_pk_fma_f32 v[148:149], v[8:9], v[132:133], v[136:137] op_sel:[1,0,0] op_sel_hi:[1,1,1]
v_pk_fma_f32 v[150:151], v[8:9], v[134:135], v[138:139] op_sel:[1,0,0] op_sel_hi:[1,1,1]
v_pk_fma_f32 v[2:3], v[10:11], v[132:133], v[136:137] op_sel:[1,0,0] op_sel_hi:[1,1,1]
v_pk_fma_f32 v[4:5], v[10:11], v[134:135], v[138:139] op_sel:[1,0,0] op_sel_hi:[1,1,1]
v_pk_fma_f32 v[16:17], v[8:9], v[16:17], v[148:149] op_sel:[0,0,0] op_sel_hi:[0,1,1]
v_pk_fma_f32 v[18:19], v[8:9], v[18:19], v[150:151] op_sel:[0,0,0] op_sel_hi:[0,1,1]
v_pk_fma_f32 v[20:21], v[10:11], v[20:21], v[2:3] op_sel:[0,0,0] op_sel_hi:[0,1,1]
v_pk_fma_f32 v[22:23], v[10:11], v[22:23], v[4:5] op_sel:[0,0,0] op_sel_hi:[0,1,1]
v_pk_mul_f32 v[148:149], v[16:17], v[16:17]
v_pk_mul_f32 v[150:151], v[18:19], v[18:19]
v_pk_mul_f32 v[2:3], v[20:21], v[20:21]
v_pk_mul_f32 v[4:5], v[22:23], v[22:23]
v_pk_fma_f32 v[148:149], v[148:149], s[48:49], v[156:157]
v_pk_fma_f32 v[150:151], v[150:151], s[48:49], v[156:157]
v_pk_fma_f32 v[2:3], v[2:3], s[48:49], v[156:157]
v_pk_fma_f32 v[4:5], v[4:5], s[48:49], v[156:157]
v_pk_mul_f32 v[148:149], v[148:149], v[16:17]
v_pk_mul_f32 v[150:151], v[150:151], v[18:19]
v_pk_mul_f32 v[2:3], v[2:3], v[20:21]
v_pk_mul_f32 v[4:5], v[4:5], v[22:23]
v_exp_f32 v148, v148
v_exp_f32 v149, v149
v_exp_f32 v150, v150
v_exp_f32 v151, v151
v_exp_f32 v2, v2
v_exp_f32 v3, v3
v_exp_f32 v4, v4
v_exp_f32 v5, v5
v_pk_add_f32 v[148:149], v[148:149], v[128:129] op_sel:[0,0] op_sel_hi:[1,0]
v_pk_add_f32 v[150:151], v[150:151], v[128:129] op_sel:[0,0] op_sel_hi:[1,0]
v_pk_add_f32 v[2:3], v[2:3], v[128:129] op_sel:[0,0] op_sel_hi:[1,0]
v_pk_add_f32 v[4:5], v[4:5], v[128:129] op_sel:[0,0] op_sel_hi:[1,0]
v_rcp_f32 v148, v148
v_rcp_f32 v149, v149
v_rcp_f32 v150, v150
v_rcp_f32 v151, v151
v_rcp_f32 v2, v2
v_rcp_f32 v3, v3
v_rcp_f32 v4, v4
v_rcp_f32 v5, v5
v_pk_mul_f32 v[16:17], v[16:17], v[148:149]
v_pk_mul_f32 v[18:19], v[18:19], v[150:151]
v_pk_mul_f32 v[20:21], v[20:21], v[2:3]
v_pk_mul_f32 v[22:23], v[22:23], v[4:5]
v_cvt_pk_bf16_f32 v16, v16, v17
v_cvt_pk_bf16_f32 v17, v18, v19
v_cvt_pk_bf16_f32 v20, v20, v21
v_cvt_pk_bf16_f32 v21, v22, v23
v_pk_fma_f32 v[148:149], v[12:13], v[132:133], v[136:137] op_sel:[1,0,0] op_sel_hi:[1,1,1]
v_pk_fma_f32 v[150:151], v[12:13], v[134:135], v[138:139] op_sel:[1,0,0] op_sel_hi:[1,1,1]
v_pk_fma_f32 v[2:3], v[14:15], v[132:133], v[136:137] op_sel:[1,0,0] op_sel_hi:[1,1,1]
v_pk_fma_f32 v[4:5], v[14:15], v[134:135], v[138:139] op_sel:[1,0,0] op_sel_hi:[1,1,1]
v_pk_fma_f32 v[24:25], v[12:13], v[24:25], v[148:149] op_sel:[0,0,0] op_sel_hi:[0,1,1]
v_pk_fma_f32 v[26:27], v[12:13], v[26:27], v[150:151] op_sel:[0,0,0] op_sel_hi:[0,1,1]
v_pk_fma_f32 v[28:29], v[14:15], v[28:29], v[2:3] op_sel:[0,0,0] op_sel_hi:[0,1,1]
v_pk_fma_f32 v[30:31], v[14:15], v[30:31], v[4:5] op_sel:[0,0,0] op_sel_hi:[0,1,1]
v_pk_mul_f32 v[148:149], v[24:25], v[24:25]
v_pk_mul_f32 v[150:151], v[26:27], v[26:27]
v_pk_mul_f32 v[2:3], v[28:29], v[28:29]
v_pk_mul_f32 v[4:5], v[30:31], v[30:31]
v_pk_fma_f32 v[148:149], v[148:149], s[48:49], v[156:157]
v_pk_fma_f32 v[150:151], v[150:151], s[48:49], v[156:157]
v_pk_fma_f32 v[2:3], v[2:3], s[48:49], v[156:157]
v_pk_fma_f32 v[4:5], v[4:5], s[48:49], v[156:157]
v_pk_mul_f32 v[148:149], v[148:149], v[24:25]
v_pk_mul_f32 v[150:151], v[150:151], v[26:27]
v_pk_mul_f32 v[2:3], v[2:3], v[28:29]
v_pk_mul_f32 v[4:5], v[4:5], v[30:31]
v_exp_f32 v148, v148
v_exp_f32 v149, v149
v_exp_f32 v150, v150
v_exp_f32 v151, v151
v_exp_f32 v2, v2
v_exp_f32 v3, v3
v_exp_f32 v4, v4
v_exp_f32 v5, v5
v_pk_add_f32 v[148:149], v[148:149], v[128:129] op_sel:[0,0] op_sel_hi:[1,0]
v_pk_add_f32 v[150:151], v[150:151], v[128:129] op_sel:[0,0] op_sel_hi:[1,0]
v_pk_add_f32 v[2:3], v[2:3], v[128:129] op_sel:[0,0] op_sel_hi:[1,0]
v_pk_add_f32 v[4:5], v[4:5], v[128:129] op_sel:[0,0] op_sel_hi:[1,0]
v_rcp_f32 v148, v148
v_rcp_f32 v149, v149
v_rcp_f32 v150, v150
v_rcp_f32 v151, v151
v_rcp_f32 v2, v2
v_rcp_f32 v3, v3
v_rcp_f32 v4, v4
v_rcp_f32 v5, v5
v_pk_mul_f32 v[24:25], v[24:25], v[148:149]
v_pk_mul_f32 v[26:27], v[26:27], v[150:151]
v_pk_mul_f32 v[28:29], v[28:29], v[2:3]
v_pk_mul_f32 v[30:31], v[30:31], v[4:5]
v_cvt_pk_bf16_f32 v24, v24, v25
v_cvt_pk_bf16_f32 v25, v26, v27
v_cvt_pk_bf16_f32 v28, v28, v29
v_cvt_pk_bf16_f32 v29, v30, v31
s_waitcnt lgkmcnt(0)
ds_read_b128 v[132:135], v129 offset:128
ds_read_b128 v[136:139], v129 offset:1024
v_pk_fma_f32 v[148:149], v[8:9], v[140:141], v[144:145] op_sel:[1,0,0] op_sel_hi:[1,1,1]
v_pk_fma_f32 v[150:151], v[8:9], v[142:143], v[146:147] op_sel:[1,0,0] op_sel_hi:[1,1,1]
v_pk_fma_f32 v[2:3], v[10:11], v[140:141], v[144:145] op_sel:[1,0,0] op_sel_hi:[1,1,1]
v_pk_fma_f32 v[4:5], v[10:11], v[142:143], v[146:147] op_sel:[1,0,0] op_sel_hi:[1,1,1]
v_pk_fma_f32 v[32:33], v[8:9], v[32:33], v[148:149] op_sel:[0,0,0] op_sel_hi:[0,1,1]
v_pk_fma_f32 v[34:35], v[8:9], v[34:35], v[150:151] op_sel:[0,0,0] op_sel_hi:[0,1,1]
v_pk_fma_f32 v[36:37], v[10:11], v[36:37], v[2:3] op_sel:[0,0,0] op_sel_hi:[0,1,1]
v_pk_fma_f32 v[38:39], v[10:11], v[38:39], v[4:5] op_sel:[0,0,0] op_sel_hi:[0,1,1]
v_pk_mul_f32 v[148:149], v[32:33], v[32:33]
v_pk_mul_f32 v[150:151], v[34:35], v[34:35]
v_pk_mul_f32 v[2:3], v[36:37], v[36:37]
v_pk_mul_f32 v[4:5], v[38:39], v[38:39]
v_pk_fma_f32 v[148:149], v[148:149], s[48:49], v[156:157]
v_pk_fma_f32 v[150:151], v[150:151], s[48:49], v[156:157]
v_pk_fma_f32 v[2:3], v[2:3], s[48:49], v[156:157]
v_pk_fma_f32 v[4:5], v[4:5], s[48:49], v[156:157]
v_pk_mul_f32 v[148:149], v[148:149], v[32:33]
v_pk_mul_f32 v[150:151], v[150:151], v[34:35]
v_pk_mul_f32 v[2:3], v[2:3], v[36:37]
v_pk_mul_f32 v[4:5], v[4:5], v[38:39]
v_exp_f32 v148, v148
v_exp_f32 v149, v149
v_exp_f32 v150, v150
v_exp_f32 v151, v151
v_exp_f32 v2, v2
v_exp_f32 v3, v3
v_exp_f32 v4, v4
v_exp_f32 v5, v5
v_pk_add_f32 v[148:149], v[148:149], v[128:129] op_sel:[0,0] op_sel_hi:[1,0]
v_pk_add_f32 v[150:151], v[150:151], v[128:129] op_sel:[0,0] op_sel_hi:[1,0]
v_pk_add_f32 v[2:3], v[2:3], v[128:129] op_sel:[0,0] op_sel_hi:[1,0]
v_pk_add_f32 v[4:5], v[4:5], v[128:129] op_sel:[0,0] op_sel_hi:[1,0]
v_rcp_f32 v148, v148
v_rcp_f32 v149, v149
v_rcp_f32 v150, v150
v_rcp_f32 v151, v151
v_rcp_f32 v2, v2
v_rcp_f32 v3, v3
v_rcp_f32 v4, v4
v_rcp_f32 v5, v5
v_pk_mul_f32 v[32:33], v[32:33], v[148:149]
v_pk_mul_f32 v[34:35], v[34:35], v[150:151]
v_pk_mul_f32 v[36:37], v[36:37], v[2:3]
v_pk_mul_f32 v[38:39], v[38:39], v[4:5]
v_cvt_pk_bf16_f32 v18, v32, v33
v_cvt_pk_bf16_f32 v19, v34, v35
v_cvt_pk_bf16_f32 v22, v36, v37
v_cvt_pk_bf16_f32 v23, v38, v39
s_add_u32 s11, s46, 0
buffer_store_dwordx4 v[16:19], v130, s[24:27], s11 offen sc1
s_add_u32 s11, s46, 114688
buffer_store_dwordx4 v[20:23], v130, s[24:27], s11 offen sc1
v_pk_fma_f32 v[148:149], v[12:13], v[140:141], v[144:145] op_sel:[1,0,0] op_sel_hi:[1,1,1]
v_pk_fma_f32 v[150:151], v[12:13], v[142:143], v[146:147] op_sel:[1,0,0] op_sel_hi:[1,1,1]
v_pk_fma_f32 v[2:3], v[14:15], v[140:141], v[144:145] op_sel:[1,0,0] op_sel_hi:[1,1,1]
v_pk_fma_f32 v[4:5], v[14:15], v[142:143], v[146:147] op_sel:[1,0,0] op_sel_hi:[1,1,1]
v_pk_fma_f32 v[40:41], v[12:13], v[40:41], v[148:149] op_sel:[0,0,0] op_sel_hi:[0,1,1]
v_pk_fma_f32 v[42:43], v[12:13], v[42:43], v[150:151] op_sel:[0,0,0] op_sel_hi:[0,1,1]
v_pk_fma_f32 v[44:45], v[14:15], v[44:45], v[2:3] op_sel:[0,0,0] op_sel_hi:[0,1,1]
v_pk_fma_f32 v[46:47], v[14:15], v[46:47], v[4:5] op_sel:[0,0,0] op_sel_hi:[0,1,1]
v_pk_mul_f32 v[148:149], v[40:41], v[40:41]
v_pk_mul_f32 v[150:151], v[42:43], v[42:43]
v_pk_mul_f32 v[2:3], v[44:45], v[44:45]
v_pk_mul_f32 v[4:5], v[46:47], v[46:47]
v_pk_fma_f32 v[148:149], v[148:149], s[48:49], v[156:157]
v_pk_fma_f32 v[150:151], v[150:151], s[48:49], v[156:157]
v_pk_fma_f32 v[2:3], v[2:3], s[48:49], v[156:157]
v_pk_fma_f32 v[4:5], v[4:5], s[48:49], v[156:157]
v_pk_mul_f32 v[148:149], v[148:149], v[40:41]
v_pk_mul_f32 v[150:151], v[150:151], v[42:43]
v_pk_mul_f32 v[2:3], v[2:3], v[44:45]
v_pk_mul_f32 v[4:5], v[4:5], v[46:47]
v_exp_f32 v148, v148
v_exp_f32 v149, v149
v_exp_f32 v150, v150
v_exp_f32 v151, v151
v_exp_f32 v2, v2
v_exp_f32 v3, v3
v_exp_f32 v4, v4
v_exp_f32 v5, v5
v_pk_add_f32 v[148:149], v[148:149], v[128:129] op_sel:[0,0] op_sel_hi:[1,0]
v_pk_add_f32 v[150:151], v[150:151], v[128:129] op_sel:[0,0] op_sel_hi:[1,0]
v_pk_add_f32 v[2:3], v[2:3], v[128:129] op_sel:[0,0] op_sel_hi:[1,0]
v_pk_add_f32 v[4:5], v[4:5], v[128:129] op_sel:[0,0] op_sel_hi:[1,0]
v_rcp_f32 v148, v148
v_rcp_f32 v149, v149
v_rcp_f32 v150, v150
v_rcp_f32 v151, v151
v_rcp_f32 v2, v2
v_rcp_f32 v3, v3
v_rcp_f32 v4, v4
v_rcp_f32 v5, v5
v_pk_mul_f32 v[40:41], v[40:41], v[148:149]
v_pk_mul_f32 v[42:43], v[42:43], v[150:151]
v_pk_mul_f32 v[44:45], v[44:45], v[2:3]
v_pk_mul_f32 v[46:47], v[46:47], v[4:5]
v_cvt_pk_bf16_f32 v26, v40, v41
v_cvt_pk_bf16_f32 v27, v42, v43
v_cvt_pk_bf16_f32 v30, v44, v45
v_cvt_pk_bf16_f32 v31, v46, v47
s_add_u32 s11, s46, 229376
buffer_store_dwordx4 v[24:27], v130, s[24:27], s11 offen sc1
s_add_u32 s11, s46, 344064
buffer_store_dwordx4 v[28:31], v130, s[24:27], s11 offen sc1
s_waitcnt lgkmcnt(0)
ds_read_b128 v[140:143], v129 offset:192
ds_read_b128 v[144:147], v129 offset:1088
v_pk_fma_f32 v[148:149], v[8:9], v[132:133], v[136:137] op_sel:[1,0,0] op_sel_hi:[1,1,1]
v_pk_fma_f32 v[150:151], v[8:9], v[134:135], v[138:139] op_sel:[1,0,0] op_sel_hi:[1,1,1]
v_pk_fma_f32 v[2:3], v[10:11], v[132:133], v[136:137] op_sel:[1,0,0] op_sel_hi:[1,1,1]
v_pk_fma_f32 v[4:5], v[10:11], v[134:135], v[138:139] op_sel:[1,0,0] op_sel_hi:[1,1,1]
v_pk_fma_f32 v[48:49], v[8:9], v[48:49], v[148:149] op_sel:[0,0,0] op_sel_hi:[0,1,1]
v_pk_fma_f32 v[50:51], v[8:9], v[50:51], v[150:151] op_sel:[0,0,0] op_sel_hi:[0,1,1]
v_pk_fma_f32 v[52:53], v[10:11], v[52:53], v[2:3] op_sel:[0,0,0] op_sel_hi:[0,1,1]
v_pk_fma_f32 v[54:55], v[10:11], v[54:55], v[4:5] op_sel:[0,0,0] op_sel_hi:[0,1,1]
v_pk_mul_f32 v[148:149], v[48:49], v[48:49]
v_pk_mul_f32 v[150:151], v[50:51], v[50:51]
v_pk_mul_f32 v[2:3], v[52:53], v[52:53]
v_pk_mul_f32 v[4:5], v[54:55], v[54:55]
v_pk_fma_f32 v[148:149], v[148:149], s[48:49], v[156:157]
v_pk_fma_f32 v[150:151], v[150:151], s[48:49], v[156:157]
v_pk_fma_f32 v[2:3], v[2:3], s[48:49], v[156:157]
v_pk_fma_f32 v[4:5], v[4:5], s[48:49], v[156:157]
v_pk_mul_f32 v[148:149], v[148:149], v[48:49]
v_pk_mul_f32 v[150:151], v[150:151], v[50:51]
v_pk_mul_f32 v[2:3], v[2:3], v[52:53]
v_pk_mul_f32 v[4:5], v[4:5], v[54:55]
v_exp_f32 v148, v148
v_exp_f32 v149, v149
v_exp_f32 v150, v150
v_exp_f32 v151, v151
v_exp_f32 v2, v2
v_exp_f32 v3, v3
v_exp_f32 v4, v4
v_exp_f32 v5, v5
v_pk_add_f32 v[148:149], v[148:149], v[128:129] op_sel:[0,0] op_sel_hi:[1,0]
v_pk_add_f32 v[150:151], v[150:151], v[128:129] op_sel:[0,0] op_sel_hi:[1,0]
v_pk_add_f32 v[2:3], v[2:3], v[128:129] op_sel:[0,0] op_sel_hi:[1,0]
v_pk_add_f32 v[4:5], v[4:5], v[128:129] op_sel:[0,0] op_sel_hi:[1,0]
v_rcp_f32 v148, v148
v_rcp_f32 v149, v149
v_rcp_f32 v150, v150
v_rcp_f32 v151, v151
v_rcp_f32 v2, v2
v_rcp_f32 v3, v3
v_rcp_f32 v4, v4
v_rcp_f32 v5, v5
v_pk_mul_f32 v[48:49], v[48:49], v[148:149]
v_pk_mul_f32 v[50:51], v[50:51], v[150:151]
v_pk_mul_f32 v[52:53], v[52:53], v[2:3]
v_pk_mul_f32 v[54:55], v[54:55], v[4:5]
v_cvt_pk_bf16_f32 v48, v48, v49
v_cvt_pk_bf16_f32 v49, v50, v51
v_cvt_pk_bf16_f32 v52, v52, v53
v_cvt_pk_bf16_f32 v53, v54, v55
v_pk_fma_f32 v[148:149], v[12:13], v[132:133], v[136:137] op_sel:[1,0,0] op_sel_hi:[1,1,1]
v_pk_fma_f32 v[150:151], v[12:13], v[134:135], v[138:139] op_sel:[1,0,0] op_sel_hi:[1,1,1]
v_pk_fma_f32 v[2:3], v[14:15], v[132:133], v[136:137] op_sel:[1,0,0] op_sel_hi:[1,1,1]
v_pk_fma_f32 v[4:5], v[14:15], v[134:135], v[138:139] op_sel:[1,0,0] op_sel_hi:[1,1,1]
v_pk_fma_f32 v[56:57], v[12:13], v[56:57], v[148:149] op_sel:[0,0,0] op_sel_hi:[0,1,1]
v_pk_fma_f32 v[58:59], v[12:13], v[58:59], v[150:151] op_sel:[0,0,0] op_sel_hi:[0,1,1]
v_pk_fma_f32 v[60:61], v[14:15], v[60:61], v[2:3] op_sel:[0,0,0] op_sel_hi:[0,1,1]
v_pk_fma_f32 v[62:63], v[14:15], v[62:63], v[4:5] op_sel:[0,0,0] op_sel_hi:[0,1,1]
v_pk_mul_f32 v[148:149], v[56:57], v[56:57]
v_pk_mul_f32 v[150:151], v[58:59], v[58:59]
v_pk_mul_f32 v[2:3], v[60:61], v[60:61]
v_pk_mul_f32 v[4:5], v[62:63], v[62:63]
v_pk_fma_f32 v[148:149], v[148:149], s[48:49], v[156:157]
v_pk_fma_f32 v[150:151], v[150:151], s[48:49], v[156:157]
v_pk_fma_f32 v[2:3], v[2:3], s[48:49], v[156:157]
v_pk_fma_f32 v[4:5], v[4:5], s[48:49], v[156:157]
v_pk_mul_f32 v[148:149], v[148:149], v[56:57]
v_pk_mul_f32 v[150:151], v[150:151], v[58:59]
v_pk_mul_f32 v[2:3], v[2:3], v[60:61]
v_pk_mul_f32 v[4:5], v[4:5], v[62:63]
v_exp_f32 v148, v148
v_exp_f32 v149, v149
v_exp_f32 v150, v150
v_exp_f32 v151, v151
v_exp_f32 v2, v2
v_exp_f32 v3, v3
v_exp_f32 v4, v4
v_exp_f32 v5, v5
v_pk_add_f32 v[148:149], v[148:149], v[128:129] op_sel:[0,0] op_sel_hi:[1,0]
v_pk_add_f32 v[150:151], v[150:151], v[128:129] op_sel:[0,0] op_sel_hi:[1,0]
v_pk_add_f32 v[2:3], v[2:3], v[128:129] op_sel:[0,0] op_sel_hi:[1,0]
v_pk_add_f32 v[4:5], v[4:5], v[128:129] op_sel:[0,0] op_sel_hi:[1,0]
v_rcp_f32 v148, v148
v_rcp_f32 v149, v149
v_rcp_f32 v150, v150
v_rcp_f32 v151, v151
v_rcp_f32 v2, v2
v_rcp_f32 v3, v3
v_rcp_f32 v4, v4
v_rcp_f32 v5, v5
v_pk_mul_f32 v[56:57], v[56:57], v[148:149]
v_pk_mul_f32 v[58:59], v[58:59], v[150:151]
v_pk_mul_f32 v[60:61], v[60:61], v[2:3]
v_pk_mul_f32 v[62:63], v[62:63], v[4:5]
v_cvt_pk_bf16_f32 v56, v56, v57
v_cvt_pk_bf16_f32 v57, v58, v59
v_cvt_pk_bf16_f32 v60, v60, v61
v_cvt_pk_bf16_f32 v61, v62, v63
s_waitcnt lgkmcnt(0)
ds_read_b128 v[132:135], v129 offset:256
ds_read_b128 v[136:139], v129 offset:1152
v_pk_fma_f32 v[148:149], v[8:9], v[140:141], v[144:145] op_sel:[1,0,0] op_sel_hi:[1,1,1]
v_pk_fma_f32 v[150:151], v[8:9], v[142:143], v[146:147] op_sel:[1,0,0] op_sel_hi:[1,1,1]
v_pk_fma_f32 v[2:3], v[10:11], v[140:141], v[144:145] op_sel:[1,0,0] op_sel_hi:[1,1,1]
v_pk_fma_f32 v[4:5], v[10:11], v[142:143], v[146:147] op_sel:[1,0,0] op_sel_hi:[1,1,1]
v_pk_fma_f32 v[64:65], v[8:9], v[64:65], v[148:149] op_sel:[0,0,0] op_sel_hi:[0,1,1]
v_pk_fma_f32 v[66:67], v[8:9], v[66:67], v[150:151] op_sel:[0,0,0] op_sel_hi:[0,1,1]
v_pk_fma_f32 v[68:69], v[10:11], v[68:69], v[2:3] op_sel:[0,0,0] op_sel_hi:[0,1,1]
v_pk_fma_f32 v[70:71], v[10:11], v[70:71], v[4:5] op_sel:[0,0,0] op_sel_hi:[0,1,1]
v_pk_mul_f32 v[148:149], v[64:65], v[64:65]
v_pk_mul_f32 v[150:151], v[66:67], v[66:67]
v_pk_mul_f32 v[2:3], v[68:69], v[68:69]
v_pk_mul_f32 v[4:5], v[70:71], v[70:71]
v_pk_fma_f32 v[148:149], v[148:149], s[48:49], v[156:157]
v_pk_fma_f32 v[150:151], v[150:151], s[48:49], v[156:157]
v_pk_fma_f32 v[2:3], v[2:3], s[48:49], v[156:157]
v_pk_fma_f32 v[4:5], v[4:5], s[48:49], v[156:157]
v_pk_mul_f32 v[148:149], v[148:149], v[64:65]
v_pk_mul_f32 v[150:151], v[150:151], v[66:67]
v_pk_mul_f32 v[2:3], v[2:3], v[68:69]
v_pk_mul_f32 v[4:5], v[4:5], v[70:71]
v_exp_f32 v148, v148
v_exp_f32 v149, v149
v_exp_f32 v150, v150
v_exp_f32 v151, v151
v_exp_f32 v2, v2
v_exp_f32 v3, v3
v_exp_f32 v4, v4
v_exp_f32 v5, v5
v_pk_add_f32 v[148:149], v[148:149], v[128:129] op_sel:[0,0] op_sel_hi:[1,0]
v_pk_add_f32 v[150:151], v[150:151], v[128:129] op_sel:[0,0] op_sel_hi:[1,0]
v_pk_add_f32 v[2:3], v[2:3], v[128:129] op_sel:[0,0] op_sel_hi:[1,0]
v_pk_add_f32 v[4:5], v[4:5], v[128:129] op_sel:[0,0] op_sel_hi:[1,0]
v_rcp_f32 v148, v148
v_rcp_f32 v149, v149
v_rcp_f32 v150, v150
v_rcp_f32 v151, v151
v_rcp_f32 v2, v2
v_rcp_f32 v3, v3
v_rcp_f32 v4, v4
v_rcp_f32 v5, v5
v_pk_mul_f32 v[64:65], v[64:65], v[148:149]
v_pk_mul_f32 v[66:67], v[66:67], v[150:151]
v_pk_mul_f32 v[68:69], v[68:69], v[2:3]
v_pk_mul_f32 v[70:71], v[70:71], v[4:5]
v_cvt_pk_bf16_f32 v50, v64, v65
v_cvt_pk_bf16_f32 v51, v66, v67
v_cvt_pk_bf16_f32 v54, v68, v69
v_cvt_pk_bf16_f32 v55, v70, v71
s_add_u32 s11, s46, 1024
buffer_store_dwordx4 v[48:51], v130, s[24:27], s11 offen sc1
s_add_u32 s11, s46, 115712
buffer_store_dwordx4 v[52:55], v130, s[24:27], s11 offen sc1
v_pk_fma_f32 v[148:149], v[12:13], v[140:141], v[144:145] op_sel:[1,0,0] op_sel_hi:[1,1,1]
v_pk_fma_f32 v[150:151], v[12:13], v[142:143], v[146:147] op_sel:[1,0,0] op_sel_hi:[1,1,1]
v_pk_fma_f32 v[2:3], v[14:15], v[140:141], v[144:145] op_sel:[1,0,0] op_sel_hi:[1,1,1]
v_pk_fma_f32 v[4:5], v[14:15], v[142:143], v[146:147] op_sel:[1,0,0] op_sel_hi:[1,1,1]
v_pk_fma_f32 v[72:73], v[12:13], v[72:73], v[148:149] op_sel:[0,0,0] op_sel_hi:[0,1,1]
v_pk_fma_f32 v[74:75], v[12:13], v[74:75], v[150:151] op_sel:[0,0,0] op_sel_hi:[0,1,1]
v_pk_fma_f32 v[76:77], v[14:15], v[76:77], v[2:3] op_sel:[0,0,0] op_sel_hi:[0,1,1]
v_pk_fma_f32 v[78:79], v[14:15], v[78:79], v[4:5] op_sel:[0,0,0] op_sel_hi:[0,1,1]
v_pk_mul_f32 v[148:149], v[72:73], v[72:73]
v_pk_mul_f32 v[150:151], v[74:75], v[74:75]
v_pk_mul_f32 v[2:3], v[76:77], v[76:77]
v_pk_mul_f32 v[4:5], v[78:79], v[78:79]
v_pk_fma_f32 v[148:149], v[148:149], s[48:49], v[156:157]
v_pk_fma_f32 v[150:151], v[150:151], s[48:49], v[156:157]
v_pk_fma_f32 v[2:3], v[2:3], s[48:49], v[156:157]
v_pk_fma_f32 v[4:5], v[4:5], s[48:49], v[156:157]
v_pk_mul_f32 v[148:149], v[148:149], v[72:73]
v_pk_mul_f32 v[150:151], v[150:151], v[74:75]
v_pk_mul_f32 v[2:3], v[2:3], v[76:77]
v_pk_mul_f32 v[4:5], v[4:5], v[78:79]
v_exp_f32 v148, v148
v_exp_f32 v149, v149
v_exp_f32 v150, v150
v_exp_f32 v151, v151
v_exp_f32 v2, v2
v_exp_f32 v3, v3
v_exp_f32 v4, v4
v_exp_f32 v5, v5
v_pk_add_f32 v[148:149], v[148:149], v[128:129] op_sel:[0,0] op_sel_hi:[1,0]
v_pk_add_f32 v[150:151], v[150:151], v[128:129] op_sel:[0,0] op_sel_hi:[1,0]
v_pk_add_f32 v[2:3], v[2:3], v[128:129] op_sel:[0,0] op_sel_hi:[1,0]
v_pk_add_f32 v[4:5], v[4:5], v[128:129] op_sel:[0,0] op_sel_hi:[1,0]
v_rcp_f32 v148, v148
v_rcp_f32 v149, v149
v_rcp_f32 v150, v150
v_rcp_f32 v151, v151
v_rcp_f32 v2, v2
v_rcp_f32 v3, v3
v_rcp_f32 v4, v4
v_rcp_f32 v5, v5
v_pk_mul_f32 v[72:73], v[72:73], v[148:149]
v_pk_mul_f32 v[74:75], v[74:75], v[150:151]
v_pk_mul_f32 v[76:77], v[76:77], v[2:3]
v_pk_mul_f32 v[78:79], v[78:79], v[4:5]
v_cvt_pk_bf16_f32 v58, v72, v73
v_cvt_pk_bf16_f32 v59, v74, v75
v_cvt_pk_bf16_f32 v62, v76, v77
v_cvt_pk_bf16_f32 v63, v78, v79
s_add_u32 s11, s46, 230400
buffer_store_dwordx4 v[56:59], v130, s[24:27], s11 offen sc1
s_add_u32 s11, s46, 345088
buffer_store_dwordx4 v[60:63], v130, s[24:27], s11 offen sc1
s_waitcnt lgkmcnt(0)
s_barrier
s_waitcnt lgkmcnt(0)
ds_read_b128 v[140:143], v129 offset:320
ds_read_b128 v[144:147], v129 offset:1216
v_pk_fma_f32 v[148:149], v[8:9], v[132:133], v[136:137] op_sel:[1,0,0] op_sel_hi:[1,1,1]
v_pk_fma_f32 v[150:151], v[8:9], v[134:135], v[138:139] op_sel:[1,0,0] op_sel_hi:[1,1,1]
v_pk_fma_f32 v[2:3], v[10:11], v[132:133], v[136:137] op_sel:[1,0,0] op_sel_hi:[1,1,1]
v_pk_fma_f32 v[4:5], v[10:11], v[134:135], v[138:139] op_sel:[1,0,0] op_sel_hi:[1,1,1]
v_pk_fma_f32 v[80:81], v[8:9], v[80:81], v[148:149] op_sel:[0,0,0] op_sel_hi:[0,1,1]
v_pk_fma_f32 v[82:83], v[8:9], v[82:83], v[150:151] op_sel:[0,0,0] op_sel_hi:[0,1,1]
v_pk_fma_f32 v[84:85], v[10:11], v[84:85], v[2:3] op_sel:[0,0,0] op_sel_hi:[0,1,1]
v_pk_fma_f32 v[86:87], v[10:11], v[86:87], v[4:5] op_sel:[0,0,0] op_sel_hi:[0,1,1]
v_pk_mul_f32 v[148:149], v[80:81], v[80:81]
v_pk_mul_f32 v[150:151], v[82:83], v[82:83]
v_pk_mul_f32 v[2:3], v[84:85], v[84:85]
v_pk_mul_f32 v[4:5], v[86:87], v[86:87]
v_pk_fma_f32 v[148:149], v[148:149], s[48:49], v[156:157]
v_pk_fma_f32 v[150:151], v[150:151], s[48:49], v[156:157]
v_pk_fma_f32 v[2:3], v[2:3], s[48:49], v[156:157]
v_pk_fma_f32 v[4:5], v[4:5], s[48:49], v[156:157]
v_pk_mul_f32 v[148:149], v[148:149], v[80:81]
v_pk_mul_f32 v[150:151], v[150:151], v[82:83]
v_pk_mul_f32 v[2:3], v[2:3], v[84:85]
v_pk_mul_f32 v[4:5], v[4:5], v[86:87]
v_exp_f32 v148, v148
v_exp_f32 v149, v149
v_exp_f32 v150, v150
v_exp_f32 v151, v151
v_exp_f32 v2, v2
v_exp_f32 v3, v3
v_exp_f32 v4, v4
v_exp_f32 v5, v5
v_pk_add_f32 v[148:149], v[148:149], v[128:129] op_sel:[0,0] op_sel_hi:[1,0]
v_pk_add_f32 v[150:151], v[150:151], v[128:129] op_sel:[0,0] op_sel_hi:[1,0]
v_pk_add_f32 v[2:3], v[2:3], v[128:129] op_sel:[0,0] op_sel_hi:[1,0]
v_pk_add_f32 v[4:5], v[4:5], v[128:129] op_sel:[0,0] op_sel_hi:[1,0]
v_rcp_f32 v148, v148
v_rcp_f32 v149, v149
v_rcp_f32 v150, v150
v_rcp_f32 v151, v151
v_rcp_f32 v2, v2
v_rcp_f32 v3, v3
v_rcp_f32 v4, v4
v_rcp_f32 v5, v5
v_pk_mul_f32 v[80:81], v[80:81], v[148:149]
v_pk_mul_f32 v[82:83], v[82:83], v[150:151]
v_pk_mul_f32 v[84:85], v[84:85], v[2:3]
v_pk_mul_f32 v[86:87], v[86:87], v[4:5]
v_cvt_pk_bf16_f32 v80, v80, v81
v_cvt_pk_bf16_f32 v81, v82, v83
v_cvt_pk_bf16_f32 v84, v84, v85
v_cvt_pk_bf16_f32 v85, v86, v87
v_pk_fma_f32 v[148:149], v[12:13], v[132:133], v[136:137] op_sel:[1,0,0] op_sel_hi:[1,1,1]
v_pk_fma_f32 v[150:151], v[12:13], v[134:135], v[138:139] op_sel:[1,0,0] op_sel_hi:[1,1,1]
v_pk_fma_f32 v[2:3], v[14:15], v[132:133], v[136:137] op_sel:[1,0,0] op_sel_hi:[1,1,1]
v_pk_fma_f32 v[4:5], v[14:15], v[134:135], v[138:139] op_sel:[1,0,0] op_sel_hi:[1,1,1]
v_pk_fma_f32 v[88:89], v[12:13], v[88:89], v[148:149] op_sel:[0,0,0] op_sel_hi:[0,1,1]
v_pk_fma_f32 v[90:91], v[12:13], v[90:91], v[150:151] op_sel:[0,0,0] op_sel_hi:[0,1,1]
v_pk_fma_f32 v[92:93], v[14:15], v[92:93], v[2:3] op_sel:[0,0,0] op_sel_hi:[0,1,1]
v_pk_fma_f32 v[94:95], v[14:15], v[94:95], v[4:5] op_sel:[0,0,0] op_sel_hi:[0,1,1]
v_pk_mul_f32 v[148:149], v[88:89], v[88:89]
v_pk_mul_f32 v[150:151], v[90:91], v[90:91]
v_pk_mul_f32 v[2:3], v[92:93], v[92:93]
v_pk_mul_f32 v[4:5], v[94:95], v[94:95]
v_pk_fma_f32 v[148:149], v[148:149], s[48:49], v[156:157]
v_pk_fma_f32 v[150:151], v[150:151], s[48:49], v[156:157]
v_pk_fma_f32 v[2:3], v[2:3], s[48:49], v[156:157]
v_pk_fma_f32 v[4:5], v[4:5], s[48:49], v[156:157]
v_pk_mul_f32 v[148:149], v[148:149], v[88:89]
v_pk_mul_f32 v[150:151], v[150:151], v[90:91]
v_pk_mul_f32 v[2:3], v[2:3], v[92:93]
v_pk_mul_f32 v[4:5], v[4:5], v[94:95]
v_exp_f32 v148, v148
v_exp_f32 v149, v149
v_exp_f32 v150, v150
v_exp_f32 v151, v151
v_exp_f32 v2, v2
v_exp_f32 v3, v3
v_exp_f32 v4, v4
v_exp_f32 v5, v5
v_pk_add_f32 v[148:149], v[148:149], v[128:129] op_sel:[0,0] op_sel_hi:[1,0]
v_pk_add_f32 v[150:151], v[150:151], v[128:129] op_sel:[0,0] op_sel_hi:[1,0]
v_pk_add_f32 v[2:3], v[2:3], v[128:129] op_sel:[0,0] op_sel_hi:[1,0]
v_pk_add_f32 v[4:5], v[4:5], v[128:129] op_sel:[0,0] op_sel_hi:[1,0]
v_rcp_f32 v148, v148
v_rcp_f32 v149, v149
v_rcp_f32 v150, v150
v_rcp_f32 v151, v151
v_rcp_f32 v2, v2
v_rcp_f32 v3, v3
v_rcp_f32 v4, v4
v_rcp_f32 v5, v5
v_pk_mul_f32 v[88:89], v[88:89], v[148:149]
v_pk_mul_f32 v[90:91], v[90:91], v[150:151]
v_pk_mul_f32 v[92:93], v[92:93], v[2:3]
v_pk_mul_f32 v[94:95], v[94:95], v[4:5]
v_cvt_pk_bf16_f32 v88, v88, v89
v_cvt_pk_bf16_f32 v89, v90, v91
v_cvt_pk_bf16_f32 v92, v92, v93
v_cvt_pk_bf16_f32 v93, v94, v95
s_waitcnt lgkmcnt(0)
ds_read_b128 v[132:135], v129 offset:384
ds_read_b128 v[136:139], v129 offset:1280
v_pk_fma_f32 v[148:149], v[8:9], v[140:141], v[144:145] op_sel:[1,0,0] op_sel_hi:[1,1,1]
v_pk_fma_f32 v[150:151], v[8:9], v[142:143], v[146:147] op_sel:[1,0,0] op_sel_hi:[1,1,1]
v_pk_fma_f32 v[2:3], v[10:11], v[140:141], v[144:145] op_sel:[1,0,0] op_sel_hi:[1,1,1]
v_pk_fma_f32 v[4:5], v[10:11], v[142:143], v[146:147] op_sel:[1,0,0] op_sel_hi:[1,1,1]
v_pk_fma_f32 v[96:97], v[8:9], v[96:97], v[148:149] op_sel:[0,0,0] op_sel_hi:[0,1,1]
v_pk_fma_f32 v[98:99], v[8:9], v[98:99], v[150:151] op_sel:[0,0,0] op_sel_hi:[0,1,1]
v_pk_fma_f32 v[100:101], v[10:11], v[100:101], v[2:3] op_sel:[0,0,0] op_sel_hi:[0,1,1]
v_pk_fma_f32 v[102:103], v[10:11], v[102:103], v[4:5] op_sel:[0,0,0] op_sel_hi:[0,1,1]
v_pk_mul_f32 v[148:149], v[96:97], v[96:97]
v_pk_mul_f32 v[150:151], v[98:99], v[98:99]
v_pk_mul_f32 v[2:3], v[100:101], v[100:101]
v_pk_mul_f32 v[4:5], v[102:103], v[102:103]
v_pk_fma_f32 v[148:149], v[148:149], s[48:49], v[156:157]
v_pk_fma_f32 v[150:151], v[150:151], s[48:49], v[156:157]
v_pk_fma_f32 v[2:3], v[2:3], s[48:49], v[156:157]
v_pk_fma_f32 v[4:5], v[4:5], s[48:49], v[156:157]
v_pk_mul_f32 v[148:149], v[148:149], v[96:97]
v_pk_mul_f32 v[150:151], v[150:151], v[98:99]
v_pk_mul_f32 v[2:3], v[2:3], v[100:101]
v_pk_mul_f32 v[4:5], v[4:5], v[102:103]
v_exp_f32 v148, v148
v_exp_f32 v149, v149
v_exp_f32 v150, v150
v_exp_f32 v151, v151
v_exp_f32 v2, v2
v_exp_f32 v3, v3
v_exp_f32 v4, v4
v_exp_f32 v5, v5
v_pk_add_f32 v[148:149], v[148:149], v[128:129] op_sel:[0,0] op_sel_hi:[1,0]
v_pk_add_f32 v[150:151], v[150:151], v[128:129] op_sel:[0,0] op_sel_hi:[1,0]
v_pk_add_f32 v[2:3], v[2:3], v[128:129] op_sel:[0,0] op_sel_hi:[1,0]
v_pk_add_f32 v[4:5], v[4:5], v[128:129] op_sel:[0,0] op_sel_hi:[1,0]
v_rcp_f32 v148, v148
v_rcp_f32 v149, v149
v_rcp_f32 v150, v150
v_rcp_f32 v151, v151
v_rcp_f32 v2, v2
v_rcp_f32 v3, v3
v_rcp_f32 v4, v4
v_rcp_f32 v5, v5
v_pk_mul_f32 v[96:97], v[96:97], v[148:149]
v_pk_mul_f32 v[98:99], v[98:99], v[150:151]
v_pk_mul_f32 v[100:101], v[100:101], v[2:3]
v_pk_mul_f32 v[102:103], v[102:103], v[4:5]
v_cvt_pk_bf16_f32 v82, v96, v97
v_cvt_pk_bf16_f32 v83, v98, v99
v_cvt_pk_bf16_f32 v86, v100, v101
v_cvt_pk_bf16_f32 v87, v102, v103
s_add_u32 s11, s46, 2048
buffer_store_dwordx4 v[80:83], v130, s[24:27], s11 offen sc1
s_add_u32 s11, s46, 116736
buffer_store_dwordx4 v[84:87], v130, s[24:27], s11 offen sc1
v_pk_fma_f32 v[148:149], v[12:13], v[140:141], v[144:145] op_sel:[1,0,0] op_sel_hi:[1,1,1]
v_pk_fma_f32 v[150:151], v[12:13], v[142:143], v[146:147] op_sel:[1,0,0] op_sel_hi:[1,1,1]
v_pk_fma_f32 v[2:3], v[14:15], v[140:141], v[144:145] op_sel:[1,0,0] op_sel_hi:[1,1,1]
v_pk_fma_f32 v[4:5], v[14:15], v[142:143], v[146:147] op_sel:[1,0,0] op_sel_hi:[1,1,1]
v_pk_fma_f32 v[104:105], v[12:13], v[104:105], v[148:149] op_sel:[0,0,0] op_sel_hi:[0,1,1]
v_pk_fma_f32 v[106:107], v[12:13], v[106:107], v[150:151] op_sel:[0,0,0] op_sel_hi:[0,1,1]
v_pk_fma_f32 v[108:109], v[14:15], v[108:109], v[2:3] op_sel:[0,0,0] op_sel_hi:[0,1,1]
v_pk_fma_f32 v[110:111], v[14:15], v[110:111], v[4:5] op_sel:[0,0,0] op_sel_hi:[0,1,1]
v_pk_mul_f32 v[148:149], v[104:105], v[104:105]
v_pk_mul_f32 v[150:151], v[106:107], v[106:107]
v_pk_mul_f32 v[2:3], v[108:109], v[108:109]
v_pk_mul_f32 v[4:5], v[110:111], v[110:111]
v_pk_fma_f32 v[148:149], v[148:149], s[48:49], v[156:157]
v_pk_fma_f32 v[150:151], v[150:151], s[48:49], v[156:157]
v_pk_fma_f32 v[2:3], v[2:3], s[48:49], v[156:157]
v_pk_fma_f32 v[4:5], v[4:5], s[48:49], v[156:157]
v_pk_mul_f32 v[148:149], v[148:149], v[104:105]
v_pk_mul_f32 v[150:151], v[150:151], v[106:107]
v_pk_mul_f32 v[2:3], v[2:3], v[108:109]
v_pk_mul_f32 v[4:5], v[4:5], v[110:111]
v_exp_f32 v148, v148
v_exp_f32 v149, v149
v_exp_f32 v150, v150
v_exp_f32 v151, v151
v_exp_f32 v2, v2
v_exp_f32 v3, v3
v_exp_f32 v4, v4
v_exp_f32 v5, v5
v_pk_add_f32 v[148:149], v[148:149], v[128:129] op_sel:[0,0] op_sel_hi:[1,0]
v_pk_add_f32 v[150:151], v[150:151], v[128:129] op_sel:[0,0] op_sel_hi:[1,0]
v_pk_add_f32 v[2:3], v[2:3], v[128:129] op_sel:[0,0] op_sel_hi:[1,0]
v_pk_add_f32 v[4:5], v[4:5], v[128:129] op_sel:[0,0] op_sel_hi:[1,0]
v_rcp_f32 v148, v148
v_rcp_f32 v149, v149
v_rcp_f32 v150, v150
v_rcp_f32 v151, v151
v_rcp_f32 v2, v2
v_rcp_f32 v3, v3
v_rcp_f32 v4, v4
v_rcp_f32 v5, v5
v_pk_mul_f32 v[104:105], v[104:105], v[148:149]
v_pk_mul_f32 v[106:107], v[106:107], v[150:151]
v_pk_mul_f32 v[108:109], v[108:109], v[2:3]
v_pk_mul_f32 v[110:111], v[110:111], v[4:5]
v_cvt_pk_bf16_f32 v90, v104, v105
v_cvt_pk_bf16_f32 v91, v106, v107
v_cvt_pk_bf16_f32 v94, v108, v109
v_cvt_pk_bf16_f32 v95, v110, v111
s_add_u32 s11, s46, 231424
buffer_store_dwordx4 v[88:91], v130, s[24:27], s11 offen sc1
s_add_u32 s11, s46, 346112
buffer_store_dwordx4 v[92:95], v130, s[24:27], s11 offen sc1
s_waitcnt lgkmcnt(0)
ds_read_b64 v[142:143], v131 offset:0
ds_read_b64 v[146:147], v131 offset:512
v_pk_fma_f32 v[148:149], v[8:9], v[132:133], v[136:137] op_sel:[1,0,0] op_sel_hi:[1,1,1]
v_pk_fma_f32 v[150:151], v[8:9], v[134:135], v[138:139] op_sel:[1,0,0] op_sel_hi:[1,1,1]
v_pk_fma_f32 v[2:3], v[10:11], v[132:133], v[136:137] op_sel:[1,0,0] op_sel_hi:[1,1,1]
v_pk_fma_f32 v[4:5], v[10:11], v[134:135], v[138:139] op_sel:[1,0,0] op_sel_hi:[1,1,1]
v_pk_fma_f32 v[112:113], v[8:9], v[112:113], v[148:149] op_sel:[0,0,0] op_sel_hi:[0,1,1]
v_pk_fma_f32 v[114:115], v[8:9], v[114:115], v[150:151] op_sel:[0,0,0] op_sel_hi:[0,1,1]
v_pk_fma_f32 v[116:117], v[10:11], v[116:117], v[2:3] op_sel:[0,0,0] op_sel_hi:[0,1,1]
v_pk_fma_f32 v[118:119], v[10:11], v[118:119], v[4:5] op_sel:[0,0,0] op_sel_hi:[0,1,1]
v_pk_mul_f32 v[148:149], v[112:113], v[112:113]
v_pk_mul_f32 v[150:151], v[114:115], v[114:115]
v_pk_mul_f32 v[2:3], v[116:117], v[116:117]
v_pk_mul_f32 v[4:5], v[118:119], v[118:119]
v_pk_fma_f32 v[148:149], v[148:149], s[48:49], v[156:157]
v_pk_fma_f32 v[150:151], v[150:151], s[48:49], v[156:157]
v_pk_fma_f32 v[2:3], v[2:3], s[48:49], v[156:157]
v_pk_fma_f32 v[4:5], v[4:5], s[48:49], v[156:157]
v_pk_mul_f32 v[148:149], v[148:149], v[112:113]
v_pk_mul_f32 v[150:151], v[150:151], v[114:115]
v_pk_mul_f32 v[2:3], v[2:3], v[116:117]
v_pk_mul_f32 v[4:5], v[4:5], v[118:119]
v_exp_f32 v148, v148
v_exp_f32 v149, v149
v_exp_f32 v150, v150
v_exp_f32 v151, v151
v_exp_f32 v2, v2
v_exp_f32 v3, v3
v_exp_f32 v4, v4
v_exp_f32 v5, v5
v_pk_add_f32 v[148:149], v[148:149], v[128:129] op_sel:[0,0] op_sel_hi:[1,0]
v_pk_add_f32 v[150:151], v[150:151], v[128:129] op_sel:[0,0] op_sel_hi:[1,0]
v_pk_add_f32 v[2:3], v[2:3], v[128:129] op_sel:[0,0] op_sel_hi:[1,0]
v_pk_add_f32 v[4:5], v[4:5], v[128:129] op_sel:[0,0] op_sel_hi:[1,0]
v_rcp_f32 v148, v148
v_rcp_f32 v149, v149
v_rcp_f32 v150, v150
v_rcp_f32 v151, v151
v_rcp_f32 v2, v2
v_rcp_f32 v3, v3
v_rcp_f32 v4, v4
v_rcp_f32 v5, v5
v_pk_mul_f32 v[112:113], v[112:113], v[148:149]
v_pk_mul_f32 v[114:115], v[114:115], v[150:151]
v_pk_mul_f32 v[116:117], v[116:117], v[2:3]
v_pk_mul_f32 v[118:119], v[118:119], v[4:5]
v_cvt_pk_bf16_f32 v140, v112, v113
v_cvt_pk_bf16_f32 v141, v114, v115
v_cvt_pk_bf16_f32 v144, v116, v117
v_cvt_pk_bf16_f32 v145, v118, v119
s_waitcnt lgkmcnt(0)
s_add_u32 s11, s46, 3072
buffer_store_dwordx4 v[140:143], v130, s[24:27], s11 offen sc1
s_add_u32 s11, s46, 117760
buffer_store_dwordx4 v[144:147], v130, s[24:27], s11 offen sc1
ds_read_b64 v[142:143], v131 offset:1024
ds_read_b64 v[146:147], v131 offset:1536
v_pk_fma_f32 v[148:149], v[12:13], v[132:133], v[136:137] op_sel:[1,0,0] op_sel_hi:[1,1,1]
v_pk_fma_f32 v[150:151], v[12:13], v[134:135], v[138:139] op_sel:[1,0,0] op_sel_hi:[1,1,1]
v_pk_fma_f32 v[2:3], v[14:15], v[132:133], v[136:137] op_sel:[1,0,0] op_sel_hi:[1,1,1]
v_pk_fma_f32 v[4:5], v[14:15], v[134:135], v[138:139] op_sel:[1,0,0] op_sel_hi:[1,1,1]
v_pk_fma_f32 v[120:121], v[12:13], v[120:121], v[148:149] op_sel:[0,0,0] op_sel_hi:[0,1,1]
v_pk_fma_f32 v[122:123], v[12:13], v[122:123], v[150:151] op_sel:[0,0,0] op_sel_hi:[0,1,1]
v_pk_fma_f32 v[124:125], v[14:15], v[124:125], v[2:3] op_sel:[0,0,0] op_sel_hi:[0,1,1]
v_pk_fma_f32 v[126:127], v[14:15], v[126:127], v[4:5] op_sel:[0,0,0] op_sel_hi:[0,1,1]
v_pk_mul_f32 v[148:149], v[120:121], v[120:121]
v_pk_mul_f32 v[150:151], v[122:123], v[122:123]
v_pk_mul_f32 v[2:3], v[124:125], v[124:125]
v_pk_mul_f32 v[4:5], v[126:127], v[126:127]
v_pk_fma_f32 v[148:149], v[148:149], s[48:49], v[156:157]
v_pk_fma_f32 v[150:151], v[150:151], s[48:49], v[156:157]
v_pk_fma_f32 v[2:3], v[2:3], s[48:49], v[156:157]
v_pk_fma_f32 v[4:5], v[4:5], s[48:49], v[156:157]
v_pk_mul_f32 v[148:149], v[148:149], v[120:121]
v_pk_mul_f32 v[150:151], v[150:151], v[122:123]
v_pk_mul_f32 v[2:3], v[2:3], v[124:125]
v_pk_mul_f32 v[4:5], v[4:5], v[126:127]
v_exp_f32 v148, v148
v_exp_f32 v149, v149
v_exp_f32 v150, v150
v_exp_f32 v151, v151
v_exp_f32 v2, v2
v_exp_f32 v3, v3
v_exp_f32 v4, v4
v_exp_f32 v5, v5
v_pk_add_f32 v[148:149], v[148:149], v[128:129] op_sel:[0,0] op_sel_hi:[1,0]
v_pk_add_f32 v[150:151], v[150:151], v[128:129] op_sel:[0,0] op_sel_hi:[1,0]
v_pk_add_f32 v[2:3], v[2:3], v[128:129] op_sel:[0,0] op_sel_hi:[1,0]
v_pk_add_f32 v[4:5], v[4:5], v[128:129] op_sel:[0,0] op_sel_hi:[1,0]
v_rcp_f32 v148, v148
v_rcp_f32 v149, v149
v_rcp_f32 v150, v150
v_rcp_f32 v151, v151
v_rcp_f32 v2, v2
v_rcp_f32 v3, v3
v_rcp_f32 v4, v4
v_rcp_f32 v5, v5
v_pk_mul_f32 v[120:121], v[120:121], v[148:149]
v_pk_mul_f32 v[122:123], v[122:123], v[150:151]
v_pk_mul_f32 v[124:125], v[124:125], v[2:3]
v_pk_mul_f32 v[126:127], v[126:127], v[4:5]
v_cvt_pk_bf16_f32 v140, v120, v121
v_cvt_pk_bf16_f32 v141, v122, v123
v_cvt_pk_bf16_f32 v144, v124, v125
v_cvt_pk_bf16_f32 v145, v126, v127
s_waitcnt lgkmcnt(0)
s_add_u32 s11, s46, 232448
buffer_store_dwordx4 v[140:143], v130, s[24:27], s11 offen sc1
s_add_u32 s11, s46, 347136
buffer_store_dwordx4 v[144:147], v130, s[24:27], s11 offen sc1
s_branch L_wnj_6
L_wn1_5:
s_waitcnt lgkmcnt(0)
ds_read_b128 v[140:143], v129 offset:64
ds_read_b128 v[144:147], v129 offset:960
v_pk_fma_f32 v[148:149], v[8:9], v[132:133], v[136:137] op_sel:[1,0,0] op_sel_hi:[1,1,1]
v_pk_fma_f32 v[150:151], v[8:9], v[134:135], v[138:139] op_sel:[1,0,0] op_sel_hi:[1,1,1]
v_pk_fma_f32 v[2:3], v[10:11], v[132:133], v[136:137] op_sel:[1,0,0] op_sel_hi:[1,1,1]
v_pk_fma_f32 v[4:5], v[10:11], v[134:135], v[138:139] op_sel:[1,0,0] op_sel_hi:[1,1,1]
v_pk_fma_f32 v[16:17], v[8:9], v[16:17], v[148:149] op_sel:[0,0,0] op_sel_hi:[0,1,1]
v_pk_fma_f32 v[18:19], v[8:9], v[18:19], v[150:151] op_sel:[0,0,0] op_sel_hi:[0,1,1]
v_pk_fma_f32 v[20:21], v[10:11], v[20:21], v[2:3] op_sel:[0,0,0] op_sel_hi:[0,1,1]
v_pk_fma_f32 v[22:23], v[10:11], v[22:23], v[4:5] op_sel:[0,0,0] op_sel_hi:[0,1,1]
v_pk_mul_f32 v[148:149], v[16:17], v[16:17]
v_pk_mul_f32 v[150:151], v[18:19], v[18:19]
v_pk_mul_f32 v[2:3], v[20:21], v[20:21]
v_pk_mul_f32 v[4:5], v[22:23], v[22:23]
v_pk_fma_f32 v[148:149], v[148:149], s[48:49], v[156:157]
v_pk_fma_f32 v[150:151], v[150:151], s[48:49], v[156:157]
v_pk_fma_f32 v[2:3], v[2:3], s[48:49], v[156:157]
v_pk_fma_f32 v[4:5], v[4:5], s[48:49], v[156:157]
v_pk_mul_f32 v[148:149], v[148:149], v[16:17]
v_pk_mul_f32 v[150:151], v[150:151], v[18:19]
v_pk_mul_f32 v[2:3], v[2:3], v[20:21]
v_pk_mul_f32 v[4:5], v[4:5], v[22:23]
v_exp_f32 v148, v148
v_exp_f32 v149, v149
v_exp_f32 v150, v150
v_exp_f32 v151, v151
v_exp_f32 v2, v2
v_exp_f32 v3, v3
v_exp_f32 v4, v4
v_exp_f32 v5, v5
v_pk_add_f32 v[148:149], v[148:149], v[128:129] op_sel:[0,0] op_sel_hi:[1,0]
v_pk_add_f32 v[150:151], v[150:151], v[128:129] op_sel:[0,0] op_sel_hi:[1,0]
v_pk_add_f32 v[2:3], v[2:3], v[128:129] op_sel:[0,0] op_sel_hi:[1,0]
v_pk_add_f32 v[4:5], v[4:5], v[128:129] op_sel:[0,0] op_sel_hi:[1,0]
v_rcp_f32 v148, v148
v_rcp_f32 v149, v149
v_rcp_f32 v150, v150
v_rcp_f32 v151, v151
v_rcp_f32 v2, v2
v_rcp_f32 v3, v3
v_rcp_f32 v4, v4
v_rcp_f32 v5, v5
v_pk_mul_f32 v[16:17], v[16:17], v[148:149]
v_pk_mul_f32 v[18:19], v[18:19], v[150:151]
v_pk_mul_f32 v[20:21], v[20:21], v[2:3]
v_pk_mul_f32 v[22:23], v[22:23], v[4:5]
v_cvt_pk_bf16_f32 v152, v16, v17
v_cvt_pk_bf16_f32 v153, v18, v19
v_cvt_pk_bf16_f32 v154, v20, v21
v_cvt_pk_bf16_f32 v155, v22, v23
ds_write_b64 v131, v[152:153] offset:0
ds_write_b64 v131, v[154:155] offset:512
v_pk_fma_f32 v[148:149], v[12:13], v[132:133], v[136:137] op_sel:[1,0,0] op_sel_hi:[1,1,1]
v_pk_fma_f32 v[150:151], v[12:13], v[134:135], v[138:139] op_sel:[1,0,0] op_sel_hi:[1,1,1]
v_pk_fma_f32 v[2:3], v[14:15], v[132:133], v[136:137] op_sel:[1,0,0] op_sel_hi:[1,1,1]
v_pk_fma_f32 v[4:5], v[14:15], v[134:135], v[138:139] op_sel:[1,0,0] op_sel_hi:[1,1,1]
v_pk_fma_f32 v[24:25], v[12:13], v[24:25], v[148:149] op_sel:[0,0,0] op_sel_hi:[0,1,1]
v_pk_fma_f32 v[26:27], v[12:13], v[26:27], v[150:151] op_sel:[0,0,0] op_sel_hi:[0,1,1]
v_pk_fma_f32 v[28:29], v[14:15], v[28:29], v[2:3] op_sel:[0,0,0] op_sel_hi:[0,1,1]
v_pk_fma_f32 v[30:31], v[14:15], v[30:31], v[4:5] op_sel:[0,0,0] op_sel_hi:[0,1,1]
v_pk_mul_f32 v[148:149], v[24:25], v[24:25]
v_pk_mul_f32 v[150:151], v[26:27], v[26:27]
v_pk_mul_f32 v[2:3], v[28:29], v[28:29]
v_pk_mul_f32 v[4:5], v[30:31], v[30:31]
v_pk_fma_f32 v[148:149], v[148:149], s[48:49], v[156:157]
v_pk_fma_f32 v[150:151], v[150:151], s[48:49], v[156:157]
v_pk_fma_f32 v[2:3], v[2:3], s[48:49], v[156:157]
v_pk_fma_f32 v[4:5], v[4:5], s[48:49], v[156:157]
v_pk_mul_f32 v[148:149], v[148:149], v[24:25]
v_pk_mul_f32 v[150:151], v[150:151], v[26:27]
v_pk_mul_f32 v[2:3], v[2:3], v[28:29]
v_pk_mul_f32 v[4:5], v[4:5], v[30:31]
v_exp_f32 v148, v148
v_exp_f32 v149, v149
v_exp_f32 v150, v150
v_exp_f32 v151, v151
v_exp_f32 v2, v2
v_exp_f32 v3, v3
v_exp_f32 v4, v4
v_exp_f32 v5, v5
v_pk_add_f32 v[148:149], v[148:149], v[128:129] op_sel:[0,0] op_sel_hi:[1,0]
v_pk_add_f32 v[150:151], v[150:151], v[128:129] op_sel:[0,0] op_sel_hi:[1,0]
v_pk_add_f32 v[2:3], v[2:3], v[128:129] op_sel:[0,0] op_sel_hi:[1,0]
v_pk_add_f32 v[4:5], v[4:5], v[128:129] op_sel:[0,0] op_sel_hi:[1,0]
v_rcp_f32 v148, v148
v_rcp_f32 v149, v149
v_rcp_f32 v150, v150
v_rcp_f32 v151, v151
v_rcp_f32 v2, v2
v_rcp_f32 v3, v3
v_rcp_f32 v4, v4
v_rcp_f32 v5, v5
v_pk_mul_f32 v[24:25], v[24:25], v[148:149]
v_pk_mul_f32 v[26:27], v[26:27], v[150:151]
v_pk_mul_f32 v[28:29], v[28:29], v[2:3]
v_pk_mul_f32 v[30:31], v[30:31], v[4:5]
v_cvt_pk_bf16_f32 v152, v24, v25
v_cvt_pk_bf16_f32 v153, v26, v27
v_cvt_pk_bf16_f32 v154, v28, v29
v_cvt_pk_bf16_f32 v155, v30, v31
ds_write_b64 v131, v[152:153] offset:1024
ds_write_b64 v131, v[154:155] offset:1536
s_waitcnt lgkmcnt(0)
ds_read_b128 v[132:135], v129 offset:128
ds_read_b128 v[136:139], v129 offset:1024
v_pk_fma_f32 v[148:149], v[8:9], v[140:141], v[144:145] op_sel:[1,0,0] op_sel_hi:[1,1,1]
v_pk_fma_f32 v[150:151], v[8:9], v[142:143], v[146:147] op_sel:[1,0,0] op_sel_hi:[1,1,1]
v_pk_fma_f32 v[2:3], v[10:11], v[140:141], v[144:145] op_sel:[1,0,0] op_sel_hi:[1,1,1]
v_pk_fma_f32 v[4:5], v[10:11], v[142:143], v[146:147] op_sel:[1,0,0] op_sel_hi:[1,1,1]
v_pk_fma_f32 v[32:33], v[8:9], v[32:33], v[148:149] op_sel:[0,0,0] op_sel_hi:[0,1,1]
v_pk_fma_f32 v[34:35], v[8:9], v[34:35], v[150:151] op_sel:[0,0,0] op_sel_hi:[0,1,1]
v_pk_fma_f32 v[36:37], v[10:11], v[36:37], v[2:3] op_sel:[0,0,0] op_sel_hi:[0,1,1]
v_pk_fma_f32 v[38:39], v[10:11], v[38:39], v[4:5] op_sel:[0,0,0] op_sel_hi:[0,1,1]
v_pk_mul_f32 v[148:149], v[32:33], v[32:33]
v_pk_mul_f32 v[150:151], v[34:35], v[34:35]
v_pk_mul_f32 v[2:3], v[36:37], v[36:37]
v_pk_mul_f32 v[4:5], v[38:39], v[38:39]
v_pk_fma_f32 v[148:149], v[148:149], s[48:49], v[156:157]
v_pk_fma_f32 v[150:151], v[150:151], s[48:49], v[156:157]
v_pk_fma_f32 v[2:3], v[2:3], s[48:49], v[156:157]
v_pk_fma_f32 v[4:5], v[4:5], s[48:49], v[156:157]
v_pk_mul_f32 v[148:149], v[148:149], v[32:33]
v_pk_mul_f32 v[150:151], v[150:151], v[34:35]
v_pk_mul_f32 v[2:3], v[2:3], v[36:37]
v_pk_mul_f32 v[4:5], v[4:5], v[38:39]
v_exp_f32 v148, v148
v_exp_f32 v149, v149
v_exp_f32 v150, v150
v_exp_f32 v151, v151
v_exp_f32 v2, v2
v_exp_f32 v3, v3
v_exp_f32 v4, v4
v_exp_f32 v5, v5
v_pk_add_f32 v[148:149], v[148:149], v[128:129] op_sel:[0,0] op_sel_hi:[1,0]
v_pk_add_f32 v[150:151], v[150:151], v[128:129] op_sel:[0,0] op_sel_hi:[1,0]
v_pk_add_f32 v[2:3], v[2:3], v[128:129] op_sel:[0,0] op_sel_hi:[1,0]
v_pk_add_f32 v[4:5], v[4:5], v[128:129] op_sel:[0,0] op_sel_hi:[1,0]
v_rcp_f32 v148, v148
v_rcp_f32 v149, v149
v_rcp_f32 v150, v150
v_rcp_f32 v151, v151
v_rcp_f32 v2, v2
v_rcp_f32 v3, v3
v_rcp_f32 v4, v4
v_rcp_f32 v5, v5
v_pk_mul_f32 v[32:33], v[32:33], v[148:149]
v_pk_mul_f32 v[34:35], v[34:35], v[150:151]
v_pk_mul_f32 v[36:37], v[36:37], v[2:3]
v_pk_mul_f32 v[38:39], v[38:39], v[4:5]
v_cvt_pk_bf16_f32 v32, v32, v33
v_cvt_pk_bf16_f32 v33, v34, v35
v_cvt_pk_bf16_f32 v36, v36, v37
v_cvt_pk_bf16_f32 v37, v38, v39
v_pk_fma_f32 v[148:149], v[12:13], v[140:141], v[144:145] op_sel:[1,0,0] op_sel_hi:[1,1,1]
v_pk_fma_f32 v[150:151], v[12:13], v[142:143], v[146:147] op_sel:[1,0,0] op_sel_hi:[1,1,1]
v_pk_fma_f32 v[2:3], v[14:15], v[140:141], v[144:145] op_sel:[1,0,0] op_sel_hi:[1,1,1]
v_pk_fma_f32 v[4:5], v[14:15], v[142:143], v[146:147] op_sel:[1,0,0] op_sel_hi:[1,1,1]
v_pk_fma_f32 v[40:41], v[12:13], v[40:41], v[148:149] op_sel:[0,0,0] op_sel_hi:[0,1,1]
v_pk_fma_f32 v[42:43], v[12:13], v[42:43], v[150:151] op_sel:[0,0,0] op_sel_hi:[0,1,1]
v_pk_fma_f32 v[44:45], v[14:15], v[44:45], v[2:3] op_sel:[0,0,0] op_sel_hi:[0,1,1]
v_pk_fma_f32 v[46:47], v[14:15], v[46:47], v[4:5] op_sel:[0,0,0] op_sel_hi:[0,1,1]
v_pk_mul_f32 v[148:149], v[40:41], v[40:41]
v_pk_mul_f32 v[150:151], v[42:43], v[42:43]
v_pk_mul_f32 v[2:3], v[44:45], v[44:45]
v_pk_mul_f32 v[4:5], v[46:47], v[46:47]
v_pk_fma_f32 v[148:149], v[148:149], s[48:49], v[156:157]
v_pk_fma_f32 v[150:151], v[150:151], s[48:49], v[156:157]
v_pk_fma_f32 v[2:3], v[2:3], s[48:49], v[156:157]
v_pk_fma_f32 v[4:5], v[4:5], s[48:49], v[156:157]
v_pk_mul_f32 v[148:149], v[148:149], v[40:41]
v_pk_mul_f32 v[150:151], v[150:151], v[42:43]
v_pk_mul_f32 v[2:3], v[2:3], v[44:45]
v_pk_mul_f32 v[4:5], v[4:5], v[46:47]
v_exp_f32 v148, v148
v_exp_f32 v149, v149
v_exp_f32 v150, v150
v_exp_f32 v151, v151
v_exp_f32 v2, v2
v_exp_f32 v3, v3
v_exp_f32 v4, v4
v_exp_f32 v5, v5
v_pk_add_f32 v[148:149], v[148:149], v[128:129] op_sel:[0,0] op_sel_hi:[1,0]
v_pk_add_f32 v[150:151], v[150:151], v[128:129] op_sel:[0,0] op_sel_hi:[1,0]
v_pk_add_f32 v[2:3], v[2:3], v[128:129] op_sel:[0,0] op_sel_hi:[1,0]
v_pk_add_f32 v[4:5], v[4:5], v[128:129] op_sel:[0,0] op_sel_hi:[1,0]
v_rcp_f32 v148, v148
v_rcp_f32 v149, v149
v_rcp_f32 v150, v150
v_rcp_f32 v151, v151
v_rcp_f32 v2, v2
v_rcp_f32 v3, v3
v_rcp_f32 v4, v4
v_rcp_f32 v5, v5
v_pk_mul_f32 v[40:41], v[40:41], v[148:149]
v_pk_mul_f32 v[42:43], v[42:43], v[150:151]
v_pk_mul_f32 v[44:45], v[44:45], v[2:3]
v_pk_mul_f32 v[46:47], v[46:47], v[4:5]
v_cvt_pk_bf16_f32 v40, v40, v41
v_cvt_pk_bf16_f32 v41, v42, v43
v_cvt_pk_bf16_f32 v44, v44, v45
v_cvt_pk_bf16_f32 v45, v46, v47
s_waitcnt lgkmcnt(0)
ds_read_b128 v[140:143], v129 offset:192
ds_read_b128 v[144:147], v129 offset:1088
v_pk_fma_f32 v[148:149], v[8:9], v[132:133], v[136:137] op_sel:[1,0,0] op_sel_hi:[1,1,1]
v_pk_fma_f32 v[150:151], v[8:9], v[134:135], v[138:139] op_sel:[1,0,0] op_sel_hi:[1,1,1]
v_pk_fma_f32 v[2:3], v[10:11], v[132:133], v[136:137] op_sel:[1,0,0] op_sel_hi:[1,1,1]
v_pk_fma_f32 v[4:5], v[10:11], v[134:135], v[138:139] op_sel:[1,0,0] op_sel_hi:[1,1,1]
v_pk_fma_f32 v[48:49], v[8:9], v[48:49], v[148:149] op_sel:[0,0,0] op_sel_hi:[0,1,1]
v_pk_fma_f32 v[50:51], v[8:9], v[50:51], v[150:151] op_sel:[0,0,0] op_sel_hi:[0,1,1]
v_pk_fma_f32 v[52:53], v[10:11], v[52:53], v[2:3] op_sel:[0,0,0] op_sel_hi:[0,1,1]
v_pk_fma_f32 v[54:55], v[10:11], v[54:55], v[4:5] op_sel:[0,0,0] op_sel_hi:[0,1,1]
v_pk_mul_f32 v[148:149], v[48:49], v[48:49]
v_pk_mul_f32 v[150:151], v[50:51], v[50:51]
v_pk_mul_f32 v[2:3], v[52:53], v[52:53]
v_pk_mul_f32 v[4:5], v[54:55], v[54:55]
v_pk_fma_f32 v[148:149], v[148:149], s[48:49], v[156:157]
v_pk_fma_f32 v[150:151], v[150:151], s[48:49], v[156:157]
v_pk_fma_f32 v[2:3], v[2:3], s[48:49], v[156:157]
v_pk_fma_f32 v[4:5], v[4:5], s[48:49], v[156:157]
v_pk_mul_f32 v[148:149], v[148:149], v[48:49]
v_pk_mul_f32 v[150:151], v[150:151], v[50:51]
v_pk_mul_f32 v[2:3], v[2:3], v[52:53]
v_pk_mul_f32 v[4:5], v[4:5], v[54:55]
v_exp_f32 v148, v148
v_exp_f32 v149, v149
v_exp_f32 v150, v150
v_exp_f32 v151, v151
v_exp_f32 v2, v2
v_exp_f32 v3, v3
v_exp_f32 v4, v4
v_exp_f32 v5, v5
v_pk_add_f32 v[148:149], v[148:149], v[128:129] op_sel:[0,0] op_sel_hi:[1,0]
v_pk_add_f32 v[150:151], v[150:151], v[128:129] op_sel:[0,0] op_sel_hi:[1,0]
v_pk_add_f32 v[2:3], v[2:3], v[128:129] op_sel:[0,0] op_sel_hi:[1,0]
v_pk_add_f32 v[4:5], v[4:5], v[128:129] op_sel:[0,0] op_sel_hi:[1,0]
v_rcp_f32 v148, v148
v_rcp_f32 v149, v149
v_rcp_f32 v150, v150
v_rcp_f32 v151, v151
v_rcp_f32 v2, v2
v_rcp_f32 v3, v3
v_rcp_f32 v4, v4
v_rcp_f32 v5, v5
v_pk_mul_f32 v[48:49], v[48:49], v[148:149]
v_pk_mul_f32 v[50:51], v[50:51], v[150:151]
v_pk_mul_f32 v[52:53], v[52:53], v[2:3]
v_pk_mul_f32 v[54:55], v[54:55], v[4:5]
v_cvt_pk_bf16_f32 v34, v48, v49
v_cvt_pk_bf16_f32 v35, v50, v51
v_cvt_pk_bf16_f32 v38, v52, v53
v_cvt_pk_bf16_f32 v39, v54, v55
s_add_u32 s11, s46, 4096
buffer_store_dwordx4 v[32:35], v130, s[24:27], s11 offen sc1
s_add_u32 s11, s46, 118784
buffer_store_dwordx4 v[36:39], v130, s[24:27], s11 offen sc1
v_pk_fma_f32 v[148:149], v[12:13], v[132:133], v[136:137] op_sel:[1,0,0] op_sel_hi:[1,1,1]
v_pk_fma_f32 v[150:151], v[12:13], v[134:135], v[138:139] op_sel:[1,0,0] op_sel_hi:[1,1,1]
v_pk_fma_f32 v[2:3], v[14:15], v[132:133], v[136:137] op_sel:[1,0,0] op_sel_hi:[1,1,1]
v_pk_fma_f32 v[4:5], v[14:15], v[134:135], v[138:139] op_sel:[1,0,0] op_sel_hi:[1,1,1]
v_pk_fma_f32 v[56:57], v[12:13], v[56:57], v[148:149] op_sel:[0,0,0] op_sel_hi:[0,1,1]
v_pk_fma_f32 v[58:59], v[12:13], v[58:59], v[150:151] op_sel:[0,0,0] op_sel_hi:[0,1,1]
v_pk_fma_f32 v[60:61], v[14:15], v[60:61], v[2:3] op_sel:[0,0,0] op_sel_hi:[0,1,1]
v_pk_fma_f32 v[62:63], v[14:15], v[62:63], v[4:5] op_sel:[0,0,0] op_sel_hi:[0,1,1]
v_pk_mul_f32 v[148:149], v[56:57], v[56:57]
v_pk_mul_f32 v[150:151], v[58:59], v[58:59]
v_pk_mul_f32 v[2:3], v[60:61], v[60:61]
v_pk_mul_f32 v[4:5], v[62:63], v[62:63]
v_pk_fma_f32 v[148:149], v[148:149], s[48:49], v[156:157]
v_pk_fma_f32 v[150:151], v[150:151], s[48:49], v[156:157]
v_pk_fma_f32 v[2:3], v[2:3], s[48:49], v[156:157]
v_pk_fma_f32 v[4:5], v[4:5], s[48:49], v[156:157]
v_pk_mul_f32 v[148:149], v[148:149], v[56:57]
v_pk_mul_f32 v[150:151], v[150:151], v[58:59]
v_pk_mul_f32 v[2:3], v[2:3], v[60:61]
v_pk_mul_f32 v[4:5], v[4:5], v[62:63]
v_exp_f32 v148, v148
v_exp_f32 v149, v149
v_exp_f32 v150, v150
v_exp_f32 v151, v151
v_exp_f32 v2, v2
v_exp_f32 v3, v3
v_exp_f32 v4, v4
v_exp_f32 v5, v5
v_pk_add_f32 v[148:149], v[148:149], v[128:129] op_sel:[0,0] op_sel_hi:[1,0]
v_pk_add_f32 v[150:151], v[150:151], v[128:129] op_sel:[0,0] op_sel_hi:[1,0]
v_pk_add_f32 v[2:3], v[2:3], v[128:129] op_sel:[0,0] op_sel_hi:[1,0]
v_pk_add_f32 v[4:5], v[4:5], v[128:129] op_sel:[0,0] op_sel_hi:[1,0]
v_rcp_f32 v148, v148
v_rcp_f32 v149, v149
v_rcp_f32 v150, v150
v_rcp_f32 v151, v151
v_rcp_f32 v2, v2
v_rcp_f32 v3, v3
v_rcp_f32 v4, v4
v_rcp_f32 v5, v5
v_pk_mul_f32 v[56:57], v[56:57], v[148:149]
v_pk_mul_f32 v[58:59], v[58:59], v[150:151]
v_pk_mul_f32 v[60:61], v[60:61], v[2:3]
v_pk_mul_f32 v[62:63], v[62:63], v[4:5]
v_cvt_pk_bf16_f32 v42, v56, v57
v_cvt_pk_bf16_f32 v43, v58, v59
v_cvt_pk_bf16_f32 v46, v60, v61
v_cvt_pk_bf16_f32 v47, v62, v63
s_add_u32 s11, s46, 233472
buffer_store_dwordx4 v[40:43], v130, s[24:27], s11 offen sc1
s_add_u32 s11, s46, 348160
buffer_store_dwordx4 v[44:47], v130, s[24:27], s11 offen sc1
s_waitcnt lgkmcnt(0)
ds_read_b128 v[132:135], v129 offset:256
ds_read_b128 v[136:139], v129 offset:1152
v_pk_fma_f32 v[148:149], v[8:9], v[140:141], v[144:145] op_sel:[1,0,0] op_sel_hi:[1,1,1]
v_pk_fma_f32 v[150:151], v[8:9], v[142:143], v[146:147] op_sel:[1,0,0] op_sel_hi:[1,1,1]
v_pk_fma_f32 v[2:3], v[10:11], v[140:141], v[144:145] op_sel:[1,0,0] op_sel_hi:[1,1,1]
v_pk_fma_f32 v[4:5], v[10:11], v[142:143], v[146:147] op_sel:[1,0,0] op_sel_hi:[1,1,1]
v_pk_fma_f32 v[64:65], v[8:9], v[64:65], v[148:149] op_sel:[0,0,0] op_sel_hi:[0,1,1]
v_pk_fma_f32 v[66:67], v[8:9], v[66:67], v[150:151] op_sel:[0,0,0] op_sel_hi:[0,1,1]
v_pk_fma_f32 v[68:69], v[10:11], v[68:69], v[2:3] op_sel:[0,0,0] op_sel_hi:[0,1,1]
v_pk_fma_f32 v[70:71], v[10:11], v[70:71], v[4:5] op_sel:[0,0,0] op_sel_hi:[0,1,1]
v_pk_mul_f32 v[148:149], v[64:65], v[64:65]
v_pk_mul_f32 v[150:151], v[66:67], v[66:67]
v_pk_mul_f32 v[2:3], v[68:69], v[68:69]
v_pk_mul_f32 v[4:5], v[70:71], v[70:71]
v_pk_fma_f32 v[148:149], v[148:149], s[48:49], v[156:157]
v_pk_fma_f32 v[150:151], v[150:151], s[48:49], v[156:157]
v_pk_fma_f32 v[2:3], v[2:3], s[48:49], v[156:157]
v_pk_fma_f32 v[4:5], v[4:5], s[48:49], v[156:157]
v_pk_mul_f32 v[148:149], v[148:149], v[64:65]
v_pk_mul_f32 v[150:151], v[150:151], v[66:67]
v_pk_mul_f32 v[2:3], v[2:3], v[68:69]
v_pk_mul_f32 v[4:5], v[4:5], v[70:71]
v_exp_f32 v148, v148
v_exp_f32 v149, v149
v_exp_f32 v150, v150
v_exp_f32 v151, v151
v_exp_f32 v2, v2
v_exp_f32 v3, v3
v_exp_f32 v4, v4
v_exp_f32 v5, v5
v_pk_add_f32 v[148:149], v[148:149], v[128:129] op_sel:[0,0] op_sel_hi:[1,0]
v_pk_add_f32 v[150:151], v[150:151], v[128:129] op_sel:[0,0] op_sel_hi:[1,0]
v_pk_add_f32 v[2:3], v[2:3], v[128:129] op_sel:[0,0] op_sel_hi:[1,0]
v_pk_add_f32 v[4:5], v[4:5], v[128:129] op_sel:[0,0] op_sel_hi:[1,0]
v_rcp_f32 v148, v148
v_rcp_f32 v149, v149
v_rcp_f32 v150, v150
v_rcp_f32 v151, v151
v_rcp_f32 v2, v2
v_rcp_f32 v3, v3
v_rcp_f32 v4, v4
v_rcp_f32 v5, v5
v_pk_mul_f32 v[64:65], v[64:65], v[148:149]
v_pk_mul_f32 v[66:67], v[66:67], v[150:151]
v_pk_mul_f32 v[68:69], v[68:69], v[2:3]
v_pk_mul_f32 v[70:71], v[70:71], v[4:5]
v_cvt_pk_bf16_f32 v64, v64, v65
v_cvt_pk_bf16_f32 v65, v66, v67
v_cvt_pk_bf16_f32 v68, v68, v69
v_cvt_pk_bf16_f32 v69, v70, v71
v_pk_fma_f32 v[148:149], v[12:13], v[140:141], v[144:145] op_sel:[1,0,0] op_sel_hi:[1,1,1]
v_pk_fma_f32 v[150:151], v[12:13], v[142:143], v[146:147] op_sel:[1,0,0] op_sel_hi:[1,1,1]
v_pk_fma_f32 v[2:3], v[14:15], v[140:141], v[144:145] op_sel:[1,0,0] op_sel_hi:[1,1,1]
v_pk_fma_f32 v[4:5], v[14:15], v[142:143], v[146:147] op_sel:[1,0,0] op_sel_hi:[1,1,1]
v_pk_fma_f32 v[72:73], v[12:13], v[72:73], v[148:149] op_sel:[0,0,0] op_sel_hi:[0,1,1]
v_pk_fma_f32 v[74:75], v[12:13], v[74:75], v[150:151] op_sel:[0,0,0] op_sel_hi:[0,1,1]
v_pk_fma_f32 v[76:77], v[14:15], v[76:77], v[2:3] op_sel:[0,0,0] op_sel_hi:[0,1,1]
v_pk_fma_f32 v[78:79], v[14:15], v[78:79], v[4:5] op_sel:[0,0,0] op_sel_hi:[0,1,1]
v_pk_mul_f32 v[148:149], v[72:73], v[72:73]
v_pk_mul_f32 v[150:151], v[74:75], v[74:75]
v_pk_mul_f32 v[2:3], v[76:77], v[76:77]
v_pk_mul_f32 v[4:5], v[78:79], v[78:79]
v_pk_fma_f32 v[148:149], v[148:149], s[48:49], v[156:157]
v_pk_fma_f32 v[150:151], v[150:151], s[48:49], v[156:157]
v_pk_fma_f32 v[2:3], v[2:3], s[48:49], v[156:157]
v_pk_fma_f32 v[4:5], v[4:5], s[48:49], v[156:157]
v_pk_mul_f32 v[148:149], v[148:149], v[72:73]
v_pk_mul_f32 v[150:151], v[150:151], v[74:75]
v_pk_mul_f32 v[2:3], v[2:3], v[76:77]
v_pk_mul_f32 v[4:5], v[4:5], v[78:79]
v_exp_f32 v148, v148
v_exp_f32 v149, v149
v_exp_f32 v150, v150
v_exp_f32 v151, v151
v_exp_f32 v2, v2
v_exp_f32 v3, v3
v_exp_f32 v4, v4
v_exp_f32 v5, v5
v_pk_add_f32 v[148:149], v[148:149], v[128:129] op_sel:[0,0] op_sel_hi:[1,0]
v_pk_add_f32 v[150:151], v[150:151], v[128:129] op_sel:[0,0] op_sel_hi:[1,0]
v_pk_add_f32 v[2:3], v[2:3], v[128:129] op_sel:[0,0] op_sel_hi:[1,0]
v_pk_add_f32 v[4:5], v[4:5], v[128:129] op_sel:[0,0] op_sel_hi:[1,0]
v_rcp_f32 v148, v148
v_rcp_f32 v149, v149
v_rcp_f32 v150, v150
v_rcp_f32 v151, v151
v_rcp_f32 v2, v2
v_rcp_f32 v3, v3
v_rcp_f32 v4, v4
v_rcp_f32 v5, v5
v_pk_mul_f32 v[72:73], v[72:73], v[148:149]
v_pk_mul_f32 v[74:75], v[74:75], v[150:151]
v_pk_mul_f32 v[76:77], v[76:77], v[2:3]
v_pk_mul_f32 v[78:79], v[78:79], v[4:5]
v_cvt_pk_bf16_f32 v72, v72, v73
v_cvt_pk_bf16_f32 v73, v74, v75
v_cvt_pk_bf16_f32 v76, v76, v77
v_cvt_pk_bf16_f32 v77, v78, v79
s_waitcnt lgkmcnt(0)
s_barrier
s_waitcnt lgkmcnt(0)
ds_read_b128 v[140:143], v129 offset:320
ds_read_b128 v[144:147], v129 offset:1216
v_pk_fma_f32 v[148:149], v[8:9], v[132:133], v[136:137] op_sel:[1,0,0] op_sel_hi:[1,1,1]
v_pk_fma_f32 v[150:151], v[8:9], v[134:135], v[138:139] op_sel:[1,0,0] op_sel_hi:[1,1,1]
v_pk_fma_f32 v[2:3], v[10:11], v[132:133], v[136:137] op_sel:[1,0,0] op_sel_hi:[1,1,1]
v_pk_fma_f32 v[4:5], v[10:11], v[134:135], v[138:139] op_sel:[1,0,0] op_sel_hi:[1,1,1]
v_pk_fma_f32 v[80:81], v[8:9], v[80:81], v[148:149] op_sel:[0,0,0] op_sel_hi:[0,1,1]
v_pk_fma_f32 v[82:83], v[8:9], v[82:83], v[150:151] op_sel:[0,0,0] op_sel_hi:[0,1,1]
v_pk_fma_f32 v[84:85], v[10:11], v[84:85], v[2:3] op_sel:[0,0,0] op_sel_hi:[0,1,1]
v_pk_fma_f32 v[86:87], v[10:11], v[86:87], v[4:5] op_sel:[0,0,0] op_sel_hi:[0,1,1]
v_pk_mul_f32 v[148:149], v[80:81], v[80:81]
v_pk_mul_f32 v[150:151], v[82:83], v[82:83]
v_pk_mul_f32 v[2:3], v[84:85], v[84:85]
v_pk_mul_f32 v[4:5], v[86:87], v[86:87]
v_pk_fma_f32 v[148:149], v[148:149], s[48:49], v[156:157]
v_pk_fma_f32 v[150:151], v[150:151], s[48:49], v[156:157]
v_pk_fma_f32 v[2:3], v[2:3], s[48:49], v[156:157]
v_pk_fma_f32 v[4:5], v[4:5], s[48:49], v[156:157]
v_pk_mul_f32 v[148:149], v[148:149], v[80:81]
v_pk_mul_f32 v[150:151], v[150:151], v[82:83]
v_pk_mul_f32 v[2:3], v[2:3], v[84:85]
v_pk_mul_f32 v[4:5], v[4:5], v[86:87]
v_exp_f32 v148, v148
v_exp_f32 v149, v149
v_exp_f32 v150, v150
v_exp_f32 v151, v151
v_exp_f32 v2, v2
v_exp_f32 v3, v3
v_exp_f32 v4, v4
v_exp_f32 v5, v5
v_pk_add_f32 v[148:149], v[148:149], v[128:129] op_sel:[0,0] op_sel_hi:[1,0]
v_pk_add_f32 v[150:151], v[150:151], v[128:129] op_sel:[0,0] op_sel_hi:[1,0]
v_pk_add_f32 v[2:3], v[2:3], v[128:129] op_sel:[0,0] op_sel_hi:[1,0]
v_pk_add_f32 v[4:5], v[4:5], v[128:129] op_sel:[0,0] op_sel_hi:[1,0]
v_rcp_f32 v148, v148
v_rcp_f32 v149, v149
v_rcp_f32 v150, v150
v_rcp_f32 v151, v151
v_rcp_f32 v2, v2
v_rcp_f32 v3, v3
v_rcp_f32 v4, v4
v_rcp_f32 v5, v5
v_pk_mul_f32 v[80:81], v[80:81], v[148:149]
v_pk_mul_f32 v[82:83], v[82:83], v[150:151]
v_pk_mul_f32 v[84:85], v[84:85], v[2:3]
v_pk_mul_f32 v[86:87], v[86:87], v[4:5]
v_cvt_pk_bf16_f32 v66, v80, v81
v_cvt_pk_bf16_f32 v67, v82, v83
v_cvt_pk_bf16_f32 v70, v84, v85
v_cvt_pk_bf16_f32 v71, v86, v87
s_add_u32 s11, s46, 5120
buffer_store_dwordx4 v[64:67], v130, s[24:27], s11 offen sc1
s_add_u32 s11, s46, 119808
buffer_store_dwordx4 v[68:71], v130, s[24:27], s11 offen sc1
v_pk_fma_f32 v[148:149], v[12:13], v[132:133], v[136:137] op_sel:[1,0,0] op_sel_hi:[1,1,1]
v_pk_fma_f32 v[150:151], v[12:13], v[134:135], v[138:139] op_sel:[1,0,0] op_sel_hi:[1,1,1]
v_pk_fma_f32 v[2:3], v[14:15], v[132:133], v[136:137] op_sel:[1,0,0] op_sel_hi:[1,1,1]
v_pk_fma_f32 v[4:5], v[14:15], v[134:135], v[138:139] op_sel:[1,0,0] op_sel_hi:[1,1,1]
v_pk_fma_f32 v[88:89], v[12:13], v[88:89], v[148:149] op_sel:[0,0,0] op_sel_hi:[0,1,1]
v_pk_fma_f32 v[90:91], v[12:13], v[90:91], v[150:151] op_sel:[0,0,0] op_sel_hi:[0,1,1]
v_pk_fma_f32 v[92:93], v[14:15], v[92:93], v[2:3] op_sel:[0,0,0] op_sel_hi:[0,1,1]
v_pk_fma_f32 v[94:95], v[14:15], v[94:95], v[4:5] op_sel:[0,0,0] op_sel_hi:[0,1,1]
v_pk_mul_f32 v[148:149], v[88:89], v[88:89]
v_pk_mul_f32 v[150:151], v[90:91], v[90:91]
v_pk_mul_f32 v[2:3], v[92:93], v[92:93]
v_pk_mul_f32 v[4:5], v[94:95], v[94:95]
v_pk_fma_f32 v[148:149], v[148:149], s[48:49], v[156:157]
v_pk_fma_f32 v[150:151], v[150:151], s[48:49], v[156:157]
v_pk_fma_f32 v[2:3], v[2:3], s[48:49], v[156:157]
v_pk_fma_f32 v[4:5], v[4:5], s[48:49], v[156:157]
v_pk_mul_f32 v[148:149], v[148:149], v[88:89]
v_pk_mul_f32 v[150:151], v[150:151], v[90:91]
v_pk_mul_f32 v[2:3], v[2:3], v[92:93]
v_pk_mul_f32 v[4:5], v[4:5], v[94:95]
v_exp_f32 v148, v148
v_exp_f32 v149, v149
v_exp_f32 v150, v150
v_exp_f32 v151, v151
v_exp_f32 v2, v2
v_exp_f32 v3, v3
v_exp_f32 v4, v4
v_exp_f32 v5, v5
v_pk_add_f32 v[148:149], v[148:149], v[128:129] op_sel:[0,0] op_sel_hi:[1,0]
v_pk_add_f32 v[150:151], v[150:151], v[128:129] op_sel:[0,0] op_sel_hi:[1,0]
v_pk_add_f32 v[2:3], v[2:3], v[128:129] op_sel:[0,0] op_sel_hi:[1,0]
v_pk_add_f32 v[4:5], v[4:5], v[128:129] op_sel:[0,0] op_sel_hi:[1,0]
v_rcp_f32 v148, v148
v_rcp_f32 v149, v149
v_rcp_f32 v150, v150
v_rcp_f32 v151, v151
v_rcp_f32 v2, v2
v_rcp_f32 v3, v3
v_rcp_f32 v4, v4
v_rcp_f32 v5, v5
v_pk_mul_f32 v[88:89], v[88:89], v[148:149]
v_pk_mul_f32 v[90:91], v[90:91], v[150:151]
v_pk_mul_f32 v[92:93], v[92:93], v[2:3]
v_pk_mul_f32 v[94:95], v[94:95], v[4:5]
v_cvt_pk_bf16_f32 v74, v88, v89
v_cvt_pk_bf16_f32 v75, v90, v91
v_cvt_pk_bf16_f32 v78, v92, v93
v_cvt_pk_bf16_f32 v79, v94, v95
s_add_u32 s11, s46, 234496
buffer_store_dwordx4 v[72:75], v130, s[24:27], s11 offen sc1
s_add_u32 s11, s46, 349184
buffer_store_dwordx4 v[76:79], v130, s[24:27], s11 offen sc1
s_waitcnt lgkmcnt(0)
ds_read_b128 v[132:135], v129 offset:384
ds_read_b128 v[136:139], v129 offset:1280
v_pk_fma_f32 v[148:149], v[8:9], v[140:141], v[144:145] op_sel:[1,0,0] op_sel_hi:[1,1,1]
v_pk_fma_f32 v[150:151], v[8:9], v[142:143], v[146:147] op_sel:[1,0,0] op_sel_hi:[1,1,1]
v_pk_fma_f32 v[2:3], v[10:11], v[140:141], v[144:145] op_sel:[1,0,0] op_sel_hi:[1,1,1]
v_pk_fma_f32 v[4:5], v[10:11], v[142:143], v[146:147] op_sel:[1,0,0] op_sel_hi:[1,1,1]
v_pk_fma_f32 v[96:97], v[8:9], v[96:97], v[148:149] op_sel:[0,0,0] op_sel_hi:[0,1,1]
v_pk_fma_f32 v[98:99], v[8:9], v[98:99], v[150:151] op_sel:[0,0,0] op_sel_hi:[0,1,1]
v_pk_fma_f32 v[100:101], v[10:11], v[100:101], v[2:3] op_sel:[0,0,0] op_sel_hi:[0,1,1]
v_pk_fma_f32 v[102:103], v[10:11], v[102:103], v[4:5] op_sel:[0,0,0] op_sel_hi:[0,1,1]
v_pk_mul_f32 v[148:149], v[96:97], v[96:97]
v_pk_mul_f32 v[150:151], v[98:99], v[98:99]
v_pk_mul_f32 v[2:3], v[100:101], v[100:101]
v_pk_mul_f32 v[4:5], v[102:103], v[102:103]
v_pk_fma_f32 v[148:149], v[148:149], s[48:49], v[156:157]
v_pk_fma_f32 v[150:151], v[150:151], s[48:49], v[156:157]
v_pk_fma_f32 v[2:3], v[2:3], s[48:49], v[156:157]
v_pk_fma_f32 v[4:5], v[4:5], s[48:49], v[156:157]
v_pk_mul_f32 v[148:149], v[148:149], v[96:97]
v_pk_mul_f32 v[150:151], v[150:151], v[98:99]
v_pk_mul_f32 v[2:3], v[2:3], v[100:101]
v_pk_mul_f32 v[4:5], v[4:5], v[102:103]
v_exp_f32 v148, v148
v_exp_f32 v149, v149
v_exp_f32 v150, v150
v_exp_f32 v151, v151
v_exp_f32 v2, v2
v_exp_f32 v3, v3
v_exp_f32 v4, v4
v_exp_f32 v5, v5
v_pk_add_f32 v[148:149], v[148:149], v[128:129] op_sel:[0,0] op_sel_hi:[1,0]
v_pk_add_f32 v[150:151], v[150:151], v[128:129] op_sel:[0,0] op_sel_hi:[1,0]
v_pk_add_f32 v[2:3], v[2:3], v[128:129] op_sel:[0,0] op_sel_hi:[1,0]
v_pk_add_f32 v[4:5], v[4:5], v[128:129] op_sel:[0,0] op_sel_hi:[1,0]
v_rcp_f32 v148, v148
v_rcp_f32 v149, v149
v_rcp_f32 v150, v150
v_rcp_f32 v151, v151
v_rcp_f32 v2, v2
v_rcp_f32 v3, v3
v_rcp_f32 v4, v4
v_rcp_f32 v5, v5
v_pk_mul_f32 v[96:97], v[96:97], v[148:149]
v_pk_mul_f32 v[98:99], v[98:99], v[150:151]
v_pk_mul_f32 v[100:101], v[100:101], v[2:3]
v_pk_mul_f32 v[102:103], v[102:103], v[4:5]
v_cvt_pk_bf16_f32 v96, v96, v97
v_cvt_pk_bf16_f32 v97, v98, v99
v_cvt_pk_bf16_f32 v100, v100, v101
v_cvt_pk_bf16_f32 v101, v102, v103
v_pk_fma_f32 v[148:149], v[12:13], v[140:141], v[144:145] op_sel:[1,0,0] op_sel_hi:[1,1,1]
v_pk_fma_f32 v[150:151], v[12:13], v[142:143], v[146:147] op_sel:[1,0,0] op_sel_hi:[1,1,1]
v_pk_fma_f32 v[2:3], v[14:15], v[140:141], v[144:145] op_sel:[1,0,0] op_sel_hi:[1,1,1]
v_pk_fma_f32 v[4:5], v[14:15], v[142:143], v[146:147] op_sel:[1,0,0] op_sel_hi:[1,1,1]
v_pk_fma_f32 v[104:105], v[12:13], v[104:105], v[148:149] op_sel:[0,0,0] op_sel_hi:[0,1,1]
v_pk_fma_f32 v[106:107], v[12:13], v[106:107], v[150:151] op_sel:[0,0,0] op_sel_hi:[0,1,1]
v_pk_fma_f32 v[108:109], v[14:15], v[108:109], v[2:3] op_sel:[0,0,0] op_sel_hi:[0,1,1]
v_pk_fma_f32 v[110:111], v[14:15], v[110:111], v[4:5] op_sel:[0,0,0] op_sel_hi:[0,1,1]
v_pk_mul_f32 v[148:149], v[104:105], v[104:105]
v_pk_mul_f32 v[150:151], v[106:107], v[106:107]
v_pk_mul_f32 v[2:3], v[108:109], v[108:109]
v_pk_mul_f32 v[4:5], v[110:111], v[110:111]
v_pk_fma_f32 v[148:149], v[148:149], s[48:49], v[156:157]
v_pk_fma_f32 v[150:151], v[150:151], s[48:49], v[156:157]
v_pk_fma_f32 v[2:3], v[2:3], s[48:49], v[156:157]
v_pk_fma_f32 v[4:5], v[4:5], s[48:49], v[156:157]
v_pk_mul_f32 v[148:149], v[148:149], v[104:105]
v_pk_mul_f32 v[150:151], v[150:151], v[106:107]
v_pk_mul_f32 v[2:3], v[2:3], v[108:109]
v_pk_mul_f32 v[4:5], v[4:5], v[110:111]
v_exp_f32 v148, v148
v_exp_f32 v149, v149
v_exp_f32 v150, v150
v_exp_f32 v151, v151
v_exp_f32 v2, v2
v_exp_f32 v3, v3
v_exp_f32 v4, v4
v_exp_f32 v5, v5
v_pk_add_f32 v[148:149], v[148:149], v[128:129] op_sel:[0,0] op_sel_hi:[1,0]
v_pk_add_f32 v[150:151], v[150:151], v[128:129] op_sel:[0,0] op_sel_hi:[1,0]
v_pk_add_f32 v[2:3], v[2:3], v[128:129] op_sel:[0,0] op_sel_hi:[1,0]
v_pk_add_f32 v[4:5], v[4:5], v[128:129] op_sel:[0,0] op_sel_hi:[1,0]
v_rcp_f32 v148, v148
v_rcp_f32 v149, v149
v_rcp_f32 v150, v150
v_rcp_f32 v151, v151
v_rcp_f32 v2, v2
v_rcp_f32 v3, v3
v_rcp_f32 v4, v4
v_rcp_f32 v5, v5
v_pk_mul_f32 v[104:105], v[104:105], v[148:149]
v_pk_mul_f32 v[106:107], v[106:107], v[150:151]
v_pk_mul_f32 v[108:109], v[108:109], v[2:3]
v_pk_mul_f32 v[110:111], v[110:111], v[4:5]
v_cvt_pk_bf16_f32 v104, v104, v105
v_cvt_pk_bf16_f32 v105, v106, v107
v_cvt_pk_bf16_f32 v108, v108, v109
v_cvt_pk_bf16_f32 v109, v110, v111
s_waitcnt lgkmcnt(0)
v_pk_fma_f32 v[148:149], v[8:9], v[132:133], v[136:137] op_sel:[1,0,0] op_sel_hi:[1,1,1]
v_pk_fma_f32 v[150:151], v[8:9], v[134:135], v[138:139] op_sel:[1,0,0] op_sel_hi:[1,1,1]
v_pk_fma_f32 v[2:3], v[10:11], v[132:133], v[136:137] op_sel:[1,0,0] op_sel_hi:[1,1,1]
v_pk_fma_f32 v[4:5], v[10:11], v[134:135], v[138:139] op_sel:[1,0,0] op_sel_hi:[1,1,1]
v_pk_fma_f32 v[112:113], v[8:9], v[112:113], v[148:149] op_sel:[0,0,0] op_sel_hi:[0,1,1]
v_pk_fma_f32 v[114:115], v[8:9], v[114:115], v[150:151] op_sel:[0,0,0] op_sel_hi:[0,1,1]
v_pk_fma_f32 v[116:117], v[10:11], v[116:117], v[2:3] op_sel:[0,0,0] op_sel_hi:[0,1,1]
v_pk_fma_f32 v[118:119], v[10:11], v[118:119], v[4:5] op_sel:[0,0,0] op_sel_hi:[0,1,1]
v_pk_mul_f32 v[148:149], v[112:113], v[112:113]
v_pk_mul_f32 v[150:151], v[114:115], v[114:115]
v_pk_mul_f32 v[2:3], v[116:117], v[116:117]
v_pk_mul_f32 v[4:5], v[118:119], v[118:119]
v_pk_fma_f32 v[148:149], v[148:149], s[48:49], v[156:157]
v_pk_fma_f32 v[150:151], v[150:151], s[48:49], v[156:157]
v_pk_fma_f32 v[2:3], v[2:3], s[48:49], v[156:157]
v_pk_fma_f32 v[4:5], v[4:5], s[48:49], v[156:157]
v_pk_mul_f32 v[148:149], v[148:149], v[112:113]
v_pk_mul_f32 v[150:151], v[150:151], v[114:115]
v_pk_mul_f32 v[2:3], v[2:3], v[116:117]
v_pk_mul_f32 v[4:5], v[4:5], v[118:119]
v_exp_f32 v148, v148
v_exp_f32 v149, v149
v_exp_f32 v150, v150
v_exp_f32 v151, v151
v_exp_f32 v2, v2
v_exp_f32 v3, v3
v_exp_f32 v4, v4
v_exp_f32 v5, v5
v_pk_add_f32 v[148:149], v[148:149], v[128:129] op_sel:[0,0] op_sel_hi:[1,0]
v_pk_add_f32 v[150:151], v[150:151], v[128:129] op_sel:[0,0] op_sel_hi:[1,0]
v_pk_add_f32 v[2:3], v[2:3], v[128:129] op_sel:[0,0] op_sel_hi:[1,0]
v_pk_add_f32 v[4:5], v[4:5], v[128:129] op_sel:[0,0] op_sel_hi:[1,0]
v_rcp_f32 v148, v148
v_rcp_f32 v149, v149
v_rcp_f32 v150, v150
v_rcp_f32 v151, v151
v_rcp_f32 v2, v2
v_rcp_f32 v3, v3
v_rcp_f32 v4, v4
v_rcp_f32 v5, v5
v_pk_mul_f32 v[112:113], v[112:113], v[148:149]
v_pk_mul_f32 v[114:115], v[114:115], v[150:151]
v_pk_mul_f32 v[116:117], v[116:117], v[2:3]
v_pk_mul_f32 v[118:119], v[118:119], v[4:5]
v_cvt_pk_bf16_f32 v98, v112, v113
v_cvt_pk_bf16_f32 v99, v114, v115
v_cvt_pk_bf16_f32 v102, v116, v117
v_cvt_pk_bf16_f32 v103, v118, v119
s_add_u32 s11, s46, 6144
buffer_store_dwordx4 v[96:99], v130, s[24:27], s11 offen sc1
s_add_u32 s11, s46, 120832
buffer_store_dwordx4 v[100:103], v130, s[24:27], s11 offen sc1
v_pk_fma_f32 v[148:149], v[12:13], v[132:133], v[136:137] op_sel:[1,0,0] op_sel_hi:[1,1,1]
v_pk_fma_f32 v[150:151], v[12:13], v[134:135], v[138:139] op_sel:[1,0,0] op_sel_hi:[1,1,1]
v_pk_fma_f32 v[2:3], v[14:15], v[132:133], v[136:137] op_sel:[1,0,0] op_sel_hi:[1,1,1]
v_pk_fma_f32 v[4:5], v[14:15], v[134:135], v[138:139] op_sel:[1,0,0] op_sel_hi:[1,1,1]
v_pk_fma_f32 v[120:121], v[12:13], v[120:121], v[148:149] op_sel:[0,0,0] op_sel_hi:[0,1,1]
v_pk_fma_f32 v[122:123], v[12:13], v[122:123], v[150:151] op_sel:[0,0,0] op_sel_hi:[0,1,1]
v_pk_fma_f32 v[124:125], v[14:15], v[124:125], v[2:3] op_sel:[0,0,0] op_sel_hi:[0,1,1]
v_pk_fma_f32 v[126:127], v[14:15], v[126:127], v[4:5] op_sel:[0,0,0] op_sel_hi:[0,1,1]
v_pk_mul_f32 v[148:149], v[120:121], v[120:121]
v_pk_mul_f32 v[150:151], v[122:123], v[122:123]
v_pk_mul_f32 v[2:3], v[124:125], v[124:125]
v_pk_mul_f32 v[4:5], v[126:127], v[126:127]
v_pk_fma_f32 v[148:149], v[148:149], s[48:49], v[156:157]
v_pk_fma_f32 v[150:151], v[150:151], s[48:49], v[156:157]
v_pk_fma_f32 v[2:3], v[2:3], s[48:49], v[156:157]
v_pk_fma_f32 v[4:5], v[4:5], s[48:49], v[156:157]
v_pk_mul_f32 v[148:149], v[148:149], v[120:121]
v_pk_mul_f32 v[150:151], v[150:151], v[122:123]
v_pk_mul_f32 v[2:3], v[2:3], v[124:125]
v_pk_mul_f32 v[4:5], v[4:5], v[126:127]
v_exp_f32 v148, v148
v_exp_f32 v149, v149
v_exp_f32 v150, v150
v_exp_f32 v151, v151
v_exp_f32 v2, v2
v_exp_f32 v3, v3
v_exp_f32 v4, v4
v_exp_f32 v5, v5
v_pk_add_f32 v[148:149], v[148:149], v[128:129] op_sel:[0,0] op_sel_hi:[1,0]
v_pk_add_f32 v[150:151], v[150:151], v[128:129] op_sel:[0,0] op_sel_hi:[1,0]
v_pk_add_f32 v[2:3], v[2:3], v[128:129] op_sel:[0,0] op_sel_hi:[1,0]
v_pk_add_f32 v[4:5], v[4:5], v[128:129] op_sel:[0,0] op_sel_hi:[1,0]
v_rcp_f32 v148, v148
v_rcp_f32 v149, v149
v_rcp_f32 v150, v150
v_rcp_f32 v151, v151
v_rcp_f32 v2, v2
v_rcp_f32 v3, v3
v_rcp_f32 v4, v4
v_rcp_f32 v5, v5
v_pk_mul_f32 v[120:121], v[120:121], v[148:149]
v_pk_mul_f32 v[122:123], v[122:123], v[150:151]
v_pk_mul_f32 v[124:125], v[124:125], v[2:3]
v_pk_mul_f32 v[126:127], v[126:127], v[4:5]
v_cvt_pk_bf16_f32 v106, v120, v121
v_cvt_pk_bf16_f32 v107, v122, v123
v_cvt_pk_bf16_f32 v110, v124, v125
v_cvt_pk_bf16_f32 v111, v126, v127
s_add_u32 s11, s46, 235520
buffer_store_dwordx4 v[104:107], v130, s[24:27], s11 offen sc1
s_add_u32 s11, s46, 350208
buffer_store_dwordx4 v[108:111], v130, s[24:27], s11 offen sc1
L_wnj_6:
s_barrier
s_mov_b32 s28, s82
s_and_b32 s29, s83, 0xffff
s_mov_b32 s30, 7340032
s_mov_b32 s31, 0x20000
v_lshlrev_b32 v2, 4, v1
v_add_u32 v3, 112640, v2
s_and_b32 s55, s9, 1
s_mul_i32 s55, s55, 32
s_lshl_b32 s50, s8, 3
s_lshl_b32 s10, s5, 1
s_add_u32 s50, s50, s10
s_mul_i32 s50, s50, 114688
s_lshl_b32 s51, s5, 12
v_lshrrev_b32 v6, 3, v1
v_and_b32 v7, 7, v1
v_lshrrev_b32 v8, 1, v7
v_lshrrev_b32 v9, 1, v6
v_xor_b32 v8, v8, v9
v_lshlrev_b32 v8, 1, v8
v_and_b32 v9, 1, v7
v_or_b32 v8, v8, v9
v_lshlrev_b32 v8, 4, v8
v_lshlrev_b32 v6, 11, v6
v_add_u32 v4, v6, v8
v_add_u32 v5, 15360, v4
s_lshl_b32 s52, s5, 15
s_lshl_b32 s10, s9, 7
s_add_u32 s54, s52, s10
s_xor_b32 s10, s10, 128
s_add_u32 s10, s52, s10
s_mov_b32 s52, s54
s_mov_b32 s54, s10
s_lshl_b32 s53, s5, 11
s_add_u32 s53, s53, 16384
s_lshl_b32 s10, s55, 11
s_add_u32 s56, s50, s10
s_lshl_b32 s10, s55, 17
s_add_u32 s57, s52, s10
s_add_u32 s58, s54, s10
s_waitcnt vmcnt(0)
s_lshl_b32 s10, s6, 6
s_lshl_b32 s11, s7, 2
s_add_u32 s10, s10, s11
s_add_u32 s10, s10, s5
s_lshl_b32 s10, s10, 2
s_add_u32 s10, s10, 27660288
v_mov_b32 v142, 0
v_mov_b32 v143, s97
buffer_store_dword v143, v142, s[24:27], s10 offen sc1
s_add_u32 m0, s53, 131072
s_add_u32 s10, s57, 0
buffer_load_dwordx4 v4, s[28:31], s10 offen offset:0 lds
buffer_load_dwordx4 v5, s[28:31], s10 offen offset:1024 lds
s_add_u32 m0, s53, 139264
s_add_u32 s10, s58, 0
buffer_load_dwordx4 v4, s[28:31], s10 offen offset:0 lds
buffer_load_dwordx4 v5, s[28:31], s10 offen offset:1024 lds
s_add_u32 m0, s53, 0
s_add_u32 s10, s57, 131072
buffer_load_dwordx4 v4, s[28:31], s10 offen offset:0 lds
buffer_load_dwordx4 v5, s[28:31], s10 offen offset:1024 lds
s_add_u32 m0, s53, 8192
s_add_u32 s10, s58, 131072
buffer_load_dwordx4 v4, s[28:31], s10 offen offset:0 lds
buffer_load_dwordx4 v5, s[28:31], s10 offen offset:1024 lds
v_lshlrev_b32 v10, 2, v1
s_lshl_b32 s12, s8, 8
s_add_u32 s12, s12, 27660288
s_mov_b32 s98, 0x0
s_mov_b32 s99, 0xf0
s_and_b32 s10, s9, 1
s_cmp_eq_u32 s10, 0
s_cselect_b32 s98, 0xf, s98
s_cselect_b32 s99, 0x0, s99
s_mov_b32 s14, 0x200000
L_hlp_8:
buffer_load_dword v11, v10, s[24:27], s12 offen sc1
s_waitcnt vmcnt(0)
v_cmp_ne_u32 vcc, s97, v11
s_sub_u32 s14, s14, 1
s_cmp_eq_u32 s14, 0
s_cbranch_scc1 L_hok_7
s_and_b64 vcc, vcc, s[98:99]
s_cbranch_scc0 L_hok_7
s_sleep 8
s_branch L_hlp_8
L_hok_7:
s_add_u32 m0, s51, 131072
s_add_u32 s10, s56, 0
buffer_load_dwordx4 v2, s[24:27], s10 offen offset:0 sc1 lds
buffer_load_dwordx4 v2, s[24:27], s10 offen offset:1024 sc1 lds
buffer_load_dwordx4 v3, s[24:27], s10 offen offset:2048 sc1 lds
buffer_load_dwordx4 v3, s[24:27], s10 offen offset:3072 sc1 lds
s_add_u32 m0, s51, 0
s_add_u32 s10, s56, 2048
buffer_load_dwordx4 v2, s[24:27], s10 offen offset:0 sc1 lds
buffer_load_dwordx4 v2, s[24:27], s10 offen offset:1024 sc1 lds
buffer_load_dwordx4 v3, s[24:27], s10 offen offset:2048 sc1 lds
buffer_load_dwordx4 v3, s[24:27], s10 offen offset:3072 sc1 lds
s_and_b32 s44, s5, 1
s_lshr_b32 s45, s5, 1
v_and_b32 v8, 15, v1
v_lshrrev_b32 v9, 4, v1
s_lshl_b32 s10, s44, 13
v_lshlrev_b32 v2, 4, v1
v_add_u32 v2, s10, v2
v_lshrrev_b32 v10, 2, v8
v_lshlrev_b32 v11, 2, v9
v_add_u32 v10, v10, v11
v_lshrrev_b32 v11, 1, v10
v_and_b32 v11, 3, v11
v_lshlrev_b32 v10, 7, v10
v_and_b32 v12, 3, v8
v_lshlrev_b32 v12, 3, v12
v_add_u32 v10, v10, v12
v_add_u32 v10, 16384, v10
s_lshl_b32 s10, s45, 1
s_add_u32 s11, s10, 0
v_xor_b32 v12, s11, v11
v_lshlrev_b32 v12, 5, v12
v_add_u32 v3, v10, v12
s_add_u32 s11, s10, 1
v_xor_b32 v12, s11, v11
v_lshlrev_b32 v12, 5, v12
v_add_u32 v4, v10, v12
v_add_u32 v128, 131072, v2
v_add_u32 v129, 131072, v3
v_add_u32 v130, 131072, v4
v_add_u32 v131, 0, v2
v_add_u32 v132, 0, v3
v_add_u32 v133, 0, v4
v_add_u32 v134, 32768, v2
v_add_u32 v135, 32768, v3
v_add_u32 v136, 32768, v4
v_add_u32 v137, 65536, v2
v_add_u32 v138, 65536, v3
v_add_u32 v139, 65536, v4
s_waitcnt vmcnt(0)
s_barrier
ds_read_b64_tr_b16 a[16:17], v129 offset:0
ds_read_b64_tr_b16 a[18:19], v129 offset:2048
ds_read_b64_tr_b16 a[20:21], v130 offset:0
ds_read_b64_tr_b16 a[22:23], v130 offset:2048
ds_read_b64_tr_b16 a[24:25], v129 offset:8192
ds_read_b64_tr_b16 a[26:27], v129 offset:10240
ds_read_b64_tr_b16 a[28:29], v130 offset:8192
ds_read_b64_tr_b16 a[30:31], v130 offset:10240
ds_read_b128 a[0:3], v128 offset:0
ds_read_b128 a[4:7], v128 offset:2048
ds_read_b128 a[8:11], v128 offset:4096
ds_read_b128 a[12:15], v128 offset:6144
ds_read_b64_tr_b16 a[48:49], v129 offset:4096
ds_read_b64_tr_b16 a[50:51], v129 offset:6144
ds_read_b64_tr_b16 a[52:53], v130 offset:4096
ds_read_b64_tr_b16 a[54:55], v130 offset:6144
ds_read_b64_tr_b16 a[56:57], v129 offset:12288
ds_read_b64_tr_b16 a[58:59], v129 offset:14336
ds_read_b64_tr_b16 a[60:61], v130 offset:12288
ds_read_b64_tr_b16 a[62:63], v130 offset:14336
ds_read_b128 a[32:35], v128 offset:1024
ds_read_b128 a[36:39], v128 offset:3072
ds_read_b128 a[40:43], v128 offset:5120
ds_read_b128 a[44:47], v128 offset:7168
s_waitcnt lgkmcnt(0)
s_barrier
v_mfma_f32_16x16x32_bf16 v[16:19], a[16:19], a[0:3], 0
ds_read_b64_tr_b16 a[80:81], v132 offset:0
ds_read_b64_tr_b16 a[82:83], v132 offset:2048
v_mfma_f32_16x16x32_bf16 v[20:23], a[16:19], a[4:7], 0
ds_read_b64_tr_b16 a[84:85], v133 offset:0
ds_read_b64_tr_b16 a[86:87], v133 offset:2048
v_mfma_f32_16x16x32_bf16 v[24:27], a[16:19], a[8:11], 0
ds_read_b64_tr_b16 a[88:89], v132 offset:8192
ds_read_b64_tr_b16 a[90:91], v132 offset:10240
v_mfma_f32_16x16x32_bf16 v[28:31], a[16:19], a[12:15], 0
ds_read_b64_tr_b16 a[92:93], v133 offset:8192
ds_read_b64_tr_b16 a[94:95], v133 offset:10240
v_mfma_f32_16x16x32_bf16 v[32:35], a[20:23], a[0:3], 0
ds_read_b128 a[64:67], v131 offset:0
ds_read_b128 a[68:71], v131 offset:2048
v_mfma_f32_16x16x32_bf16 v[36:39], a[20:23], a[4:7], 0
ds_read_b128 a[72:75], v131 offset:4096
ds_read_b128 a[76:79], v131 offset:6144
v_mfma_f32_16x16x32_bf16 v[40:43], a[20:23], a[8:11], 0
ds_read_b64_tr_b16 v[96:97], v132 offset:4096
ds_read_b64_tr_b16 v[98:99], v132 offset:6144
v_mfma_f32_16x16x32_bf16 v[44:47], a[20:23], a[12:15], 0
ds_read_b64_tr_b16 v[100:101], v133 offset:4096
ds_read_b64_tr_b16 v[102:103], v133 offset:6144
v_mfma_f32_16x16x32_bf16 v[48:51], a[24:27], a[0:3], 0
ds_read_b64_tr_b16 v[104:105], v132 offset:12288
ds_read_b64_tr_b16 v[106:107], v132 offset:14336
v_mfma_f32_16x16x32_bf16 v[52:55], a[24:27], a[4:7], 0
ds_read_b64_tr_b16 v[108:109], v133 offset:12288
ds_read_b64_tr_b16 v[110:111], v133 offset:14336
v_mfma_f32_16x16x32_bf16 v[56:59], a[24:27], a[8:11], 0
ds_read_b128 v[80:83], v131 offset:1024
ds_read_b128 v[84:87], v131 offset:3072
v_mfma_f32_16x16x32_bf16 v[60:63], a[24:27], a[12:15], 0
ds_read_b128 v[88:91], v131 offset:5120
ds_read_b128 v[92:95], v131 offset:7168
v_mfma_f32_16x16x32_bf16 v[64:67], a[28:31], a[0:3], 0
v_mfma_f32_16x16x32_bf16 v[68:71], a[28:31], a[4:7], 0
v_mfma_f32_16x16x32_bf16 v[72:75], a[28:31], a[8:11], 0
v_mfma_f32_16x16x32_bf16 v[76:79], a[28:31], a[12:15], 0
v_mfma_f32_16x16x32_bf16 v[16:19], a[48:51], a[32:35], v[16:19]
v_mfma_f32_16x16x32_bf16 v[20:23], a[48:51], a[36:39], v[20:23]
v_mfma_f32_16x16x32_bf16 v[24:27], a[48:51], a[40:43], v[24:27]
v_mfma_f32_16x16x32_bf16 v[28:31], a[48:51], a[44:47], v[28:31]
v_mfma_f32_16x16x32_bf16 v[32:35], a[52:55], a[32:35], v[32:35]
v_mfma_f32_16x16x32_bf16 v[36:39], a[52:55], a[36:39], v[36:39]
v_mfma_f32_16x16x32_bf16 v[40:43], a[52:55], a[40:43], v[40:43]
v_mfma_f32_16x16x32_bf16 v[44:47], a[52:55], a[44:47], v[44:47]
v_mfma_f32_16x16x32_bf16 v[48:51], a[56:59], a[32:35], v[48:51]
v_mfma_f32_16x16x32_bf16 v[52:55], a[56:59], a[36:39], v[52:55]
v_mfma_f32_16x16x32_bf16 v[56:59], a[56:59], a[40:43], v[56:59]
v_mfma_f32_16x16x32_bf16 v[60:63], a[56:59], a[44:47], v[60:63]
v_mfma_f32_16x16x32_bf16 v[64:67], a[60:63], a[32:35], v[64:67]
v_mfma_f32_16x16x32_bf16 v[68:71], a[60:63], a[36:39], v[68:71]
v_mfma_f32_16x16x32_bf16 v[72:75], a[60:63], a[40:43], v[72:75]
v_mfma_f32_16x16x32_bf16 v[76:79], a[60:63], a[44:47], v[76:79]
s_waitcnt lgkmcnt(0)
s_barrier
v_mfma_f32_16x16x32_bf16 v[16:19], a[80:83], a[64:67], v[16:19]
ds_read_b64_tr_b16 a[16:17], v135 offset:0
ds_read_b64_tr_b16 a[18:19], v135 offset:2048
v_mfma_f32_16x16x32_bf16 v[20:23], a[80:83], a[68:71], v[20:23]
ds_read_b64_tr_b16 a[20:21], v136 offset:0
ds_read_b64_tr_b16 a[22:23], v136 offset:2048
v_mfma_f32_16x16x32_bf16 v[24:27], a[80:83], a[72:75], v[24:27]
ds_read_b64_tr_b16 a[24:25], v135 offset:8192
ds_read_b64_tr_b16 a[26:27], v135 offset:10240
v_mfma_f32_16x16x32_bf16 v[28:31], a[80:83], a[76:79], v[28:31]
ds_read_b64_tr_b16 a[28:29], v136 offset:8192
ds_read_b64_tr_b16 a[30:31], v136 offset:10240
v_mfma_f32_16x16x32_bf16 v[32:35], a[84:87], a[64:67], v[32:35]
ds_read_b128 a[0:3], v134 offset:0
ds_read_b128 a[4:7], v134 offset:2048
v_mfma_f32_16x16x32_bf16 v[36:39], a[84:87], a[68:71], v[36:39]
ds_read_b128 a[8:11], v134 offset:4096
ds_read_b128 a[12:15], v134 offset:6144
v_mfma_f32_16x16x32_bf16 v[40:43], a[84:87], a[72:75], v[40:43]
ds_read_b64_tr_b16 a[48:49], v135 offset:4096
ds_read_b64_tr_b16 a[50:51], v135 offset:6144
v_mfma_f32_16x16x32_bf16 v[44:47], a[84:87], a[76:79], v[44:47]
ds_read_b64_tr_b16 a[52:53], v136 offset:4096
ds_read_b64_tr_b16 a[54:55], v136 offset:6144
v_mfma_f32_16x16x32_bf16 v[48:51], a[88:91], a[64:67], v[48:51]
ds_read_b64_tr_b16 a[56:57], v135 offset:12288
ds_read_b64_tr_b16 a[58:59], v135 offset:14336
v_mfma_f32_16x16x32_bf16 v[52:55], a[88:91], a[68:71], v[52:55]
ds_read_b64_tr_b16 a[60:61], v136 offset:12288
ds_read_b64_tr_b16 a[62:63], v136 offset:14336
v_mfma_f32_16x16x32_bf16 v[56:59], a[88:91], a[72:75], v[56:59]
ds_read_b128 a[32:35], v134 offset:1024
ds_read_b128 a[36:39], v134 offset:3072
v_mfma_f32_16x16x32_bf16 v[60:63], a[88:91], a[76:79], v[60:63]
ds_read_b128 a[40:43], v134 offset:5120
ds_read_b128 a[44:47], v134 offset:7168
v_mfma_f32_16x16x32_bf16 v[64:67], a[92:95], a[64:67], v[64:67]
v_mfma_f32_16x16x32_bf16 v[68:71], a[92:95], a[68:71], v[68:71]
v_mfma_f32_16x16x32_bf16 v[72:75], a[92:95], a[72:75], v[72:75]
v_mfma_f32_16x16x32_bf16 v[76:79], a[92:95], a[76:79], v[76:79]
v_mfma_f32_16x16x32_bf16 v[16:19], v[96:99], v[80:83], v[16:19]
v_mfma_f32_16x16x32_bf16 v[20:23], v[96:99], v[84:87], v[20:23]
v_mfma_f32_16x16x32_bf16 v[24:27], v[96:99], v[88:91], v[24:27]
v_mfma_f32_16x16x32_bf16 v[28:31], v[96:99], v[92:95], v[28:31]
v_mfma_f32_16x16x32_bf16 v[32:35], v[100:103], v[80:83], v[32:35]
v_mfma_f32_16x16x32_bf16 v[36:39], v[100:103], v[84:87], v[36:39]
v_mfma_f32_16x16x32_bf16 v[40:43], v[100:103], v[88:91], v[40:43]
v_mfma_f32_16x16x32_bf16 v[44:47], v[100:103], v[92:95], v[44:47]
v_mfma_f32_16x16x32_bf16 v[48:51], v[104:107], v[80:83], v[48:51]
v_mfma_f32_16x16x32_bf16 v[52:55], v[104:107], v[84:87], v[52:55]
v_mfma_f32_16x16x32_bf16 v[56:59], v[104:107], v[88:91], v[56:59]
v_mfma_f32_16x16x32_bf16 v[60:63], v[104:107], v[92:95], v[60:63]
v_mfma_f32_16x16x32_bf16 v[64:67], v[108:111], v[80:83], v[64:67]
v_mfma_f32_16x16x32_bf16 v[68:71], v[108:111], v[84:87], v[68:71]
v_mfma_f32_16x16x32_bf16 v[72:75], v[108:111], v[88:91], v[72:75]
v_mfma_f32_16x16x32_bf16 v[76:79], v[108:111], v[92:95], v[76:79]
s_waitcnt lgkmcnt(0)
s_barrier
v_mfma_f32_16x16x32_bf16 v[16:19], a[16:19], a[0:3], v[16:19]
ds_read_b64_tr_b16 a[80:81], v138 offset:0
ds_read_b64_tr_b16 a[82:83], v138 offset:2048
v_mfma_f32_16x16x32_bf16 v[20:23], a[16:19], a[4:7], v[20:23]
ds_read_b64_tr_b16 a[84:85], v139 offset:0
ds_read_b64_tr_b16 a[86:87], v139 offset:2048
v_mfma_f32_16x16x32_bf16 v[24:27], a[16:19], a[8:11], v[24:27]
ds_read_b64_tr_b16 a[88:89], v138 offset:8192
ds_read_b64_tr_b16 a[90:91], v138 offset:10240
v_mfma_f32_16x16x32_bf16 v[28:31], a[16:19], a[12:15], v[28:31]
ds_read_b64_tr_b16 a[92:93], v139 offset:8192
ds_read_b64_tr_b16 a[94:95], v139 offset:10240
v_mfma_f32_16x16x32_bf16 v[32:35], a[20:23], a[0:3], v[32:35]
ds_read_b128 a[64:67], v137 offset:0
ds_read_b128 a[68:71], v137 offset:2048
v_mfma_f32_16x16x32_bf16 v[36:39], a[20:23], a[4:7], v[36:39]
ds_read_b128 a[72:75], v137 offset:4096
ds_read_b128 a[76:79], v137 offset:6144
v_mfma_f32_16x16x32_bf16 v[40:43], a[20:23], a[8:11], v[40:43]
ds_read_b64_tr_b16 v[96:97], v138 offset:4096
ds_read_b64_tr_b16 v[98:99], v138 offset:6144
v_mfma_f32_16x16x32_bf16 v[44:47], a[20:23], a[12:15], v[44:47]
ds_read_b64_tr_b16 v[100:101], v139 offset:4096
ds_read_b64_tr_b16 v[102:103], v139 offset:6144
v_mfma_f32_16x16x32_bf16 v[48:51], a[24:27], a[0:3], v[48:51]
ds_read_b64_tr_b16 v[104:105], v138 offset:12288
ds_read_b64_tr_b16 v[106:107], v138 offset:14336
v_mfma_f32_16x16x32_bf16 v[52:55], a[24:27], a[4:7], v[52:55]
ds_read_b64_tr_b16 v[108:109], v139 offset:12288
ds_read_b64_tr_b16 v[110:111], v139 offset:14336
v_mfma_f32_16x16x32_bf16 v[56:59], a[24:27], a[8:11], v[56:59]
ds_read_b128 v[80:83], v137 offset:1024
ds_read_b128 v[84:87], v137 offset:3072
v_mfma_f32_16x16x32_bf16 v[60:63], a[24:27], a[12:15], v[60:63]
ds_read_b128 v[88:91], v137 offset:5120
ds_read_b128 v[92:95], v137 offset:7168
v_mfma_f32_16x16x32_bf16 v[64:67], a[28:31], a[0:3], v[64:67]
v_mfma_f32_16x16x32_bf16 v[68:71], a[28:31], a[4:7], v[68:71]
v_mfma_f32_16x16x32_bf16 v[72:75], a[28:31], a[8:11], v[72:75]
v_mfma_f32_16x16x32_bf16 v[76:79], a[28:31], a[12:15], v[76:79]
v_mfma_f32_16x16x32_bf16 v[16:19], a[48:51], a[32:35], v[16:19]
v_mfma_f32_16x16x32_bf16 v[20:23], a[48:51], a[36:39], v[20:23]
v_mfma_f32_16x16x32_bf16 v[24:27], a[48:51], a[40:43], v[24:27]
v_mfma_f32_16x16x32_bf16 v[28:31], a[48:51], a[44:47], v[28:31]
v_mfma_f32_16x16x32_bf16 v[32:35], a[52:55], a[32:35], v[32:35]
v_mfma_f32_16x16x32_bf16 v[36:39], a[52:55], a[36:39], v[36:39]
v_mfma_f32_16x16x32_bf16 v[40:43], a[52:55], a[40:43], v[40:43]
v_mfma_f32_16x16x32_bf16 v[44:47], a[52:55], a[44:47], v[44:47]
v_mfma_f32_16x16x32_bf16 v[48:51], a[56:59], a[32:35], v[48:51]
v_mfma_f32_16x16x32_bf16 v[52:55], a[56:59], a[36:39], v[52:55]
v_mfma_f32_16x16x32_bf16 v[56:59], a[56:59], a[40:43], v[56:59]
v_mfma_f32_16x16x32_bf16 v[60:63], a[56:59], a[44:47], v[60:63]
v_mfma_f32_16x16x32_bf16 v[64:67], a[60:63], a[32:35], v[64:67]
v_mfma_f32_16x16x32_bf16 v[68:71], a[60:63], a[36:39], v[68:71]
v_mfma_f32_16x16x32_bf16 v[72:75], a[60:63], a[40:43], v[72:75]
v_mfma_f32_16x16x32_bf16 v[76:79], a[60:63], a[44:47], v[76:79]
s_waitcnt lgkmcnt(0)
s_barrier
v_mfma_f32_16x16x32_bf16 v[16:19], a[80:83], a[64:67], v[16:19]
ds_read_b64_tr_b16 a[16:17], v129 offset:0
ds_read_b64_tr_b16 a[18:19], v129 offset:2048
v_mfma_f32_16x16x32_bf16 v[20:23], a[80:83], a[68:71], v[20:23]
ds_read_b64_tr_b16 a[20:21], v130 offset:0
ds_read_b64_tr_b16 a[22:23], v130 offset:2048
v_mfma_f32_16x16x32_bf16 v[24:27], a[80:83], a[72:75], v[24:27]
ds_read_b64_tr_b16 a[24:25], v129 offset:8192
ds_read_b64_tr_b16 a[26:27], v129 offset:10240
v_mfma_f32_16x16x32_bf16 v[28:31], a[80:83], a[76:79], v[28:31]
ds_read_b64_tr_b16 a[28:29], v130 offset:8192
ds_read_b64_tr_b16 a[30:31], v130 offset:10240
v_mfma_f32_16x16x32_bf16 v[32:35], a[84:87], a[64:67], v[32:35]
ds_read_b128 a[0:3], v128 offset:0
ds_read_b128 a[4:7], v128 offset:2048
v_mfma_f32_16x16x32_bf16 v[36:39], a[84:87], a[68:71], v[36:39]
ds_read_b128 a[8:11], v128 offset:4096
ds_read_b128 a[12:15], v128 offset:6144
v_mfma_f32_16x16x32_bf16 v[40:43], a[84:87], a[72:75], v[40:43]
ds_read_b64_tr_b16 a[48:49], v129 offset:4096
ds_read_b64_tr_b16 a[50:51], v129 offset:6144
v_mfma_f32_16x16x32_bf16 v[44:47], a[84:87], a[76:79], v[44:47]
ds_read_b64_tr_b16 a[52:53], v130 offset:4096
ds_read_b64_tr_b16 a[54:55], v130 offset:6144
v_mfma_f32_16x16x32_bf16 v[48:51], a[88:91], a[64:67], v[48:51]
ds_read_b64_tr_b16 a[56:57], v129 offset:12288
ds_read_b64_tr_b16 a[58:59], v129 offset:14336
v_mfma_f32_16x16x32_bf16 v[52:55], a[88:91], a[68:71], v[52:55]
ds_read_b64_tr_b16 a[60:61], v130 offset:12288
ds_read_b64_tr_b16 a[62:63], v130 offset:14336
v_mfma_f32_16x16x32_bf16 v[56:59], a[88:91], a[72:75], v[56:59]
ds_read_b128 a[32:35], v128 offset:1024
ds_read_b128 a[36:39], v128 offset:3072
v_mfma_f32_16x16x32_bf16 v[60:63], a[88:91], a[76:79], v[60:63]
ds_read_b128 a[40:43], v128 offset:5120
ds_read_b128 a[44:47], v128 offset:7168
v_mfma_f32_16x16x32_bf16 v[64:67], a[92:95], a[64:67], v[64:67]
v_mfma_f32_16x16x32_bf16 v[68:71], a[92:95], a[68:71], v[68:71]
v_mfma_f32_16x16x32_bf16 v[72:75], a[92:95], a[72:75], v[72:75]
v_mfma_f32_16x16x32_bf16 v[76:79], a[92:95], a[76:79], v[76:79]
v_mfma_f32_16x16x32_bf16 v[16:19], v[96:99], v[80:83], v[16:19]
v_mfma_f32_16x16x32_bf16 v[20:23], v[96:99], v[84:87], v[20:23]
v_mfma_f32_16x16x32_bf16 v[24:27], v[96:99], v[88:91], v[24:27]
v_mfma_f32_16x16x32_bf16 v[28:31], v[96:99], v[92:95], v[28:31]
v_mfma_f32_16x16x32_bf16 v[32:35], v[100:103], v[80:83], v[32:35]
v_mfma_f32_16x16x32_bf16 v[36:39], v[100:103], v[84:87], v[36:39]
v_mfma_f32_16x16x32_bf16 v[40:43], v[100:103], v[88:91], v[40:43]
v_mfma_f32_16x16x32_bf16 v[44:47], v[100:103], v[92:95], v[44:47]
v_mfma_f32_16x16x32_bf16 v[48:51], v[104:107], v[80:83], v[48:51]
v_mfma_f32_16x16x32_bf16 v[52:55], v[104:107], v[84:87], v[52:55]
v_mfma_f32_16x16x32_bf16 v[56:59], v[104:107], v[88:91], v[56:59]
v_mfma_f32_16x16x32_bf16 v[60:63], v[104:107], v[92:95], v[60:63]
v_mfma_f32_16x16x32_bf16 v[64:67], v[108:111], v[80:83], v[64:67]
v_mfma_f32_16x16x32_bf16 v[68:71], v[108:111], v[84:87], v[68:71]
v_mfma_f32_16x16x32_bf16 v[72:75], v[108:111], v[88:91], v[72:75]
v_mfma_f32_16x16x32_bf16 v[76:79], v[108:111], v[92:95], v[76:79]
s_waitcnt lgkmcnt(0)
s_barrier
v_mfma_f32_16x16x32_bf16 v[16:19], a[16:19], a[0:3], v[16:19]
ds_read_b64_tr_b16 a[80:81], v132 offset:0
ds_read_b64_tr_b16 a[82:83], v132 offset:2048
v_mfma_f32_16x16x32_bf16 v[20:23], a[16:19], a[4:7], v[20:23]
ds_read_b64_tr_b16 a[84:85], v133 offset:0
ds_read_b64_tr_b16 a[86:87], v133 offset:2048
v_mfma_f32_16x16x32_bf16 v[24:27], a[16:19], a[8:11], v[24:27]
ds_read_b64_tr_b16 a[88:89], v132 offset:8192
ds_read_b64_tr_b16 a[90:91], v132 offset:10240
v_mfma_f32_16x16x32_bf16 v[28:31], a[16:19], a[12:15], v[28:31]
ds_read_b64_tr_b16 a[92:93], v133 offset:8192
ds_read_b64_tr_b16 a[94:95], v133 offset:10240
v_mfma_f32_16x16x32_bf16 v[32:35], a[20:23], a[0:3], v[32:35]
ds_read_b128 a[64:67], v131 offset:0
ds_read_b128 a[68:71], v131 offset:2048
v_mfma_f32_16x16x32_bf16 v[36:39], a[20:23], a[4:7], v[36:39]
ds_read_b128 a[72:75], v131 offset:4096
ds_read_b128 a[76:79], v131 offset:6144
v_mfma_f32_16x16x32_bf16 v[40:43], a[20:23], a[8:11], v[40:43]
ds_read_b64_tr_b16 v[96:97], v132 offset:4096
ds_read_b64_tr_b16 v[98:99], v132 offset:6144
v_mfma_f32_16x16x32_bf16 v[44:47], a[20:23], a[12:15], v[44:47]
ds_read_b64_tr_b16 v[100:101], v133 offset:4096
ds_read_b64_tr_b16 v[102:103], v133 offset:6144
v_mfma_f32_16x16x32_bf16 v[48:51], a[24:27], a[0:3], v[48:51]
ds_read_b64_tr_b16 v[104:105], v132 offset:12288
ds_read_b64_tr_b16 v[106:107], v132 offset:14336
v_mfma_f32_16x16x32_bf16 v[52:55], a[24:27], a[4:7], v[52:55]
ds_read_b64_tr_b16 v[108:109], v133 offset:12288
ds_read_b64_tr_b16 v[110:111], v133 offset:14336
v_mfma_f32_16x16x32_bf16 v[56:59], a[24:27], a[8:11], v[56:59]
ds_read_b128 v[80:83], v131 offset:1024
ds_read_b128 v[84:87], v131 offset:3072
v_mfma_f32_16x16x32_bf16 v[60:63], a[24:27], a[12:15], v[60:63]
ds_read_b128 v[88:91], v131 offset:5120
ds_read_b128 v[92:95], v131 offset:7168
v_mfma_f32_16x16x32_bf16 v[64:67], a[28:31], a[0:3], v[64:67]
v_mfma_f32_16x16x32_bf16 v[68:71], a[28:31], a[4:7], v[68:71]
v_mfma_f32_16x16x32_bf16 v[72:75], a[28:31], a[8:11], v[72:75]
v_mfma_f32_16x16x32_bf16 v[76:79], a[28:31], a[12:15], v[76:79]
v_mfma_f32_16x16x32_bf16 v[16:19], a[48:51], a[32:35], v[16:19]
v_mfma_f32_16x16x32_bf16 v[20:23], a[48:51], a[36:39], v[20:23]
v_mfma_f32_16x16x32_bf16 v[24:27], a[48:51], a[40:43], v[24:27]
v_mfma_f32_16x16x32_bf16 v[28:31], a[48:51], a[44:47], v[28:31]
v_mfma_f32_16x16x32_bf16 v[32:35], a[52:55], a[32:35], v[32:35]
v_mfma_f32_16x16x32_bf16 v[36:39], a[52:55], a[36:39], v[36:39]
v_mfma_f32_16x16x32_bf16 v[40:43], a[52:55], a[40:43], v[40:43]
v_mfma_f32_16x16x32_bf16 v[44:47], a[52:55], a[44:47], v[44:47]
v_mfma_f32_16x16x32_bf16 v[48:51], a[56:59], a[32:35], v[48:51]
v_mfma_f32_16x16x32_bf16 v[52:55], a[56:59], a[36:39], v[52:55]
v_mfma_f32_16x16x32_bf16 v[56:59], a[56:59], a[40:43], v[56:59]
v_mfma_f32_16x16x32_bf16 v[60:63], a[56:59], a[44:47], v[60:63]
v_mfma_f32_16x16x32_bf16 v[64:67], a[60:63], a[32:35], v[64:67]
v_mfma_f32_16x16x32_bf16 v[68:71], a[60:63], a[36:39], v[68:71]
v_mfma_f32_16x16x32_bf16 v[72:75], a[60:63], a[40:43], v[72:75]
v_mfma_f32_16x16x32_bf16 v[76:79], a[60:63], a[44:47], v[76:79]
s_waitcnt lgkmcnt(0)
s_barrier
v_mfma_f32_16x16x32_bf16 v[16:19], a[80:83], a[64:67], v[16:19]
ds_read_b64_tr_b16 a[16:17], v135 offset:0
ds_read_b64_tr_b16 a[18:19], v135 offset:2048
v_mfma_f32_16x16x32_bf16 v[20:23], a[80:83], a[68:71], v[20:23]
ds_read_b64_tr_b16 a[20:21], v136 offset:0
ds_read_b64_tr_b16 a[22:23], v136 offset:2048
v_mfma_f32_16x16x32_bf16 v[24:27], a[80:83], a[72:75], v[24:27]
ds_read_b64_tr_b16 a[24:25], v135 offset:8192
ds_read_b64_tr_b16 a[26:27], v135 offset:10240
v_mfma_f32_16x16x32_bf16 v[28:31], a[80:83], a[76:79], v[28:31]
ds_read_b64_tr_b16 a[28:29], v136 offset:8192
ds_read_b64_tr_b16 a[30:31], v136 offset:10240
v_mfma_f32_16x16x32_bf16 v[32:35], a[84:87], a[64:67], v[32:35]
ds_read_b128 a[0:3], v134 offset:0
ds_read_b128 a[4:7], v134 offset:2048
v_mfma_f32_16x16x32_bf16 v[36:39], a[84:87], a[68:71], v[36:39]
ds_read_b128 a[8:11], v134 offset:4096
ds_read_b128 a[12:15], v134 offset:6144
v_mfma_f32_16x16x32_bf16 v[40:43], a[84:87], a[72:75], v[40:43]
ds_read_b64_tr_b16 a[48:49], v135 offset:4096
ds_read_b64_tr_b16 a[50:51], v135 offset:6144
v_mfma_f32_16x16x32_bf16 v[44:47], a[84:87], a[76:79], v[44:47]
ds_read_b64_tr_b16 a[52:53], v136 offset:4096
ds_read_b64_tr_b16 a[54:55], v136 offset:6144
v_mfma_f32_16x16x32_bf16 v[48:51], a[88:91], a[64:67], v[48:51]
ds_read_b64_tr_b16 a[56:57], v135 offset:12288
ds_read_b64_tr_b16 a[58:59], v135 offset:14336
v_mfma_f32_16x16x32_bf16 v[52:55], a[88:91], a[68:71], v[52:55]
ds_read_b64_tr_b16 a[60:61], v136 offset:12288
ds_read_b64_tr_b16 a[62:63], v136 offset:14336
v_mfma_f32_16x16x32_bf16 v[56:59], a[88:91], a[72:75], v[56:59]
ds_read_b128 a[32:35], v134 offset:1024
ds_read_b128 a[36:39], v134 offset:3072
v_mfma_f32_16x16x32_bf16 v[60:63], a[88:91], a[76:79], v[60:63]
ds_read_b128 a[40:43], v134 offset:5120
ds_read_b128 a[44:47], v134 offset:7168
v_mfma_f32_16x16x32_bf16 v[64:67], a[92:95], a[64:67], v[64:67]
v_mfma_f32_16x16x32_bf16 v[68:71], a[92:95], a[68:71], v[68:71]
v_mfma_f32_16x16x32_bf16 v[72:75], a[92:95], a[72:75], v[72:75]
v_mfma_f32_16x16x32_bf16 v[76:79], a[92:95], a[76:79], v[76:79]
v_mfma_f32_16x16x32_bf16 v[16:19], v[96:99], v[80:83], v[16:19]
v_mfma_f32_16x16x32_bf16 v[20:23], v[96:99], v[84:87], v[20:23]
v_mfma_f32_16x16x32_bf16 v[24:27], v[96:99], v[88:91], v[24:27]
v_mfma_f32_16x16x32_bf16 v[28:31], v[96:99], v[92:95], v[28:31]
v_mfma_f32_16x16x32_bf16 v[32:35], v[100:103], v[80:83], v[32:35]
v_mfma_f32_16x16x32_bf16 v[36:39], v[100:103], v[84:87], v[36:39]
v_mfma_f32_16x16x32_bf16 v[40:43], v[100:103], v[88:91], v[40:43]
v_mfma_f32_16x16x32_bf16 v[44:47], v[100:103], v[92:95], v[44:47]
v_mfma_f32_16x16x32_bf16 v[48:51], v[104:107], v[80:83], v[48:51]
v_mfma_f32_16x16x32_bf16 v[52:55], v[104:107], v[84:87], v[52:55]
v_mfma_f32_16x16x32_bf16 v[56:59], v[104:107], v[88:91], v[56:59]
v_mfma_f32_16x16x32_bf16 v[60:63], v[104:107], v[92:95], v[60:63]
v_mfma_f32_16x16x32_bf16 v[64:67], v[108:111], v[80:83], v[64:67]
v_mfma_f32_16x16x32_bf16 v[68:71], v[108:111], v[84:87], v[68:71]
v_mfma_f32_16x16x32_bf16 v[72:75], v[108:111], v[88:91], v[72:75]
v_mfma_f32_16x16x32_bf16 v[76:79], v[108:111], v[92:95], v[76:79]
s_waitcnt lgkmcnt(0)
s_barrier
v_mfma_f32_16x16x32_bf16 v[16:19], a[16:19], a[0:3], v[16:19]
ds_read_b64_tr_b16 a[80:81], v138 offset:0
ds_read_b64_tr_b16 a[82:83], v138 offset:2048
v_mfma_f32_16x16x32_bf16 v[20:23], a[16:19], a[4:7], v[20:23]
ds_read_b64_tr_b16 a[84:85], v139 offset:0
ds_read_b64_tr_b16 a[86:87], v139 offset:2048
v_mfma_f32_16x16x32_bf16 v[24:27], a[16:19], a[8:11], v[24:27]
ds_read_b64_tr_b16 a[88:89], v138 offset:8192
ds_read_b64_tr_b16 a[90:91], v138 offset:10240
v_mfma_f32_16x16x32_bf16 v[28:31], a[16:19], a[12:15], v[28:31]
ds_read_b64_tr_b16 a[92:93], v139 offset:8192
ds_read_b64_tr_b16 a[94:95], v139 offset:10240
v_mfma_f32_16x16x32_bf16 v[32:35], a[20:23], a[0:3], v[32:35]
ds_read_b128 a[64:67], v137 offset:0
ds_read_b128 a[68:71], v137 offset:2048
v_mfma_f32_16x16x32_bf16 v[36:39], a[20:23], a[4:7], v[36:39]
ds_read_b128 a[72:75], v137 offset:4096
ds_read_b128 a[76:79], v137 offset:6144
v_mfma_f32_16x16x32_bf16 v[40:43], a[20:23], a[8:11], v[40:43]
ds_read_b64_tr_b16 v[96:97], v138 offset:4096
ds_read_b64_tr_b16 v[98:99], v138 offset:6144
v_mfma_f32_16x16x32_bf16 v[44:47], a[20:23], a[12:15], v[44:47]
ds_read_b64_tr_b16 v[100:101], v139 offset:4096
ds_read_b64_tr_b16 v[102:103], v139 offset:6144
v_mfma_f32_16x16x32_bf16 v[48:51], a[24:27], a[0:3], v[48:51]
ds_read_b64_tr_b16 v[104:105], v138 offset:12288
ds_read_b64_tr_b16 v[106:107], v138 offset:14336
v_mfma_f32_16x16x32_bf16 v[52:55], a[24:27], a[4:7], v[52:55]
ds_read_b64_tr_b16 v[108:109], v139 offset:12288
ds_read_b64_tr_b16 v[110:111], v139 offset:14336
v_mfma_f32_16x16x32_bf16 v[56:59], a[24:27], a[8:11], v[56:59]
ds_read_b128 v[80:83], v137 offset:1024
ds_read_b128 v[84:87], v137 offset:3072
v_mfma_f32_16x16x32_bf16 v[60:63], a[24:27], a[12:15], v[60:63]
ds_read_b128 v[88:91], v137 offset:5120
ds_read_b128 v[92:95], v137 offset:7168
v_mfma_f32_16x16x32_bf16 v[64:67], a[28:31], a[0:3], v[64:67]
v_mfma_f32_16x16x32_bf16 v[68:71], a[28:31], a[4:7], v[68:71]
v_mfma_f32_16x16x32_bf16 v[72:75], a[28:31], a[8:11], v[72:75]
v_mfma_f32_16x16x32_bf16 v[76:79], a[28:31], a[12:15], v[76:79]
v_mfma_f32_16x16x32_bf16 v[16:19], a[48:51], a[32:35], v[16:19]
v_mfma_f32_16x16x32_bf16 v[20:23], a[48:51], a[36:39], v[20:23]
v_mfma_f32_16x16x32_bf16 v[24:27], a[48:51], a[40:43], v[24:27]
v_mfma_f32_16x16x32_bf16 v[28:31], a[48:51], a[44:47], v[28:31]
v_mfma_f32_16x16x32_bf16 v[32:35], a[52:55], a[32:35], v[32:35]
v_mfma_f32_16x16x32_bf16 v[36:39], a[52:55], a[36:39], v[36:39]
v_mfma_f32_16x16x32_bf16 v[40:43], a[52:55], a[40:43], v[40:43]
v_mfma_f32_16x16x32_bf16 v[44:47], a[52:55], a[44:47], v[44:47]
v_mfma_f32_16x16x32_bf16 v[48:51], a[56:59], a[32:35], v[48:51]
v_mfma_f32_16x16x32_bf16 v[52:55], a[56:59], a[36:39], v[52:55]
v_mfma_f32_16x16x32_bf16 v[56:59], a[56:59], a[40:43], v[56:59]
v_mfma_f32_16x16x32_bf16 v[60:63], a[56:59], a[44:47], v[60:63]
v_mfma_f32_16x16x32_bf16 v[64:67], a[60:63], a[32:35], v[64:67]
v_mfma_f32_16x16x32_bf16 v[68:71], a[60:63], a[36:39], v[68:71]
v_mfma_f32_16x16x32_bf16 v[72:75], a[60:63], a[40:43], v[72:75]
v_mfma_f32_16x16x32_bf16 v[76:79], a[60:63], a[44:47], v[76:79]
s_waitcnt lgkmcnt(0)
s_barrier
v_mfma_f32_16x16x32_bf16 v[16:19], a[80:83], a[64:67], v[16:19]
ds_read_b64_tr_b16 a[16:17], v129 offset:0
ds_read_b64_tr_b16 a[18:19], v129 offset:2048
v_mfma_f32_16x16x32_bf16 v[20:23], a[80:83], a[68:71], v[20:23]
ds_read_b64_tr_b16 a[20:21], v130 offset:0
ds_read_b64_tr_b16 a[22:23], v130 offset:2048
v_mfma_f32_16x16x32_bf16 v[24:27], a[80:83], a[72:75], v[24:27]
ds_read_b64_tr_b16 a[24:25], v129 offset:8192
ds_read_b64_tr_b16 a[26:27], v129 offset:10240
v_mfma_f32_16x16x32_bf16 v[28:31], a[80:83], a[76:79], v[28:31]
ds_read_b64_tr_b16 a[28:29], v130 offset:8192
ds_read_b64_tr_b16 a[30:31], v130 offset:10240
v_mfma_f32_16x16x32_bf16 v[32:35], a[84:87], a[64:67], v[32:35]
ds_read_b128 a[0:3], v128 offset:0
ds_read_b128 a[4:7], v128 offset:2048
v_mfma_f32_16x16x32_bf16 v[36:39], a[84:87], a[68:71], v[36:39]
ds_read_b128 a[8:11], v128 offset:4096
ds_read_b128 a[12:15], v128 offset:6144
v_mfma_f32_16x16x32_bf16 v[40:43], a[84:87], a[72:75], v[40:43]
ds_read_b64_tr_b16 a[48:49], v129 offset:4096
ds_read_b64_tr_b16 a[50:51], v129 offset:6144
v_mfma_f32_16x16x32_bf16 v[44:47], a[84:87], a[76:79], v[44:47]
ds_read_b64_tr_b16 a[52:53], v130 offset:4096
ds_read_b64_tr_b16 a[54:55], v130 offset:6144
v_mfma_f32_16x16x32_bf16 v[48:51], a[88:91], a[64:67], v[48:51]
ds_read_b64_tr_b16 a[56:57], v129 offset:12288
ds_read_b64_tr_b16 a[58:59], v129 offset:14336
v_mfma_f32_16x16x32_bf16 v[52:55], a[88:91], a[68:71], v[52:55]
ds_read_b64_tr_b16 a[60:61], v130 offset:12288
ds_read_b64_tr_b16 a[62:63], v130 offset:14336
v_mfma_f32_16x16x32_bf16 v[56:59], a[88:91], a[72:75], v[56:59]
ds_read_b128 a[32:35], v128 offset:1024
ds_read_b128 a[36:39], v128 offset:3072
v_mfma_f32_16x16x32_bf16 v[60:63], a[88:91], a[76:79], v[60:63]
ds_read_b128 a[40:43], v128 offset:5120
ds_read_b128 a[44:47], v128 offset:7168
v_mfma_f32_16x16x32_bf16 v[64:67], a[92:95], a[64:67], v[64:67]
v_mfma_f32_16x16x32_bf16 v[68:71], a[92:95], a[68:71], v[68:71]
v_mfma_f32_16x16x32_bf16 v[72:75], a[92:95], a[72:75], v[72:75]
v_mfma_f32_16x16x32_bf16 v[76:79], a[92:95], a[76:79], v[76:79]
v_mfma_f32_16x16x32_bf16 v[16:19], v[96:99], v[80:83], v[16:19]
v_mfma_f32_16x16x32_bf16 v[20:23], v[96:99], v[84:87], v[20:23]
v_mfma_f32_16x16x32_bf16 v[24:27], v[96:99], v[88:91], v[24:27]
v_mfma_f32_16x16x32_bf16 v[28:31], v[96:99], v[92:95], v[28:31]
v_mfma_f32_16x16x32_bf16 v[32:35], v[100:103], v[80:83], v[32:35]
v_mfma_f32_16x16x32_bf16 v[36:39], v[100:103], v[84:87], v[36:39]
v_mfma_f32_16x16x32_bf16 v[40:43], v[100:103], v[88:91], v[40:43]
v_mfma_f32_16x16x32_bf16 v[44:47], v[100:103], v[92:95], v[44:47]
v_mfma_f32_16x16x32_bf16 v[48:51], v[104:107], v[80:83], v[48:51]
v_mfma_f32_16x16x32_bf16 v[52:55], v[104:107], v[84:87], v[52:55]
v_mfma_f32_16x16x32_bf16 v[56:59], v[104:107], v[88:91], v[56:59]
v_mfma_f32_16x16x32_bf16 v[60:63], v[104:107], v[92:95], v[60:63]
v_mfma_f32_16x16x32_bf16 v[64:67], v[108:111], v[80:83], v[64:67]
v_mfma_f32_16x16x32_bf16 v[68:71], v[108:111], v[84:87], v[68:71]
v_mfma_f32_16x16x32_bf16 v[72:75], v[108:111], v[88:91], v[72:75]
v_mfma_f32_16x16x32_bf16 v[76:79], v[108:111], v[92:95], v[76:79]
s_waitcnt lgkmcnt(0)
s_barrier
v_mfma_f32_16x16x32_bf16 v[16:19], a[16:19], a[0:3], v[16:19]
ds_read_b64_tr_b16 a[80:81], v132 offset:0
ds_read_b64_tr_b16 a[82:83], v132 offset:2048
v_mfma_f32_16x16x32_bf16 v[20:23], a[16:19], a[4:7], v[20:23]
ds_read_b64_tr_b16 a[84:85], v133 offset:0
ds_read_b64_tr_b16 a[86:87], v133 offset:2048
v_mfma_f32_16x16x32_bf16 v[24:27], a[16:19], a[8:11], v[24:27]
ds_read_b64_tr_b16 a[88:89], v132 offset:8192
ds_read_b64_tr_b16 a[90:91], v132 offset:10240
v_mfma_f32_16x16x32_bf16 v[28:31], a[16:19], a[12:15], v[28:31]
ds_read_b64_tr_b16 a[92:93], v133 offset:8192
ds_read_b64_tr_b16 a[94:95], v133 offset:10240
v_mfma_f32_16x16x32_bf16 v[32:35], a[20:23], a[0:3], v[32:35]
ds_read_b128 a[64:67], v131 offset:0
ds_read_b128 a[68:71], v131 offset:2048
v_mfma_f32_16x16x32_bf16 v[36:39], a[20:23], a[4:7], v[36:39]
ds_read_b128 a[72:75], v131 offset:4096
ds_read_b128 a[76:79], v131 offset:6144
v_mfma_f32_16x16x32_bf16 v[40:43], a[20:23], a[8:11], v[40:43]
ds_read_b64_tr_b16 v[96:97], v132 offset:4096
ds_read_b64_tr_b16 v[98:99], v132 offset:6144
v_mfma_f32_16x16x32_bf16 v[44:47], a[20:23], a[12:15], v[44:47]
ds_read_b64_tr_b16 v[100:101], v133 offset:4096
ds_read_b64_tr_b16 v[102:103], v133 offset:6144
v_mfma_f32_16x16x32_bf16 v[48:51], a[24:27], a[0:3], v[48:51]
ds_read_b64_tr_b16 v[104:105], v132 offset:12288
ds_read_b64_tr_b16 v[106:107], v132 offset:14336
v_mfma_f32_16x16x32_bf16 v[52:55], a[24:27], a[4:7], v[52:55]
ds_read_b64_tr_b16 v[108:109], v133 offset:12288
ds_read_b64_tr_b16 v[110:111], v133 offset:14336
v_mfma_f32_16x16x32_bf16 v[56:59], a[24:27], a[8:11], v[56:59]
ds_read_b128 v[80:83], v131 offset:1024
ds_read_b128 v[84:87], v131 offset:3072
v_mfma_f32_16x16x32_bf16 v[60:63], a[24:27], a[12:15], v[60:63]
ds_read_b128 v[88:91], v131 offset:5120
ds_read_b128 v[92:95], v131 offset:7168
v_mfma_f32_16x16x32_bf16 v[64:67], a[28:31], a[0:3], v[64:67]
v_mfma_f32_16x16x32_bf16 v[68:71], a[28:31], a[4:7], v[68:71]
v_mfma_f32_16x16x32_bf16 v[72:75], a[28:31], a[8:11], v[72:75]
v_mfma_f32_16x16x32_bf16 v[76:79], a[28:31], a[12:15], v[76:79]
v_mfma_f32_16x16x32_bf16 v[16:19], a[48:51], a[32:35], v[16:19]
v_mfma_f32_16x16x32_bf16 v[20:23], a[48:51], a[36:39], v[20:23]
v_mfma_f32_16x16x32_bf16 v[24:27], a[48:51], a[40:43], v[24:27]
v_mfma_f32_16x16x32_bf16 v[28:31], a[48:51], a[44:47], v[28:31]
v_mfma_f32_16x16x32_bf16 v[32:35], a[52:55], a[32:35], v[32:35]
v_mfma_f32_16x16x32_bf16 v[36:39], a[52:55], a[36:39], v[36:39]
v_mfma_f32_16x16x32_bf16 v[40:43], a[52:55], a[40:43], v[40:43]
v_mfma_f32_16x16x32_bf16 v[44:47], a[52:55], a[44:47], v[44:47]
v_mfma_f32_16x16x32_bf16 v[48:51], a[56:59], a[32:35], v[48:51]
v_mfma_f32_16x16x32_bf16 v[52:55], a[56:59], a[36:39], v[52:55]
v_mfma_f32_16x16x32_bf16 v[56:59], a[56:59], a[40:43], v[56:59]
v_mfma_f32_16x16x32_bf16 v[60:63], a[56:59], a[44:47], v[60:63]
v_mfma_f32_16x16x32_bf16 v[64:67], a[60:63], a[32:35], v[64:67]
v_mfma_f32_16x16x32_bf16 v[68:71], a[60:63], a[36:39], v[68:71]
v_mfma_f32_16x16x32_bf16 v[72:75], a[60:63], a[40:43], v[72:75]
v_mfma_f32_16x16x32_bf16 v[76:79], a[60:63], a[44:47], v[76:79]
s_waitcnt lgkmcnt(0)
s_barrier
v_mfma_f32_16x16x32_bf16 v[16:19], a[80:83], a[64:67], v[16:19]
ds_read_b64_tr_b16 a[16:17], v135 offset:0
ds_read_b64_tr_b16 a[18:19], v135 offset:2048
v_mfma_f32_16x16x32_bf16 v[20:23], a[80:83], a[68:71], v[20:23]
ds_read_b64_tr_b16 a[20:21], v136 offset:0
ds_read_b64_tr_b16 a[22:23], v136 offset:2048
v_mfma_f32_16x16x32_bf16 v[24:27], a[80:83], a[72:75], v[24:27]
ds_read_b64_tr_b16 a[24:25], v135 offset:8192
ds_read_b64_tr_b16 a[26:27], v135 offset:10240
v_mfma_f32_16x16x32_bf16 v[28:31], a[80:83], a[76:79], v[28:31]
ds_read_b64_tr_b16 a[28:29], v136 offset:8192
ds_read_b64_tr_b16 a[30:31], v136 offset:10240
v_mfma_f32_16x16x32_bf16 v[32:35], a[84:87], a[64:67], v[32:35]
ds_read_b128 a[0:3], v134 offset:0
ds_read_b128 a[4:7], v134 offset:2048
v_mfma_f32_16x16x32_bf16 v[36:39], a[84:87], a[68:71], v[36:39]
ds_read_b128 a[8:11], v134 offset:4096
ds_read_b128 a[12:15], v134 offset:6144
v_mfma_f32_16x16x32_bf16 v[40:43], a[84:87], a[72:75], v[40:43]
ds_read_b64_tr_b16 a[48:49], v135 offset:4096
ds_read_b64_tr_b16 a[50:51], v135 offset:6144
v_mfma_f32_16x16x32_bf16 v[44:47], a[84:87], a[76:79], v[44:47]
ds_read_b64_tr_b16 a[52:53], v136 offset:4096
ds_read_b64_tr_b16 a[54:55], v136 offset:6144
v_mfma_f32_16x16x32_bf16 v[48:51], a[88:91], a[64:67], v[48:51]
ds_read_b64_tr_b16 a[56:57], v135 offset:12288
ds_read_b64_tr_b16 a[58:59], v135 offset:14336
v_mfma_f32_16x16x32_bf16 v[52:55], a[88:91], a[68:71], v[52:55]
ds_read_b64_tr_b16 a[60:61], v136 offset:12288
ds_read_b64_tr_b16 a[62:63], v136 offset:14336
v_mfma_f32_16x16x32_bf16 v[56:59], a[88:91], a[72:75], v[56:59]
ds_read_b128 a[32:35], v134 offset:1024
ds_read_b128 a[36:39], v134 offset:3072
v_mfma_f32_16x16x32_bf16 v[60:63], a[88:91], a[76:79], v[60:63]
ds_read_b128 a[40:43], v134 offset:5120
ds_read_b128 a[44:47], v134 offset:7168
v_mfma_f32_16x16x32_bf16 v[64:67], a[92:95], a[64:67], v[64:67]
v_mfma_f32_16x16x32_bf16 v[68:71], a[92:95], a[68:71], v[68:71]
v_mfma_f32_16x16x32_bf16 v[72:75], a[92:95], a[72:75], v[72:75]
v_mfma_f32_16x16x32_bf16 v[76:79], a[92:95], a[76:79], v[76:79]
v_mfma_f32_16x16x32_bf16 v[16:19], v[96:99], v[80:83], v[16:19]
v_mfma_f32_16x16x32_bf16 v[20:23], v[96:99], v[84:87], v[20:23]
v_mfma_f32_16x16x32_bf16 v[24:27], v[96:99], v[88:91], v[24:27]
v_mfma_f32_16x16x32_bf16 v[28:31], v[96:99], v[92:95], v[28:31]
v_mfma_f32_16x16x32_bf16 v[32:35], v[100:103], v[80:83], v[32:35]
v_mfma_f32_16x16x32_bf16 v[36:39], v[100:103], v[84:87], v[36:39]
v_mfma_f32_16x16x32_bf16 v[40:43], v[100:103], v[88:91], v[40:43]
v_mfma_f32_16x16x32_bf16 v[44:47], v[100:103], v[92:95], v[44:47]
v_mfma_f32_16x16x32_bf16 v[48:51], v[104:107], v[80:83], v[48:51]
v_mfma_f32_16x16x32_bf16 v[52:55], v[104:107], v[84:87], v[52:55]
v_mfma_f32_16x16x32_bf16 v[56:59], v[104:107], v[88:91], v[56:59]
v_mfma_f32_16x16x32_bf16 v[60:63], v[104:107], v[92:95], v[60:63]
v_mfma_f32_16x16x32_bf16 v[64:67], v[108:111], v[80:83], v[64:67]
v_mfma_f32_16x16x32_bf16 v[68:71], v[108:111], v[84:87], v[68:71]
v_mfma_f32_16x16x32_bf16 v[72:75], v[108:111], v[88:91], v[72:75]
v_mfma_f32_16x16x32_bf16 v[76:79], v[108:111], v[92:95], v[76:79]
s_waitcnt lgkmcnt(0)
s_barrier
v_mfma_f32_16x16x32_bf16 v[16:19], a[16:19], a[0:3], v[16:19]
ds_read_b64_tr_b16 a[80:81], v138 offset:0
ds_read_b64_tr_b16 a[82:83], v138 offset:2048
v_mfma_f32_16x16x32_bf16 v[20:23], a[16:19], a[4:7], v[20:23]
ds_read_b64_tr_b16 a[84:85], v139 offset:0
ds_read_b64_tr_b16 a[86:87], v139 offset:2048
v_mfma_f32_16x16x32_bf16 v[24:27], a[16:19], a[8:11], v[24:27]
ds_read_b64_tr_b16 a[88:89], v138 offset:8192
ds_read_b64_tr_b16 a[90:91], v138 offset:10240
v_mfma_f32_16x16x32_bf16 v[28:31], a[16:19], a[12:15], v[28:31]
ds_read_b64_tr_b16 a[92:93], v139 offset:8192
ds_read_b64_tr_b16 a[94:95], v139 offset:10240
v_mfma_f32_16x16x32_bf16 v[32:35], a[20:23], a[0:3], v[32:35]
ds_read_b128 a[64:67], v137 offset:0
ds_read_b128 a[68:71], v137 offset:2048
v_mfma_f32_16x16x32_bf16 v[36:39], a[20:23], a[4:7], v[36:39]
ds_read_b128 a[72:75], v137 offset:4096
ds_read_b128 a[76:79], v137 offset:6144
v_mfma_f32_16x16x32_bf16 v[40:43], a[20:23], a[8:11], v[40:43]
ds_read_b64_tr_b16 v[96:97], v138 offset:4096
ds_read_b64_tr_b16 v[98:99], v138 offset:6144
v_mfma_f32_16x16x32_bf16 v[44:47], a[20:23], a[12:15], v[44:47]
ds_read_b64_tr_b16 v[100:101], v139 offset:4096
ds_read_b64_tr_b16 v[102:103], v139 offset:6144
v_mfma_f32_16x16x32_bf16 v[48:51], a[24:27], a[0:3], v[48:51]
ds_read_b64_tr_b16 v[104:105], v138 offset:12288
ds_read_b64_tr_b16 v[106:107], v138 offset:14336
v_mfma_f32_16x16x32_bf16 v[52:55], a[24:27], a[4:7], v[52:55]
ds_read_b64_tr_b16 v[108:109], v139 offset:12288
ds_read_b64_tr_b16 v[110:111], v139 offset:14336
v_mfma_f32_16x16x32_bf16 v[56:59], a[24:27], a[8:11], v[56:59]
ds_read_b128 v[80:83], v137 offset:1024
ds_read_b128 v[84:87], v137 offset:3072
v_mfma_f32_16x16x32_bf16 v[60:63], a[24:27], a[12:15], v[60:63]
ds_read_b128 v[88:91], v137 offset:5120
ds_read_b128 v[92:95], v137 offset:7168
v_mfma_f32_16x16x32_bf16 v[64:67], a[28:31], a[0:3], v[64:67]
v_mfma_f32_16x16x32_bf16 v[68:71], a[28:31], a[4:7], v[68:71]
v_mfma_f32_16x16x32_bf16 v[72:75], a[28:31], a[8:11], v[72:75]
v_mfma_f32_16x16x32_bf16 v[76:79], a[28:31], a[12:15], v[76:79]
v_mfma_f32_16x16x32_bf16 v[16:19], a[48:51], a[32:35], v[16:19]
v_mfma_f32_16x16x32_bf16 v[20:23], a[48:51], a[36:39], v[20:23]
v_mfma_f32_16x16x32_bf16 v[24:27], a[48:51], a[40:43], v[24:27]
v_mfma_f32_16x16x32_bf16 v[28:31], a[48:51], a[44:47], v[28:31]
v_mfma_f32_16x16x32_bf16 v[32:35], a[52:55], a[32:35], v[32:35]
v_mfma_f32_16x16x32_bf16 v[36:39], a[52:55], a[36:39], v[36:39]
v_mfma_f32_16x16x32_bf16 v[40:43], a[52:55], a[40:43], v[40:43]
v_mfma_f32_16x16x32_bf16 v[44:47], a[52:55], a[44:47], v[44:47]
v_mfma_f32_16x16x32_bf16 v[48:51], a[56:59], a[32:35], v[48:51]
v_mfma_f32_16x16x32_bf16 v[52:55], a[56:59], a[36:39], v[52:55]
v_mfma_f32_16x16x32_bf16 v[56:59], a[56:59], a[40:43], v[56:59]
v_mfma_f32_16x16x32_bf16 v[60:63], a[56:59], a[44:47], v[60:63]
v_mfma_f32_16x16x32_bf16 v[64:67], a[60:63], a[32:35], v[64:67]
v_mfma_f32_16x16x32_bf16 v[68:71], a[60:63], a[36:39], v[68:71]
v_mfma_f32_16x16x32_bf16 v[72:75], a[60:63], a[40:43], v[72:75]
v_mfma_f32_16x16x32_bf16 v[76:79], a[60:63], a[44:47], v[76:79]
s_waitcnt lgkmcnt(0)
s_barrier
v_mfma_f32_16x16x32_bf16 v[16:19], a[80:83], a[64:67], v[16:19]
ds_read_b64_tr_b16 a[16:17], v129 offset:0
ds_read_b64_tr_b16 a[18:19], v129 offset:2048
v_mfma_f32_16x16x32_bf16 v[20:23], a[80:83], a[68:71], v[20:23]
ds_read_b64_tr_b16 a[20:21], v130 offset:0
ds_read_b64_tr_b16 a[22:23], v130 offset:2048
v_mfma_f32_16x16x32_bf16 v[24:27], a[80:83], a[72:75], v[24:27]
ds_read_b64_tr_b16 a[24:25], v129 offset:8192
ds_read_b64_tr_b16 a[26:27], v129 offset:10240
v_mfma_f32_16x16x32_bf16 v[28:31], a[80:83], a[76:79], v[28:31]
ds_read_b64_tr_b16 a[28:29], v130 offset:8192
ds_read_b64_tr_b16 a[30:31], v130 offset:10240
v_mfma_f32_16x16x32_bf16 v[32:35], a[84:87], a[64:67], v[32:35]
ds_read_b128 a[0:3], v128 offset:0
ds_read_b128 a[4:7], v128 offset:2048
v_mfma_f32_16x16x32_bf16 v[36:39], a[84:87], a[68:71], v[36:39]
ds_read_b128 a[8:11], v128 offset:4096
ds_read_b128 a[12:15], v128 offset:6144
v_mfma_f32_16x16x32_bf16 v[40:43], a[84:87], a[72:75], v[40:43]
ds_read_b64_tr_b16 a[48:49], v129 offset:4096
ds_read_b64_tr_b16 a[50:51], v129 offset:6144
v_mfma_f32_16x16x32_bf16 v[44:47], a[84:87], a[76:79], v[44:47]
ds_read_b64_tr_b16 a[52:53], v130 offset:4096
ds_read_b64_tr_b16 a[54:55], v130 offset:6144
v_mfma_f32_16x16x32_bf16 v[48:51], a[88:91], a[64:67], v[48:51]
ds_read_b64_tr_b16 a[56:57], v129 offset:12288
ds_read_b64_tr_b16 a[58:59], v129 offset:14336
v_mfma_f32_16x16x32_bf16 v[52:55], a[88:91], a[68:71], v[52:55]
ds_read_b64_tr_b16 a[60:61], v130 offset:12288
ds_read_b64_tr_b16 a[62:63], v130 offset:14336
v_mfma_f32_16x16x32_bf16 v[56:59], a[88:91], a[72:75], v[56:59]
ds_read_b128 a[32:35], v128 offset:1024
ds_read_b128 a[36:39], v128 offset:3072
v_mfma_f32_16x16x32_bf16 v[60:63], a[88:91], a[76:79], v[60:63]
ds_read_b128 a[40:43], v128 offset:5120
ds_read_b128 a[44:47], v128 offset:7168
v_mfma_f32_16x16x32_bf16 v[64:67], a[92:95], a[64:67], v[64:67]
v_mfma_f32_16x16x32_bf16 v[68:71], a[92:95], a[68:71], v[68:71]
v_mfma_f32_16x16x32_bf16 v[72:75], a[92:95], a[72:75], v[72:75]
v_mfma_f32_16x16x32_bf16 v[76:79], a[92:95], a[76:79], v[76:79]
v_mfma_f32_16x16x32_bf16 v[16:19], v[96:99], v[80:83], v[16:19]
v_mfma_f32_16x16x32_bf16 v[20:23], v[96:99], v[84:87], v[20:23]
v_mfma_f32_16x16x32_bf16 v[24:27], v[96:99], v[88:91], v[24:27]
v_mfma_f32_16x16x32_bf16 v[28:31], v[96:99], v[92:95], v[28:31]
v_mfma_f32_16x16x32_bf16 v[32:35], v[100:103], v[80:83], v[32:35]
v_mfma_f32_16x16x32_bf16 v[36:39], v[100:103], v[84:87], v[36:39]
v_mfma_f32_16x16x32_bf16 v[40:43], v[100:103], v[88:91], v[40:43]
v_mfma_f32_16x16x32_bf16 v[44:47], v[100:103], v[92:95], v[44:47]
v_mfma_f32_16x16x32_bf16 v[48:51], v[104:107], v[80:83], v[48:51]
v_mfma_f32_16x16x32_bf16 v[52:55], v[104:107], v[84:87], v[52:55]
v_mfma_f32_16x16x32_bf16 v[56:59], v[104:107], v[88:91], v[56:59]
v_mfma_f32_16x16x32_bf16 v[60:63], v[104:107], v[92:95], v[60:63]
v_mfma_f32_16x16x32_bf16 v[64:67], v[108:111], v[80:83], v[64:67]
v_mfma_f32_16x16x32_bf16 v[68:71], v[108:111], v[84:87], v[68:71]
v_mfma_f32_16x16x32_bf16 v[72:75], v[108:111], v[88:91], v[72:75]
v_mfma_f32_16x16x32_bf16 v[76:79], v[108:111], v[92:95], v[76:79]
s_waitcnt lgkmcnt(0)
s_barrier
v_mfma_f32_16x16x32_bf16 v[16:19], a[16:19], a[0:3], v[16:19]
ds_read_b64_tr_b16 a[80:81], v132 offset:0
ds_read_b64_tr_b16 a[82:83], v132 offset:2048
v_mfma_f32_16x16x32_bf16 v[20:23], a[16:19], a[4:7], v[20:23]
ds_read_b64_tr_b16 a[84:85], v133 offset:0
ds_read_b64_tr_b16 a[86:87], v133 offset:2048
v_mfma_f32_16x16x32_bf16 v[24:27], a[16:19], a[8:11], v[24:27]
ds_read_b64_tr_b16 a[88:89], v132 offset:8192
ds_read_b64_tr_b16 a[90:91], v132 offset:10240
v_mfma_f32_16x16x32_bf16 v[28:31], a[16:19], a[12:15], v[28:31]
ds_read_b64_tr_b16 a[92:93], v133 offset:8192
ds_read_b64_tr_b16 a[94:95], v133 offset:10240
v_mfma_f32_16x16x32_bf16 v[32:35], a[20:23], a[0:3], v[32:35]
ds_read_b128 a[64:67], v131 offset:0
ds_read_b128 a[68:71], v131 offset:2048
v_mfma_f32_16x16x32_bf16 v[36:39], a[20:23], a[4:7], v[36:39]
ds_read_b128 a[72:75], v131 offset:4096
ds_read_b128 a[76:79], v131 offset:6144
v_mfma_f32_16x16x32_bf16 v[40:43], a[20:23], a[8:11], v[40:43]
ds_read_b64_tr_b16 v[96:97], v132 offset:4096
ds_read_b64_tr_b16 v[98:99], v132 offset:6144
v_mfma_f32_16x16x32_bf16 v[44:47], a[20:23], a[12:15], v[44:47]
ds_read_b64_tr_b16 v[100:101], v133 offset:4096
ds_read_b64_tr_b16 v[102:103], v133 offset:6144
v_mfma_f32_16x16x32_bf16 v[48:51], a[24:27], a[0:3], v[48:51]
ds_read_b64_tr_b16 v[104:105], v132 offset:12288
ds_read_b64_tr_b16 v[106:107], v132 offset:14336
v_mfma_f32_16x16x32_bf16 v[52:55], a[24:27], a[4:7], v[52:55]
ds_read_b64_tr_b16 v[108:109], v133 offset:12288
ds_read_b64_tr_b16 v[110:111], v133 offset:14336
v_mfma_f32_16x16x32_bf16 v[56:59], a[24:27], a[8:11], v[56:59]
ds_read_b128 v[80:83], v131 offset:1024
ds_read_b128 v[84:87], v131 offset:3072
v_mfma_f32_16x16x32_bf16 v[60:63], a[24:27], a[12:15], v[60:63]
ds_read_b128 v[88:91], v131 offset:5120
ds_read_b128 v[92:95], v131 offset:7168
v_mfma_f32_16x16x32_bf16 v[64:67], a[28:31], a[0:3], v[64:67]
v_mfma_f32_16x16x32_bf16 v[68:71], a[28:31], a[4:7], v[68:71]
v_mfma_f32_16x16x32_bf16 v[72:75], a[28:31], a[8:11], v[72:75]
v_mfma_f32_16x16x32_bf16 v[76:79], a[28:31], a[12:15], v[76:79]
v_mfma_f32_16x16x32_bf16 v[16:19], a[48:51], a[32:35], v[16:19]
v_mfma_f32_16x16x32_bf16 v[20:23], a[48:51], a[36:39], v[20:23]
v_mfma_f32_16x16x32_bf16 v[24:27], a[48:51], a[40:43], v[24:27]
v_mfma_f32_16x16x32_bf16 v[28:31], a[48:51], a[44:47], v[28:31]
v_mfma_f32_16x16x32_bf16 v[32:35], a[52:55], a[32:35], v[32:35]
v_mfma_f32_16x16x32_bf16 v[36:39], a[52:55], a[36:39], v[36:39]
v_mfma_f32_16x16x32_bf16 v[40:43], a[52:55], a[40:43], v[40:43]
v_mfma_f32_16x16x32_bf16 v[44:47], a[52:55], a[44:47], v[44:47]
v_mfma_f32_16x16x32_bf16 v[48:51], a[56:59], a[32:35], v[48:51]
v_mfma_f32_16x16x32_bf16 v[52:55], a[56:59], a[36:39], v[52:55]
v_mfma_f32_16x16x32_bf16 v[56:59], a[56:59], a[40:43], v[56:59]
v_mfma_f32_16x16x32_bf16 v[60:63], a[56:59], a[44:47], v[60:63]
v_mfma_f32_16x16x32_bf16 v[64:67], a[60:63], a[32:35], v[64:67]
v_mfma_f32_16x16x32_bf16 v[68:71], a[60:63], a[36:39], v[68:71]
v_mfma_f32_16x16x32_bf16 v[72:75], a[60:63], a[40:43], v[72:75]
v_mfma_f32_16x16x32_bf16 v[76:79], a[60:63], a[44:47], v[76:79]
s_waitcnt lgkmcnt(0)
s_barrier
v_mfma_f32_16x16x32_bf16 v[16:19], a[80:83], a[64:67], v[16:19]
ds_read_b64_tr_b16 a[16:17], v135 offset:0
ds_read_b64_tr_b16 a[18:19], v135 offset:2048
v_mfma_f32_16x16x32_bf16 v[20:23], a[80:83], a[68:71], v[20:23]
ds_read_b64_tr_b16 a[20:21], v136 offset:0
ds_read_b64_tr_b16 a[22:23], v136 offset:2048
v_mfma_f32_16x16x32_bf16 v[24:27], a[80:83], a[72:75], v[24:27]
ds_read_b64_tr_b16 a[24:25], v135 offset:8192
ds_read_b64_tr_b16 a[26:27], v135 offset:10240
v_mfma_f32_16x16x32_bf16 v[28:31], a[80:83], a[76:79], v[28:31]
ds_read_b64_tr_b16 a[28:29], v136 offset:8192
ds_read_b64_tr_b16 a[30:31], v136 offset:10240
v_mfma_f32_16x16x32_bf16 v[32:35], a[84:87], a[64:67], v[32:35]
ds_read_b128 a[0:3], v134 offset:0
ds_read_b128 a[4:7], v134 offset:2048
v_mfma_f32_16x16x32_bf16 v[36:39], a[84:87], a[68:71], v[36:39]
ds_read_b128 a[8:11], v134 offset:4096
ds_read_b128 a[12:15], v134 offset:6144
v_mfma_f32_16x16x32_bf16 v[40:43], a[84:87], a[72:75], v[40:43]
ds_read_b64_tr_b16 a[48:49], v135 offset:4096
ds_read_b64_tr_b16 a[50:51], v135 offset:6144
v_mfma_f32_16x16x32_bf16 v[44:47], a[84:87], a[76:79], v[44:47]
ds_read_b64_tr_b16 a[52:53], v136 offset:4096
ds_read_b64_tr_b16 a[54:55], v136 offset:6144
v_mfma_f32_16x16x32_bf16 v[48:51], a[88:91], a[64:67], v[48:51]
ds_read_b64_tr_b16 a[56:57], v135 offset:12288
ds_read_b64_tr_b16 a[58:59], v135 offset:14336
v_mfma_f32_16x16x32_bf16 v[52:55], a[88:91], a[68:71], v[52:55]
ds_read_b64_tr_b16 a[60:61], v136 offset:12288
ds_read_b64_tr_b16 a[62:63], v136 offset:14336
v_mfma_f32_16x16x32_bf16 v[56:59], a[88:91], a[72:75], v[56:59]
ds_read_b128 a[32:35], v134 offset:1024
ds_read_b128 a[36:39], v134 offset:3072
v_mfma_f32_16x16x32_bf16 v[60:63], a[88:91], a[76:79], v[60:63]
ds_read_b128 a[40:43], v134 offset:5120
ds_read_b128 a[44:47], v134 offset:7168
v_mfma_f32_16x16x32_bf16 v[64:67], a[92:95], a[64:67], v[64:67]
v_mfma_f32_16x16x32_bf16 v[68:71], a[92:95], a[68:71], v[68:71]
v_mfma_f32_16x16x32_bf16 v[72:75], a[92:95], a[72:75], v[72:75]
v_mfma_f32_16x16x32_bf16 v[76:79], a[92:95], a[76:79], v[76:79]
v_mfma_f32_16x16x32_bf16 v[16:19], v[96:99], v[80:83], v[16:19]
v_mfma_f32_16x16x32_bf16 v[20:23], v[96:99], v[84:87], v[20:23]
v_mfma_f32_16x16x32_bf16 v[24:27], v[96:99], v[88:91], v[24:27]
v_mfma_f32_16x16x32_bf16 v[28:31], v[96:99], v[92:95], v[28:31]
v_mfma_f32_16x16x32_bf16 v[32:35], v[100:103], v[80:83], v[32:35]
v_mfma_f32_16x16x32_bf16 v[36:39], v[100:103], v[84:87], v[36:39]
v_mfma_f32_16x16x32_bf16 v[40:43], v[100:103], v[88:91], v[40:43]
v_mfma_f32_16x16x32_bf16 v[44:47], v[100:103], v[92:95], v[44:47]
v_mfma_f32_16x16x32_bf16 v[48:51], v[104:107], v[80:83], v[48:51]
v_mfma_f32_16x16x32_bf16 v[52:55], v[104:107], v[84:87], v[52:55]
v_mfma_f32_16x16x32_bf16 v[56:59], v[104:107], v[88:91], v[56:59]
v_mfma_f32_16x16x32_bf16 v[60:63], v[104:107], v[92:95], v[60:63]
v_mfma_f32_16x16x32_bf16 v[64:67], v[108:111], v[80:83], v[64:67]
v_mfma_f32_16x16x32_bf16 v[68:71], v[108:111], v[84:87], v[68:71]
v_mfma_f32_16x16x32_bf16 v[72:75], v[108:111], v[88:91], v[72:75]
v_mfma_f32_16x16x32_bf16 v[76:79], v[108:111], v[92:95], v[76:79]
s_waitcnt lgkmcnt(0)
s_barrier
v_mfma_f32_16x16x32_bf16 v[16:19], a[16:19], a[0:3], v[16:19]
ds_read_b64_tr_b16 a[80:81], v138 offset:0
ds_read_b64_tr_b16 a[82:83], v138 offset:2048
v_mfma_f32_16x16x32_bf16 v[20:23], a[16:19], a[4:7], v[20:23]
ds_read_b64_tr_b16 a[84:85], v139 offset:0
ds_read_b64_tr_b16 a[86:87], v139 offset:2048
v_mfma_f32_16x16x32_bf16 v[24:27], a[16:19], a[8:11], v[24:27]
ds_read_b64_tr_b16 a[88:89], v138 offset:8192
ds_read_b64_tr_b16 a[90:91], v138 offset:10240
v_mfma_f32_16x16x32_bf16 v[28:31], a[16:19], a[12:15], v[28:31]
ds_read_b64_tr_b16 a[92:93], v139 offset:8192
ds_read_b64_tr_b16 a[94:95], v139 offset:10240
v_mfma_f32_16x16x32_bf16 v[32:35], a[20:23], a[0:3], v[32:35]
ds_read_b128 a[64:67], v137 offset:0
ds_read_b128 a[68:71], v137 offset:2048
v_mfma_f32_16x16x32_bf16 v[36:39], a[20:23], a[4:7], v[36:39]
ds_read_b128 a[72:75], v137 offset:4096
ds_read_b128 a[76:79], v137 offset:6144
v_mfma_f32_16x16x32_bf16 v[40:43], a[20:23], a[8:11], v[40:43]
ds_read_b64_tr_b16 v[96:97], v138 offset:4096
ds_read_b64_tr_b16 v[98:99], v138 offset:6144
v_mfma_f32_16x16x32_bf16 v[44:47], a[20:23], a[12:15], v[44:47]
ds_read_b64_tr_b16 v[100:101], v139 offset:4096
ds_read_b64_tr_b16 v[102:103], v139 offset:6144
v_mfma_f32_16x16x32_bf16 v[48:51], a[24:27], a[0:3], v[48:51]
ds_read_b64_tr_b16 v[104:105], v138 offset:12288
ds_read_b64_tr_b16 v[106:107], v138 offset:14336
v_mfma_f32_16x16x32_bf16 v[52:55], a[24:27], a[4:7], v[52:55]
ds_read_b64_tr_b16 v[108:109], v139 offset:12288
ds_read_b64_tr_b16 v[110:111], v139 offset:14336
v_mfma_f32_16x16x32_bf16 v[56:59], a[24:27], a[8:11], v[56:59]
ds_read_b128 v[80:83], v137 offset:1024
ds_read_b128 v[84:87], v137 offset:3072
v_mfma_f32_16x16x32_bf16 v[60:63], a[24:27], a[12:15], v[60:63]
ds_read_b128 v[88:91], v137 offset:5120
ds_read_b128 v[92:95], v137 offset:7168
v_mfma_f32_16x16x32_bf16 v[64:67], a[28:31], a[0:3], v[64:67]
v_mfma_f32_16x16x32_bf16 v[68:71], a[28:31], a[4:7], v[68:71]
v_mfma_f32_16x16x32_bf16 v[72:75], a[28:31], a[8:11], v[72:75]
v_mfma_f32_16x16x32_bf16 v[76:79], a[28:31], a[12:15], v[76:79]
v_mfma_f32_16x16x32_bf16 v[16:19], a[48:51], a[32:35], v[16:19]
v_mfma_f32_16x16x32_bf16 v[20:23], a[48:51], a[36:39], v[20:23]
v_mfma_f32_16x16x32_bf16 v[24:27], a[48:51], a[40:43], v[24:27]
v_mfma_f32_16x16x32_bf16 v[28:31], a[48:51], a[44:47], v[28:31]
v_mfma_f32_16x16x32_bf16 v[32:35], a[52:55], a[32:35], v[32:35]
v_mfma_f32_16x16x32_bf16 v[36:39], a[52:55], a[36:39], v[36:39]
v_mfma_f32_16x16x32_bf16 v[40:43], a[52:55], a[40:43], v[40:43]
v_mfma_f32_16x16x32_bf16 v[44:47], a[52:55], a[44:47], v[44:47]
v_mfma_f32_16x16x32_bf16 v[48:51], a[56:59], a[32:35], v[48:51]
v_mfma_f32_16x16x32_bf16 v[52:55], a[56:59], a[36:39], v[52:55]
v_mfma_f32_16x16x32_bf16 v[56:59], a[56:59], a[40:43], v[56:59]
v_mfma_f32_16x16x32_bf16 v[60:63], a[56:59], a[44:47], v[60:63]
v_mfma_f32_16x16x32_bf16 v[64:67], a[60:63], a[32:35], v[64:67]
v_mfma_f32_16x16x32_bf16 v[68:71], a[60:63], a[36:39], v[68:71]
v_mfma_f32_16x16x32_bf16 v[72:75], a[60:63], a[40:43], v[72:75]
v_mfma_f32_16x16x32_bf16 v[76:79], a[60:63], a[44:47], v[76:79]
s_waitcnt lgkmcnt(0)
s_barrier
v_mfma_f32_16x16x32_bf16 v[16:19], a[80:83], a[64:67], v[16:19]
ds_read_b64_tr_b16 a[16:17], v129 offset:0
ds_read_b64_tr_b16 a[18:19], v129 offset:2048
v_mfma_f32_16x16x32_bf16 v[20:23], a[80:83], a[68:71], v[20:23]
ds_read_b64_tr_b16 a[20:21], v130 offset:0
ds_read_b64_tr_b16 a[22:23], v130 offset:2048
v_mfma_f32_16x16x32_bf16 v[24:27], a[80:83], a[72:75], v[24:27]
ds_read_b64_tr_b16 a[24:25], v129 offset:8192
ds_read_b64_tr_b16 a[26:27], v129 offset:10240
v_mfma_f32_16x16x32_bf16 v[28:31], a[80:83], a[76:79], v[28:31]
ds_read_b64_tr_b16 a[28:29], v130 offset:8192
ds_read_b64_tr_b16 a[30:31], v130 offset:10240
v_mfma_f32_16x16x32_bf16 v[32:35], a[84:87], a[64:67], v[32:35]
ds_read_b128 a[0:3], v128 offset:0
ds_read_b128 a[4:7], v128 offset:2048
v_mfma_f32_16x16x32_bf16 v[36:39], a[84:87], a[68:71], v[36:39]
ds_read_b128 a[8:11], v128 offset:4096
ds_read_b128 a[12:15], v128 offset:6144
v_mfma_f32_16x16x32_bf16 v[40:43], a[84:87], a[72:75], v[40:43]
ds_read_b64_tr_b16 a[48:49], v129 offset:4096
ds_read_b64_tr_b16 a[50:51], v129 offset:6144
v_mfma_f32_16x16x32_bf16 v[44:47], a[84:87], a[76:79], v[44:47]
ds_read_b64_tr_b16 a[52:53], v130 offset:4096
ds_read_b64_tr_b16 a[54:55], v130 offset:6144
v_mfma_f32_16x16x32_bf16 v[48:51], a[88:91], a[64:67], v[48:51]
ds_read_b64_tr_b16 a[56:57], v129 offset:12288
ds_read_b64_tr_b16 a[58:59], v129 offset:14336
v_mfma_f32_16x16x32_bf16 v[52:55], a[88:91], a[68:71], v[52:55]
ds_read_b64_tr_b16 a[60:61], v130 offset:12288
ds_read_b64_tr_b16 a[62:63], v130 offset:14336
v_mfma_f32_16x16x32_bf16 v[56:59], a[88:91], a[72:75], v[56:59]
ds_read_b128 a[32:35], v128 offset:1024
ds_read_b128 a[36:39], v128 offset:3072
v_mfma_f32_16x16x32_bf16 v[60:63], a[88:91], a[76:79], v[60:63]
ds_read_b128 a[40:43], v128 offset:5120
ds_read_b128 a[44:47], v128 offset:7168
v_mfma_f32_16x16x32_bf16 v[64:67], a[92:95], a[64:67], v[64:67]
v_mfma_f32_16x16x32_bf16 v[68:71], a[92:95], a[68:71], v[68:71]
v_mfma_f32_16x16x32_bf16 v[72:75], a[92:95], a[72:75], v[72:75]
v_mfma_f32_16x16x32_bf16 v[76:79], a[92:95], a[76:79], v[76:79]
v_mfma_f32_16x16x32_bf16 v[16:19], v[96:99], v[80:83], v[16:19]
v_mfma_f32_16x16x32_bf16 v[20:23], v[96:99], v[84:87], v[20:23]
v_mfma_f32_16x16x32_bf16 v[24:27], v[96:99], v[88:91], v[24:27]
v_mfma_f32_16x16x32_bf16 v[28:31], v[96:99], v[92:95], v[28:31]
v_mfma_f32_16x16x32_bf16 v[32:35], v[100:103], v[80:83], v[32:35]
v_mfma_f32_16x16x32_bf16 v[36:39], v[100:103], v[84:87], v[36:39]
v_mfma_f32_16x16x32_bf16 v[40:43], v[100:103], v[88:91], v[40:43]
v_mfma_f32_16x16x32_bf16 v[44:47], v[100:103], v[92:95], v[44:47]
v_mfma_f32_16x16x32_bf16 v[48:51], v[104:107], v[80:83], v[48:51]
v_mfma_f32_16x16x32_bf16 v[52:55], v[104:107], v[84:87], v[52:55]
v_mfma_f32_16x16x32_bf16 v[56:59], v[104:107], v[88:91], v[56:59]
v_mfma_f32_16x16x32_bf16 v[60:63], v[104:107], v[92:95], v[60:63]
v_mfma_f32_16x16x32_bf16 v[64:67], v[108:111], v[80:83], v[64:67]
v_mfma_f32_16x16x32_bf16 v[68:71], v[108:111], v[84:87], v[68:71]
v_mfma_f32_16x16x32_bf16 v[72:75], v[108:111], v[88:91], v[72:75]
v_mfma_f32_16x16x32_bf16 v[76:79], v[108:111], v[92:95], v[76:79]
s_waitcnt lgkmcnt(0)
s_barrier
v_mfma_f32_16x16x32_bf16 v[16:19], a[16:19], a[0:3], v[16:19]
ds_read_b64_tr_b16 a[80:81], v132 offset:0
ds_read_b64_tr_b16 a[82:83], v132 offset:2048
v_mfma_f32_16x16x32_bf16 v[20:23], a[16:19], a[4:7], v[20:23]
ds_read_b64_tr_b16 a[84:85], v133 offset:0
ds_read_b64_tr_b16 a[86:87], v133 offset:2048
v_mfma_f32_16x16x32_bf16 v[24:27], a[16:19], a[8:11], v[24:27]
ds_read_b64_tr_b16 a[88:89], v132 offset:8192
ds_read_b64_tr_b16 a[90:91], v132 offset:10240
v_mfma_f32_16x16x32_bf16 v[28:31], a[16:19], a[12:15], v[28:31]
ds_read_b64_tr_b16 a[92:93], v133 offset:8192
ds_read_b64_tr_b16 a[94:95], v133 offset:10240
v_mfma_f32_16x16x32_bf16 v[32:35], a[20:23], a[0:3], v[32:35]
ds_read_b128 a[64:67], v131 offset:0
ds_read_b128 a[68:71], v131 offset:2048
v_mfma_f32_16x16x32_bf16 v[36:39], a[20:23], a[4:7], v[36:39]
ds_read_b128 a[72:75], v131 offset:4096
ds_read_b128 a[76:79], v131 offset:6144
v_mfma_f32_16x16x32_bf16 v[40:43], a[20:23], a[8:11], v[40:43]
ds_read_b64_tr_b16 v[96:97], v132 offset:4096
ds_read_b64_tr_b16 v[98:99], v132 offset:6144
v_mfma_f32_16x16x32_bf16 v[44:47], a[20:23], a[12:15], v[44:47]
ds_read_b64_tr_b16 v[100:101], v133 offset:4096
ds_read_b64_tr_b16 v[102:103], v133 offset:6144
v_mfma_f32_16x16x32_bf16 v[48:51], a[24:27], a[0:3], v[48:51]
ds_read_b64_tr_b16 v[104:105], v132 offset:12288
ds_read_b64_tr_b16 v[106:107], v132 offset:14336
v_mfma_f32_16x16x32_bf16 v[52:55], a[24:27], a[4:7], v[52:55]
ds_read_b64_tr_b16 v[108:109], v133 offset:12288
ds_read_b64_tr_b16 v[110:111], v133 offset:14336
v_mfma_f32_16x16x32_bf16 v[56:59], a[24:27], a[8:11], v[56:59]
ds_read_b128 v[80:83], v131 offset:1024
ds_read_b128 v[84:87], v131 offset:3072
v_mfma_f32_16x16x32_bf16 v[60:63], a[24:27], a[12:15], v[60:63]
ds_read_b128 v[88:91], v131 offset:5120
ds_read_b128 v[92:95], v131 offset:7168
v_mfma_f32_16x16x32_bf16 v[64:67], a[28:31], a[0:3], v[64:67]
v_mfma_f32_16x16x32_bf16 v[68:71], a[28:31], a[4:7], v[68:71]
v_mfma_f32_16x16x32_bf16 v[72:75], a[28:31], a[8:11], v[72:75]
v_mfma_f32_16x16x32_bf16 v[76:79], a[28:31], a[12:15], v[76:79]
v_mfma_f32_16x16x32_bf16 v[16:19], a[48:51], a[32:35], v[16:19]
v_mfma_f32_16x16x32_bf16 v[20:23], a[48:51], a[36:39], v[20:23]
v_mfma_f32_16x16x32_bf16 v[24:27], a[48:51], a[40:43], v[24:27]
v_mfma_f32_16x16x32_bf16 v[28:31], a[48:51], a[44:47], v[28:31]
v_mfma_f32_16x16x32_bf16 v[32:35], a[52:55], a[32:35], v[32:35]
v_mfma_f32_16x16x32_bf16 v[36:39], a[52:55], a[36:39], v[36:39]
v_mfma_f32_16x16x32_bf16 v[40:43], a[52:55], a[40:43], v[40:43]
v_mfma_f32_16x16x32_bf16 v[44:47], a[52:55], a[44:47], v[44:47]
v_mfma_f32_16x16x32_bf16 v[48:51], a[56:59], a[32:35], v[48:51]
v_mfma_f32_16x16x32_bf16 v[52:55], a[56:59], a[36:39], v[52:55]
v_mfma_f32_16x16x32_bf16 v[56:59], a[56:59], a[40:43], v[56:59]
v_mfma_f32_16x16x32_bf16 v[60:63], a[56:59], a[44:47], v[60:63]
v_mfma_f32_16x16x32_bf16 v[64:67], a[60:63], a[32:35], v[64:67]
v_mfma_f32_16x16x32_bf16 v[68:71], a[60:63], a[36:39], v[68:71]
v_mfma_f32_16x16x32_bf16 v[72:75], a[60:63], a[40:43], v[72:75]
v_mfma_f32_16x16x32_bf16 v[76:79], a[60:63], a[44:47], v[76:79]
s_waitcnt lgkmcnt(0)
s_barrier
v_mfma_f32_16x16x32_bf16 v[16:19], a[80:83], a[64:67], v[16:19]
ds_read_b64_tr_b16 a[16:17], v135 offset:0
ds_read_b64_tr_b16 a[18:19], v135 offset:2048
v_mfma_f32_16x16x32_bf16 v[20:23], a[80:83], a[68:71], v[20:23]
ds_read_b64_tr_b16 a[20:21], v136 offset:0
ds_read_b64_tr_b16 a[22:23], v136 offset:2048
v_mfma_f32_16x16x32_bf16 v[24:27], a[80:83], a[72:75], v[24:27]
ds_read_b64_tr_b16 a[24:25], v135 offset:8192
ds_read_b64_tr_b16 a[26:27], v135 offset:10240
v_mfma_f32_16x16x32_bf16 v[28:31], a[80:83], a[76:79], v[28:31]
ds_read_b64_tr_b16 a[28:29], v136 offset:8192
ds_read_b64_tr_b16 a[30:31], v136 offset:10240
v_mfma_f32_16x16x32_bf16 v[32:35], a[84:87], a[64:67], v[32:35]
ds_read_b128 a[0:3], v134 offset:0
ds_read_b128 a[4:7], v134 offset:2048
v_mfma_f32_16x16x32_bf16 v[36:39], a[84:87], a[68:71], v[36:39]
ds_read_b128 a[8:11], v134 offset:4096
ds_read_b128 a[12:15], v134 offset:6144
v_mfma_f32_16x16x32_bf16 v[40:43], a[84:87], a[72:75], v[40:43]
ds_read_b64_tr_b16 a[48:49], v135 offset:4096
ds_read_b64_tr_b16 a[50:51], v135 offset:6144
v_mfma_f32_16x16x32_bf16 v[44:47], a[84:87], a[76:79], v[44:47]
ds_read_b64_tr_b16 a[52:53], v136 offset:4096
ds_read_b64_tr_b16 a[54:55], v136 offset:6144
v_mfma_f32_16x16x32_bf16 v[48:51], a[88:91], a[64:67], v[48:51]
ds_read_b64_tr_b16 a[56:57], v135 offset:12288
ds_read_b64_tr_b16 a[58:59], v135 offset:14336
v_mfma_f32_16x16x32_bf16 v[52:55], a[88:91], a[68:71], v[52:55]
ds_read_b64_tr_b16 a[60:61], v136 offset:12288
ds_read_b64_tr_b16 a[62:63], v136 offset:14336
v_mfma_f32_16x16x32_bf16 v[56:59], a[88:91], a[72:75], v[56:59]
ds_read_b128 a[32:35], v134 offset:1024
ds_read_b128 a[36:39], v134 offset:3072
v_mfma_f32_16x16x32_bf16 v[60:63], a[88:91], a[76:79], v[60:63]
ds_read_b128 a[40:43], v134 offset:5120
ds_read_b128 a[44:47], v134 offset:7168
v_mfma_f32_16x16x32_bf16 v[64:67], a[92:95], a[64:67], v[64:67]
v_mfma_f32_16x16x32_bf16 v[68:71], a[92:95], a[68:71], v[68:71]
v_mfma_f32_16x16x32_bf16 v[72:75], a[92:95], a[72:75], v[72:75]
v_mfma_f32_16x16x32_bf16 v[76:79], a[92:95], a[76:79], v[76:79]
v_mfma_f32_16x16x32_bf16 v[16:19], v[96:99], v[80:83], v[16:19]
v_mfma_f32_16x16x32_bf16 v[20:23], v[96:99], v[84:87], v[20:23]
v_mfma_f32_16x16x32_bf16 v[24:27], v[96:99], v[88:91], v[24:27]
v_mfma_f32_16x16x32_bf16 v[28:31], v[96:99], v[92:95], v[28:31]
v_mfma_f32_16x16x32_bf16 v[32:35], v[100:103], v[80:83], v[32:35]
v_mfma_f32_16x16x32_bf16 v[36:39], v[100:103], v[84:87], v[36:39]
v_mfma_f32_16x16x32_bf16 v[40:43], v[100:103], v[88:91], v[40:43]
v_mfma_f32_16x16x32_bf16 v[44:47], v[100:103], v[92:95], v[44:47]
v_mfma_f32_16x16x32_bf16 v[48:51], v[104:107], v[80:83], v[48:51]
v_mfma_f32_16x16x32_bf16 v[52:55], v[104:107], v[84:87], v[52:55]
v_mfma_f32_16x16x32_bf16 v[56:59], v[104:107], v[88:91], v[56:59]
v_mfma_f32_16x16x32_bf16 v[60:63], v[104:107], v[92:95], v[60:63]
v_mfma_f32_16x16x32_bf16 v[64:67], v[108:111], v[80:83], v[64:67]
v_mfma_f32_16x16x32_bf16 v[68:71], v[108:111], v[84:87], v[68:71]
v_mfma_f32_16x16x32_bf16 v[72:75], v[108:111], v[88:91], v[72:75]
v_mfma_f32_16x16x32_bf16 v[76:79], v[108:111], v[92:95], v[76:79]
s_waitcnt lgkmcnt(0)
s_barrier
v_mfma_f32_16x16x32_bf16 v[16:19], a[16:19], a[0:3], v[16:19]
ds_read_b64_tr_b16 a[80:81], v138 offset:0
ds_read_b64_tr_b16 a[82:83], v138 offset:2048
v_mfma_f32_16x16x32_bf16 v[20:23], a[16:19], a[4:7], v[20:23]
ds_read_b64_tr_b16 a[84:85], v139 offset:0
ds_read_b64_tr_b16 a[86:87], v139 offset:2048
v_mfma_f32_16x16x32_bf16 v[24:27], a[16:19], a[8:11], v[24:27]
ds_read_b64_tr_b16 a[88:89], v138 offset:8192
ds_read_b64_tr_b16 a[90:91], v138 offset:10240
v_mfma_f32_16x16x32_bf16 v[28:31], a[16:19], a[12:15], v[28:31]
ds_read_b64_tr_b16 a[92:93], v139 offset:8192
ds_read_b64_tr_b16 a[94:95], v139 offset:10240
v_mfma_f32_16x16x32_bf16 v[32:35], a[20:23], a[0:3], v[32:35]
ds_read_b128 a[64:67], v137 offset:0
ds_read_b128 a[68:71], v137 offset:2048
v_mfma_f32_16x16x32_bf16 v[36:39], a[20:23], a[4:7], v[36:39]
ds_read_b128 a[72:75], v137 offset:4096
ds_read_b128 a[76:79], v137 offset:6144
v_mfma_f32_16x16x32_bf16 v[40:43], a[20:23], a[8:11], v[40:43]
ds_read_b64_tr_b16 v[96:97], v138 offset:4096
ds_read_b64_tr_b16 v[98:99], v138 offset:6144
v_mfma_f32_16x16x32_bf16 v[44:47], a[20:23], a[12:15], v[44:47]
ds_read_b64_tr_b16 v[100:101], v139 offset:4096
ds_read_b64_tr_b16 v[102:103], v139 offset:6144
v_mfma_f32_16x16x32_bf16 v[48:51], a[24:27], a[0:3], v[48:51]
ds_read_b64_tr_b16 v[104:105], v138 offset:12288
ds_read_b64_tr_b16 v[106:107], v138 offset:14336
v_mfma_f32_16x16x32_bf16 v[52:55], a[24:27], a[4:7], v[52:55]
ds_read_b64_tr_b16 v[108:109], v139 offset:12288
ds_read_b64_tr_b16 v[110:111], v139 offset:14336
v_mfma_f32_16x16x32_bf16 v[56:59], a[24:27], a[8:11], v[56:59]
ds_read_b128 v[80:83], v137 offset:1024
ds_read_b128 v[84:87], v137 offset:3072
v_mfma_f32_16x16x32_bf16 v[60:63], a[24:27], a[12:15], v[60:63]
ds_read_b128 v[88:91], v137 offset:5120
ds_read_b128 v[92:95], v137 offset:7168
v_mfma_f32_16x16x32_bf16 v[64:67], a[28:31], a[0:3], v[64:67]
v_mfma_f32_16x16x32_bf16 v[68:71], a[28:31], a[4:7], v[68:71]
v_mfma_f32_16x16x32_bf16 v[72:75], a[28:31], a[8:11], v[72:75]
v_mfma_f32_16x16x32_bf16 v[76:79], a[28:31], a[12:15], v[76:79]
v_mfma_f32_16x16x32_bf16 v[16:19], a[48:51], a[32:35], v[16:19]
v_mfma_f32_16x16x32_bf16 v[20:23], a[48:51], a[36:39], v[20:23]
v_mfma_f32_16x16x32_bf16 v[24:27], a[48:51], a[40:43], v[24:27]
v_mfma_f32_16x16x32_bf16 v[28:31], a[48:51], a[44:47], v[28:31]
v_mfma_f32_16x16x32_bf16 v[32:35], a[52:55], a[32:35], v[32:35]
v_mfma_f32_16x16x32_bf16 v[36:39], a[52:55], a[36:39], v[36:39]
v_mfma_f32_16x16x32_bf16 v[40:43], a[52:55], a[40:43], v[40:43]
v_mfma_f32_16x16x32_bf16 v[44:47], a[52:55], a[44:47], v[44:47]
v_mfma_f32_16x16x32_bf16 v[48:51], a[56:59], a[32:35], v[48:51]
v_mfma_f32_16x16x32_bf16 v[52:55], a[56:59], a[36:39], v[52:55]
v_mfma_f32_16x16x32_bf16 v[56:59], a[56:59], a[40:43], v[56:59]
v_mfma_f32_16x16x32_bf16 v[60:63], a[56:59], a[44:47], v[60:63]
v_mfma_f32_16x16x32_bf16 v[64:67], a[60:63], a[32:35], v[64:67]
v_mfma_f32_16x16x32_bf16 v[68:71], a[60:63], a[36:39], v[68:71]
v_mfma_f32_16x16x32_bf16 v[72:75], a[60:63], a[40:43], v[72:75]
v_mfma_f32_16x16x32_bf16 v[76:79], a[60:63], a[44:47], v[76:79]
s_waitcnt lgkmcnt(0)
s_barrier
v_mfma_f32_16x16x32_bf16 v[16:19], a[80:83], a[64:67], v[16:19]
ds_read_b64_tr_b16 a[16:17], v129 offset:0
ds_read_b64_tr_b16 a[18:19], v129 offset:2048
v_mfma_f32_16x16x32_bf16 v[20:23], a[80:83], a[68:71], v[20:23]
ds_read_b64_tr_b16 a[20:21], v130 offset:0
ds_read_b64_tr_b16 a[22:23], v130 offset:2048
v_mfma_f32_16x16x32_bf16 v[24:27], a[80:83], a[72:75], v[24:27]
ds_read_b64_tr_b16 a[24:25], v129 offset:8192
ds_read_b64_tr_b16 a[26:27], v129 offset:10240
v_mfma_f32_16x16x32_bf16 v[28:31], a[80:83], a[76:79], v[28:31]
ds_read_b64_tr_b16 a[28:29], v130 offset:8192
ds_read_b64_tr_b16 a[30:31], v130 offset:10240
v_mfma_f32_16x16x32_bf16 v[32:35], a[84:87], a[64:67], v[32:35]
ds_read_b128 a[0:3], v128 offset:0
ds_read_b128 a[4:7], v128 offset:2048
v_mfma_f32_16x16x32_bf16 v[36:39], a[84:87], a[68:71], v[36:39]
ds_read_b128 a[8:11], v128 offset:4096
ds_read_b128 a[12:15], v128 offset:6144
v_mfma_f32_16x16x32_bf16 v[40:43], a[84:87], a[72:75], v[40:43]
ds_read_b64_tr_b16 a[48:49], v129 offset:4096
ds_read_b64_tr_b16 a[50:51], v129 offset:6144
v_mfma_f32_16x16x32_bf16 v[44:47], a[84:87], a[76:79], v[44:47]
ds_read_b64_tr_b16 a[52:53], v130 offset:4096
ds_read_b64_tr_b16 a[54:55], v130 offset:6144
v_mfma_f32_16x16x32_bf16 v[48:51], a[88:91], a[64:67], v[48:51]
ds_read_b64_tr_b16 a[56:57], v129 offset:12288
ds_read_b64_tr_b16 a[58:59], v129 offset:14336
v_mfma_f32_16x16x32_bf16 v[52:55], a[88:91], a[68:71], v[52:55]
ds_read_b64_tr_b16 a[60:61], v130 offset:12288
ds_read_b64_tr_b16 a[62:63], v130 offset:14336
v_mfma_f32_16x16x32_bf16 v[56:59], a[88:91], a[72:75], v[56:59]
ds_read_b128 a[32:35], v128 offset:1024
ds_read_b128 a[36:39], v128 offset:3072
v_mfma_f32_16x16x32_bf16 v[60:63], a[88:91], a[76:79], v[60:63]
ds_read_b128 a[40:43], v128 offset:5120
ds_read_b128 a[44:47], v128 offset:7168
v_mfma_f32_16x16x32_bf16 v[64:67], a[92:95], a[64:67], v[64:67]
v_mfma_f32_16x16x32_bf16 v[68:71], a[92:95], a[68:71], v[68:71]
v_mfma_f32_16x16x32_bf16 v[72:75], a[92:95], a[72:75], v[72:75]
v_mfma_f32_16x16x32_bf16 v[76:79], a[92:95], a[76:79], v[76:79]
v_mfma_f32_16x16x32_bf16 v[16:19], v[96:99], v[80:83], v[16:19]
v_mfma_f32_16x16x32_bf16 v[20:23], v[96:99], v[84:87], v[20:23]
v_mfma_f32_16x16x32_bf16 v[24:27], v[96:99], v[88:91], v[24:27]
v_mfma_f32_16x16x32_bf16 v[28:31], v[96:99], v[92:95], v[28:31]
v_mfma_f32_16x16x32_bf16 v[32:35], v[100:103], v[80:83], v[32:35]
v_mfma_f32_16x16x32_bf16 v[36:39], v[100:103], v[84:87], v[36:39]
v_mfma_f32_16x16x32_bf16 v[40:43], v[100:103], v[88:91], v[40:43]
v_mfma_f32_16x16x32_bf16 v[44:47], v[100:103], v[92:95], v[44:47]
v_mfma_f32_16x16x32_bf16 v[48:51], v[104:107], v[80:83], v[48:51]
v_mfma_f32_16x16x32_bf16 v[52:55], v[104:107], v[84:87], v[52:55]
v_mfma_f32_16x16x32_bf16 v[56:59], v[104:107], v[88:91], v[56:59]
v_mfma_f32_16x16x32_bf16 v[60:63], v[104:107], v[92:95], v[60:63]
v_mfma_f32_16x16x32_bf16 v[64:67], v[108:111], v[80:83], v[64:67]
v_mfma_f32_16x16x32_bf16 v[68:71], v[108:111], v[84:87], v[68:71]
v_mfma_f32_16x16x32_bf16 v[72:75], v[108:111], v[88:91], v[72:75]
v_mfma_f32_16x16x32_bf16 v[76:79], v[108:111], v[92:95], v[76:79]
s_waitcnt lgkmcnt(0)
s_barrier
v_mfma_f32_16x16x32_bf16 v[16:19], a[16:19], a[0:3], v[16:19]
ds_read_b64_tr_b16 a[80:81], v132 offset:0
ds_read_b64_tr_b16 a[82:83], v132 offset:2048
v_mfma_f32_16x16x32_bf16 v[20:23], a[16:19], a[4:7], v[20:23]
ds_read_b64_tr_b16 a[84:85], v133 offset:0
ds_read_b64_tr_b16 a[86:87], v133 offset:2048
v_mfma_f32_16x16x32_bf16 v[24:27], a[16:19], a[8:11], v[24:27]
ds_read_b64_tr_b16 a[88:89], v132 offset:8192
ds_read_b64_tr_b16 a[90:91], v132 offset:10240
v_mfma_f32_16x16x32_bf16 v[28:31], a[16:19], a[12:15], v[28:31]
ds_read_b64_tr_b16 a[92:93], v133 offset:8192
ds_read_b64_tr_b16 a[94:95], v133 offset:10240
v_mfma_f32_16x16x32_bf16 v[32:35], a[20:23], a[0:3], v[32:35]
ds_read_b128 a[64:67], v131 offset:0
ds_read_b128 a[68:71], v131 offset:2048
v_mfma_f32_16x16x32_bf16 v[36:39], a[20:23], a[4:7], v[36:39]
ds_read_b128 a[72:75], v131 offset:4096
ds_read_b128 a[76:79], v131 offset:6144
v_mfma_f32_16x16x32_bf16 v[40:43], a[20:23], a[8:11], v[40:43]
ds_read_b64_tr_b16 v[96:97], v132 offset:4096
ds_read_b64_tr_b16 v[98:99], v132 offset:6144
v_mfma_f32_16x16x32_bf16 v[44:47], a[20:23], a[12:15], v[44:47]
ds_read_b64_tr_b16 v[100:101], v133 offset:4096
ds_read_b64_tr_b16 v[102:103], v133 offset:6144
v_mfma_f32_16x16x32_bf16 v[48:51], a[24:27], a[0:3], v[48:51]
ds_read_b64_tr_b16 v[104:105], v132 offset:12288
ds_read_b64_tr_b16 v[106:107], v132 offset:14336
v_mfma_f32_16x16x32_bf16 v[52:55], a[24:27], a[4:7], v[52:55]
ds_read_b64_tr_b16 v[108:109], v133 offset:12288
ds_read_b64_tr_b16 v[110:111], v133 offset:14336
v_mfma_f32_16x16x32_bf16 v[56:59], a[24:27], a[8:11], v[56:59]
ds_read_b128 v[80:83], v131 offset:1024
ds_read_b128 v[84:87], v131 offset:3072
v_mfma_f32_16x16x32_bf16 v[60:63], a[24:27], a[12:15], v[60:63]
ds_read_b128 v[88:91], v131 offset:5120
ds_read_b128 v[92:95], v131 offset:7168
v_mfma_f32_16x16x32_bf16 v[64:67], a[28:31], a[0:3], v[64:67]
v_mfma_f32_16x16x32_bf16 v[68:71], a[28:31], a[4:7], v[68:71]
v_mfma_f32_16x16x32_bf16 v[72:75], a[28:31], a[8:11], v[72:75]
v_mfma_f32_16x16x32_bf16 v[76:79], a[28:31], a[12:15], v[76:79]
v_mfma_f32_16x16x32_bf16 v[16:19], a[48:51], a[32:35], v[16:19]
v_mfma_f32_16x16x32_bf16 v[20:23], a[48:51], a[36:39], v[20:23]
v_mfma_f32_16x16x32_bf16 v[24:27], a[48:51], a[40:43], v[24:27]
v_mfma_f32_16x16x32_bf16 v[28:31], a[48:51], a[44:47], v[28:31]
v_mfma_f32_16x16x32_bf16 v[32:35], a[52:55], a[32:35], v[32:35]
v_mfma_f32_16x16x32_bf16 v[36:39], a[52:55], a[36:39], v[36:39]
v_mfma_f32_16x16x32_bf16 v[40:43], a[52:55], a[40:43], v[40:43]
v_mfma_f32_16x16x32_bf16 v[44:47], a[52:55], a[44:47], v[44:47]
v_mfma_f32_16x16x32_bf16 v[48:51], a[56:59], a[32:35], v[48:51]
v_mfma_f32_16x16x32_bf16 v[52:55], a[56:59], a[36:39], v[52:55]
v_mfma_f32_16x16x32_bf16 v[56:59], a[56:59], a[40:43], v[56:59]
v_mfma_f32_16x16x32_bf16 v[60:63], a[56:59], a[44:47], v[60:63]
v_mfma_f32_16x16x32_bf16 v[64:67], a[60:63], a[32:35], v[64:67]
v_mfma_f32_16x16x32_bf16 v[68:71], a[60:63], a[36:39], v[68:71]
v_mfma_f32_16x16x32_bf16 v[72:75], a[60:63], a[40:43], v[72:75]
v_mfma_f32_16x16x32_bf16 v[76:79], a[60:63], a[44:47], v[76:79]
s_waitcnt lgkmcnt(0)
s_barrier
v_mfma_f32_16x16x32_bf16 v[16:19], a[80:83], a[64:67], v[16:19]
ds_read_b64_tr_b16 a[16:17], v135 offset:0
ds_read_b64_tr_b16 a[18:19], v135 offset:2048
v_mfma_f32_16x16x32_bf16 v[20:23], a[80:83], a[68:71], v[20:23]
ds_read_b64_tr_b16 a[20:21], v136 offset:0
ds_read_b64_tr_b16 a[22:23], v136 offset:2048
v_mfma_f32_16x16x32_bf16 v[24:27], a[80:83], a[72:75], v[24:27]
ds_read_b64_tr_b16 a[24:25], v135 offset:8192
ds_read_b64_tr_b16 a[26:27], v135 offset:10240
v_mfma_f32_16x16x32_bf16 v[28:31], a[80:83], a[76:79], v[28:31]
ds_read_b64_tr_b16 a[28:29], v136 offset:8192
ds_read_b64_tr_b16 a[30:31], v136 offset:10240
v_mfma_f32_16x16x32_bf16 v[32:35], a[84:87], a[64:67], v[32:35]
ds_read_b128 a[0:3], v134 offset:0
ds_read_b128 a[4:7], v134 offset:2048
v_mfma_f32_16x16x32_bf16 v[36:39], a[84:87], a[68:71], v[36:39]
ds_read_b128 a[8:11], v134 offset:4096
ds_read_b128 a[12:15], v134 offset:6144
v_mfma_f32_16x16x32_bf16 v[40:43], a[84:87], a[72:75], v[40:43]
ds_read_b64_tr_b16 a[48:49], v135 offset:4096
ds_read_b64_tr_b16 a[50:51], v135 offset:6144
v_mfma_f32_16x16x32_bf16 v[44:47], a[84:87], a[76:79], v[44:47]
ds_read_b64_tr_b16 a[52:53], v136 offset:4096
ds_read_b64_tr_b16 a[54:55], v136 offset:6144
v_mfma_f32_16x16x32_bf16 v[48:51], a[88:91], a[64:67], v[48:51]
ds_read_b64_tr_b16 a[56:57], v135 offset:12288
ds_read_b64_tr_b16 a[58:59], v135 offset:14336
v_mfma_f32_16x16x32_bf16 v[52:55], a[88:91], a[68:71], v[52:55]
ds_read_b64_tr_b16 a[60:61], v136 offset:12288
ds_read_b64_tr_b16 a[62:63], v136 offset:14336
v_mfma_f32_16x16x32_bf16 v[56:59], a[88:91], a[72:75], v[56:59]
ds_read_b128 a[32:35], v134 offset:1024
ds_read_b128 a[36:39], v134 offset:3072
v_mfma_f32_16x16x32_bf16 v[60:63], a[88:91], a[76:79], v[60:63]
ds_read_b128 a[40:43], v134 offset:5120
ds_read_b128 a[44:47], v134 offset:7168
v_mfma_f32_16x16x32_bf16 v[64:67], a[92:95], a[64:67], v[64:67]
v_mfma_f32_16x16x32_bf16 v[68:71], a[92:95], a[68:71], v[68:71]
v_mfma_f32_16x16x32_bf16 v[72:75], a[92:95], a[72:75], v[72:75]
v_mfma_f32_16x16x32_bf16 v[76:79], a[92:95], a[76:79], v[76:79]
v_mfma_f32_16x16x32_bf16 v[16:19], v[96:99], v[80:83], v[16:19]
v_mfma_f32_16x16x32_bf16 v[20:23], v[96:99], v[84:87], v[20:23]
v_mfma_f32_16x16x32_bf16 v[24:27], v[96:99], v[88:91], v[24:27]
v_mfma_f32_16x16x32_bf16 v[28:31], v[96:99], v[92:95], v[28:31]
v_mfma_f32_16x16x32_bf16 v[32:35], v[100:103], v[80:83], v[32:35]
v_mfma_f32_16x16x32_bf16 v[36:39], v[100:103], v[84:87], v[36:39]
v_mfma_f32_16x16x32_bf16 v[40:43], v[100:103], v[88:91], v[40:43]
v_mfma_f32_16x16x32_bf16 v[44:47], v[100:103], v[92:95], v[44:47]
v_mfma_f32_16x16x32_bf16 v[48:51], v[104:107], v[80:83], v[48:51]
v_mfma_f32_16x16x32_bf16 v[52:55], v[104:107], v[84:87], v[52:55]
v_mfma_f32_16x16x32_bf16 v[56:59], v[104:107], v[88:91], v[56:59]
v_mfma_f32_16x16x32_bf16 v[60:63], v[104:107], v[92:95], v[60:63]
v_mfma_f32_16x16x32_bf16 v[64:67], v[108:111], v[80:83], v[64:67]
v_mfma_f32_16x16x32_bf16 v[68:71], v[108:111], v[84:87], v[68:71]
v_mfma_f32_16x16x32_bf16 v[72:75], v[108:111], v[88:91], v[72:75]
v_mfma_f32_16x16x32_bf16 v[76:79], v[108:111], v[92:95], v[76:79]
s_waitcnt lgkmcnt(0)
s_barrier
v_mfma_f32_16x16x32_bf16 v[16:19], a[16:19], a[0:3], v[16:19]
ds_read_b64_tr_b16 a[80:81], v138 offset:0
ds_read_b64_tr_b16 a[82:83], v138 offset:2048
v_mfma_f32_16x16x32_bf16 v[20:23], a[16:19], a[4:7], v[20:23]
ds_read_b64_tr_b16 a[84:85], v139 offset:0
ds_read_b64_tr_b16 a[86:87], v139 offset:2048
v_mfma_f32_16x16x32_bf16 v[24:27], a[16:19], a[8:11], v[24:27]
ds_read_b64_tr_b16 a[88:89], v138 offset:8192
ds_read_b64_tr_b16 a[90:91], v138 offset:10240
v_mfma_f32_16x16x32_bf16 v[28:31], a[16:19], a[12:15], v[28:31]
ds_read_b64_tr_b16 a[92:93], v139 offset:8192
ds_read_b64_tr_b16 a[94:95], v139 offset:10240
v_mfma_f32_16x16x32_bf16 v[32:35], a[20:23], a[0:3], v[32:35]
ds_read_b128 a[64:67], v137 offset:0
ds_read_b128 a[68:71], v137 offset:2048
v_mfma_f32_16x16x32_bf16 v[36:39], a[20:23], a[4:7], v[36:39]
ds_read_b128 a[72:75], v137 offset:4096
ds_read_b128 a[76:79], v137 offset:6144
v_mfma_f32_16x16x32_bf16 v[40:43], a[20:23], a[8:11], v[40:43]
ds_read_b64_tr_b16 v[96:97], v138 offset:4096
ds_read_b64_tr_b16 v[98:99], v138 offset:6144
v_mfma_f32_16x16x32_bf16 v[44:47], a[20:23], a[12:15], v[44:47]
ds_read_b64_tr_b16 v[100:101], v139 offset:4096
ds_read_b64_tr_b16 v[102:103], v139 offset:6144
v_mfma_f32_16x16x32_bf16 v[48:51], a[24:27], a[0:3], v[48:51]
ds_read_b64_tr_b16 v[104:105], v138 offset:12288
ds_read_b64_tr_b16 v[106:107], v138 offset:14336
v_mfma_f32_16x16x32_bf16 v[52:55], a[24:27], a[4:7], v[52:55]
ds_read_b64_tr_b16 v[108:109], v139 offset:12288
ds_read_b64_tr_b16 v[110:111], v139 offset:14336
v_mfma_f32_16x16x32_bf16 v[56:59], a[24:27], a[8:11], v[56:59]
ds_read_b128 v[80:83], v137 offset:1024
ds_read_b128 v[84:87], v137 offset:3072
v_mfma_f32_16x16x32_bf16 v[60:63], a[24:27], a[12:15], v[60:63]
ds_read_b128 v[88:91], v137 offset:5120
ds_read_b128 v[92:95], v137 offset:7168
v_mfma_f32_16x16x32_bf16 v[64:67], a[28:31], a[0:3], v[64:67]
v_mfma_f32_16x16x32_bf16 v[68:71], a[28:31], a[4:7], v[68:71]
v_mfma_f32_16x16x32_bf16 v[72:75], a[28:31], a[8:11], v[72:75]
v_mfma_f32_16x16x32_bf16 v[76:79], a[28:31], a[12:15], v[76:79]
v_mfma_f32_16x16x32_bf16 v[16:19], a[48:51], a[32:35], v[16:19]
v_mfma_f32_16x16x32_bf16 v[20:23], a[48:51], a[36:39], v[20:23]
v_mfma_f32_16x16x32_bf16 v[24:27], a[48:51], a[40:43], v[24:27]
v_mfma_f32_16x16x32_bf16 v[28:31], a[48:51], a[44:47], v[28:31]
v_mfma_f32_16x16x32_bf16 v[32:35], a[52:55], a[32:35], v[32:35]
v_mfma_f32_16x16x32_bf16 v[36:39], a[52:55], a[36:39], v[36:39]
v_mfma_f32_16x16x32_bf16 v[40:43], a[52:55], a[40:43], v[40:43]
v_mfma_f32_16x16x32_bf16 v[44:47], a[52:55], a[44:47], v[44:47]
v_mfma_f32_16x16x32_bf16 v[48:51], a[56:59], a[32:35], v[48:51]
v_mfma_f32_16x16x32_bf16 v[52:55], a[56:59], a[36:39], v[52:55]
v_mfma_f32_16x16x32_bf16 v[56:59], a[56:59], a[40:43], v[56:59]
v_mfma_f32_16x16x32_bf16 v[60:63], a[56:59], a[44:47], v[60:63]
v_mfma_f32_16x16x32_bf16 v[64:67], a[60:63], a[32:35], v[64:67]
v_mfma_f32_16x16x32_bf16 v[68:71], a[60:63], a[36:39], v[68:71]
v_mfma_f32_16x16x32_bf16 v[72:75], a[60:63], a[40:43], v[72:75]
v_mfma_f32_16x16x32_bf16 v[76:79], a[60:63], a[44:47], v[76:79]
s_waitcnt lgkmcnt(0)
s_barrier
v_mfma_f32_16x16x32_bf16 v[16:19], a[80:83], a[64:67], v[16:19]
ds_read_b64_tr_b16 a[16:17], v129 offset:0
ds_read_b64_tr_b16 a[18:19], v129 offset:2048
v_mfma_f32_16x16x32_bf16 v[20:23], a[80:83], a[68:71], v[20:23]
ds_read_b64_tr_b16 a[20:21], v130 offset:0
ds_read_b64_tr_b16 a[22:23], v130 offset:2048
v_mfma_f32_16x16x32_bf16 v[24:27], a[80:83], a[72:75], v[24:27]
ds_read_b128 a[0:3], v128 offset:0
ds_read_b128 a[4:7], v128 offset:2048
v_mfma_f32_16x16x32_bf16 v[28:31], a[80:83], a[76:79], v[28:31]
ds_read_b128 a[8:11], v128 offset:4096
ds_read_b128 a[12:15], v128 offset:6144
v_mfma_f32_16x16x32_bf16 v[32:35], a[84:87], a[64:67], v[32:35]
ds_read_b64_tr_b16 a[48:49], v129 offset:4096
ds_read_b64_tr_b16 a[50:51], v129 offset:6144
v_mfma_f32_16x16x32_bf16 v[36:39], a[84:87], a[68:71], v[36:39]
ds_read_b64_tr_b16 a[52:53], v130 offset:4096
ds_read_b64_tr_b16 a[54:55], v130 offset:6144
v_mfma_f32_16x16x32_bf16 v[40:43], a[84:87], a[72:75], v[40:43]
ds_read_b128 a[32:35], v128 offset:1024
ds_read_b128 a[36:39], v128 offset:3072
v_mfma_f32_16x16x32_bf16 v[44:47], a[84:87], a[76:79], v[44:47]
ds_read_b128 a[40:43], v128 offset:5120
ds_read_b128 a[44:47], v128 offset:7168
v_mfma_f32_16x16x32_bf16 v[48:51], a[88:91], a[64:67], v[48:51]
v_mfma_f32_16x16x32_bf16 v[52:55], a[88:91], a[68:71], v[52:55]
v_mfma_f32_16x16x32_bf16 v[56:59], a[88:91], a[72:75], v[56:59]
v_mfma_f32_16x16x32_bf16 v[60:63], a[88:91], a[76:79], v[60:63]
v_mfma_f32_16x16x32_bf16 v[64:67], a[92:95], a[64:67], v[64:67]
v_mfma_f32_16x16x32_bf16 v[68:71], a[92:95], a[68:71], v[68:71]
v_mfma_f32_16x16x32_bf16 v[72:75], a[92:95], a[72:75], v[72:75]
v_mfma_f32_16x16x32_bf16 v[76:79], a[92:95], a[76:79], v[76:79]
v_mfma_f32_16x16x32_bf16 v[16:19], v[96:99], v[80:83], v[16:19]
v_mfma_f32_16x16x32_bf16 v[20:23], v[96:99], v[84:87], v[20:23]
v_mfma_f32_16x16x32_bf16 v[24:27], v[96:99], v[88:91], v[24:27]
v_mfma_f32_16x16x32_bf16 v[28:31], v[96:99], v[92:95], v[28:31]
v_mfma_f32_16x16x32_bf16 v[32:35], v[100:103], v[80:83], v[32:35]
v_mfma_f32_16x16x32_bf16 v[36:39], v[100:103], v[84:87], v[36:39]
v_mfma_f32_16x16x32_bf16 v[40:43], v[100:103], v[88:91], v[40:43]
v_mfma_f32_16x16x32_bf16 v[44:47], v[100:103], v[92:95], v[44:47]
v_mfma_f32_16x16x32_bf16 v[48:51], v[104:107], v[80:83], v[48:51]
v_mfma_f32_16x16x32_bf16 v[52:55], v[104:107], v[84:87], v[52:55]
v_mfma_f32_16x16x32_bf16 v[56:59], v[104:107], v[88:91], v[56:59]
v_mfma_f32_16x16x32_bf16 v[60:63], v[104:107], v[92:95], v[60:63]
v_mfma_f32_16x16x32_bf16 v[64:67], v[108:111], v[80:83], v[64:67]
v_mfma_f32_16x16x32_bf16 v[68:71], v[108:111], v[84:87], v[68:71]
v_mfma_f32_16x16x32_bf16 v[72:75], v[108:111], v[88:91], v[72:75]
v_mfma_f32_16x16x32_bf16 v[76:79], v[108:111], v[92:95], v[76:79]
s_waitcnt lgkmcnt(0)
s_barrier
s_lshl_b32 s46, s8, 4
s_xor_b32 s11, s9, 0
s_add_u32 s46, s46, s11
s_lshl_b32 s46, s46, 2
s_add_u32 s46, s46, s5
s_lshl_b32 s47, s46, 2
s_add_u32 s47, s47, 27668480
s_lshl_b32 s46, s46, 13
s_add_u32 s46, s46, 41943040
s_add_u32 s48, s46, 4096
v_lshlrev_b32 v144, 4, v1
s_nop 4
v_mfma_f32_16x16x32_bf16 v[16:19], a[16:19], a[0:3], v[16:19]
ds_read_b64_tr_b16 a[80:81], v132 offset:0
v_mfma_f32_16x16x32_bf16 v[20:23], a[16:19], a[4:7], v[20:23]
buffer_store_dwordx4 v[48:51], v144, s[24:27], s46 offen offset:0 sc1
ds_read_b64_tr_b16 a[82:83], v132 offset:2048
v_mfma_f32_16x16x32_bf16 v[24:27], a[16:19], a[8:11], v[24:27]
ds_read_b64_tr_b16 a[84:85], v133 offset:0
v_mfma_f32_16x16x32_bf16 v[28:31], a[16:19], a[12:15], v[28:31]
ds_read_b64_tr_b16 a[86:87], v133 offset:2048
v_mfma_f32_16x16x32_bf16 v[32:35], a[20:23], a[0:3], v[32:35]
ds_read_b128 a[64:67], v131 offset:0
v_mfma_f32_16x16x32_bf16 v[36:39], a[20:23], a[4:7], v[36:39]
buffer_store_dwordx4 v[52:55], v144, s[24:27], s46 offen offset:1024 sc1
ds_read_b128 a[68:71], v131 offset:2048
v_mfma_f32_16x16x32_bf16 v[40:43], a[20:23], a[8:11], v[40:43]
ds_read_b128 a[72:75], v131 offset:4096
v_mfma_f32_16x16x32_bf16 v[44:47], a[20:23], a[12:15], v[44:47]
ds_read_b128 a[76:79], v131 offset:6144
v_mfma_f32_16x16x32_bf16 v[16:19], a[48:51], a[32:35], v[16:19]
ds_read_b64_tr_b16 v[96:97], v132 offset:4096
v_mfma_f32_16x16x32_bf16 v[20:23], a[48:51], a[36:39], v[20:23]
buffer_store_dwordx4 v[56:59], v144, s[24:27], s46 offen offset:2048 sc1
ds_read_b64_tr_b16 v[98:99], v132 offset:6144
v_mfma_f32_16x16x32_bf16 v[24:27], a[48:51], a[40:43], v[24:27]
ds_read_b64_tr_b16 v[100:101], v133 offset:4096
v_mfma_f32_16x16x32_bf16 v[28:31], a[48:51], a[44:47], v[28:31]
ds_read_b64_tr_b16 v[102:103], v133 offset:6144
v_mfma_f32_16x16x32_bf16 v[32:35], a[52:55], a[32:35], v[32:35]
ds_read_b128 v[80:83], v131 offset:1024
v_mfma_f32_16x16x32_bf16 v[36:39], a[52:55], a[36:39], v[36:39]
buffer_store_dwordx4 v[60:63], v144, s[24:27], s46 offen offset:3072 sc1
ds_read_b128 v[84:87], v131 offset:3072
v_mfma_f32_16x16x32_bf16 v[40:43], a[52:55], a[40:43], v[40:43]
ds_read_b128 v[88:91], v131 offset:5120
v_mfma_f32_16x16x32_bf16 v[44:47], a[52:55], a[44:47], v[44:47]
ds_read_b128 v[92:95], v131 offset:7168
s_waitcnt lgkmcnt(0)
s_barrier
v_mfma_f32_16x16x32_bf16 v[16:19], a[80:83], a[64:67], v[16:19]
ds_read_b64_tr_b16 a[16:17], v135 offset:0
v_mfma_f32_16x16x32_bf16 v[20:23], a[80:83], a[68:71], v[20:23]
buffer_store_dwordx4 v[64:67], v144, s[24:27], s48 offen offset:0 sc1
ds_read_b64_tr_b16 a[18:19], v135 offset:2048
v_mfma_f32_16x16x32_bf16 v[24:27], a[80:83], a[72:75], v[24:27]
ds_read_b64_tr_b16 a[20:21], v136 offset:0
v_mfma_f32_16x16x32_bf16 v[28:31], a[80:83], a[76:79], v[28:31]
ds_read_b64_tr_b16 a[22:23], v136 offset:2048
v_mfma_f32_16x16x32_bf16 v[32:35], a[84:87], a[64:67], v[32:35]
ds_read_b128 a[0:3], v134 offset:0
v_mfma_f32_16x16x32_bf16 v[36:39], a[84:87], a[68:71], v[36:39]
buffer_store_dwordx4 v[68:71], v144, s[24:27], s48 offen offset:1024 sc1
ds_read_b128 a[4:7], v134 offset:2048
v_mfma_f32_16x16x32_bf16 v[40:43], a[84:87], a[72:75], v[40:43]
ds_read_b128 a[8:11], v134 offset:4096
v_mfma_f32_16x16x32_bf16 v[44:47], a[84:87], a[76:79], v[44:47]
ds_read_b128 a[12:15], v134 offset:6144
v_mfma_f32_16x16x32_bf16 v[16:19], v[96:99], v[80:83], v[16:19]
ds_read_b64_tr_b16 a[48:49], v135 offset:4096
v_mfma_f32_16x16x32_bf16 v[20:23], v[96:99], v[84:87], v[20:23]
buffer_store_dwordx4 v[72:75], v144, s[24:27], s48 offen offset:2048 sc1
ds_read_b64_tr_b16 a[50:51], v135 offset:6144
v_mfma_f32_16x16x32_bf16 v[24:27], v[96:99], v[88:91], v[24:27]
ds_read_b64_tr_b16 a[52:53], v136 offset:4096
v_mfma_f32_16x16x32_bf16 v[28:31], v[96:99], v[92:95], v[28:31]
ds_read_b64_tr_b16 a[54:55], v136 offset:6144
v_mfma_f32_16x16x32_bf16 v[32:35], v[100:103], v[80:83], v[32:35]
ds_read_b128 a[32:35], v134 offset:1024
v_mfma_f32_16x16x32_bf16 v[36:39], v[100:103], v[84:87], v[36:39]
buffer_store_dwordx4 v[76:79], v144, s[24:27], s48 offen offset:3072 sc1
ds_read_b128 a[36:39], v134 offset:3072
v_mfma_f32_16x16x32_bf16 v[40:43], v[100:103], v[88:91], v[40:43]
ds_read_b128 a[40:43], v134 offset:5120
v_mfma_f32_16x16x32_bf16 v[44:47], v[100:103], v[92:95], v[44:47]
ds_read_b128 a[44:47], v134 offset:7168
s_waitcnt lgkmcnt(0)
s_barrier
v_mfma_f32_16x16x32_bf16 v[16:19], a[16:19], a[0:3], v[16:19]
ds_read_b64_tr_b16 a[80:81], v138 offset:0
ds_read_b64_tr_b16 a[82:83], v138 offset:2048
v_mfma_f32_16x16x32_bf16 v[20:23], a[16:19], a[4:7], v[20:23]
ds_read_b64_tr_b16 a[84:85], v139 offset:0
ds_read_b64_tr_b16 a[86:87], v139 offset:2048
v_mfma_f32_16x16x32_bf16 v[24:27], a[16:19], a[8:11], v[24:27]
ds_read_b128 a[64:67], v137 offset:0
ds_read_b128 a[68:71], v137 offset:2048
v_mfma_f32_16x16x32_bf16 v[28:31], a[16:19], a[12:15], v[28:31]
ds_read_b128 a[72:75], v137 offset:4096
ds_read_b128 a[76:79], v137 offset:6144
v_mfma_f32_16x16x32_bf16 v[32:35], a[20:23], a[0:3], v[32:35]
ds_read_b64_tr_b16 v[96:97], v138 offset:4096
ds_read_b64_tr_b16 v[98:99], v138 offset:6144
v_mfma_f32_16x16x32_bf16 v[36:39], a[20:23], a[4:7], v[36:39]
ds_read_b64_tr_b16 v[100:101], v139 offset:4096
ds_read_b64_tr_b16 v[102:103], v139 offset:6144
v_mfma_f32_16x16x32_bf16 v[40:43], a[20:23], a[8:11], v[40:43]
ds_read_b128 v[80:83], v137 offset:1024
ds_read_b128 v[84:87], v137 offset:3072
v_mfma_f32_16x16x32_bf16 v[44:47], a[20:23], a[12:15], v[44:47]
ds_read_b128 v[88:91], v137 offset:5120
ds_read_b128 v[92:95], v137 offset:7168
v_mfma_f32_16x16x32_bf16 v[16:19], a[48:51], a[32:35], v[16:19]
v_mfma_f32_16x16x32_bf16 v[20:23], a[48:51], a[36:39], v[20:23]
v_mfma_f32_16x16x32_bf16 v[24:27], a[48:51], a[40:43], v[24:27]
v_mfma_f32_16x16x32_bf16 v[28:31], a[48:51], a[44:47], v[28:31]
v_mfma_f32_16x16x32_bf16 v[32:35], a[52:55], a[32:35], v[32:35]
v_mfma_f32_16x16x32_bf16 v[36:39], a[52:55], a[36:39], v[36:39]
v_mfma_f32_16x16x32_bf16 v[40:43], a[52:55], a[40:43], v[40:43]
v_mfma_f32_16x16x32_bf16 v[44:47], a[52:55], a[44:47], v[44:47]
s_waitcnt lgkmcnt(0)
s_barrier
s_waitcnt vmcnt(0)
v_mov_b32 v142, 0
v_mov_b32 v143, s97
buffer_store_dword v143, v142, s[24:27], s47 offen sc1
v_mfma_f32_16x16x32_bf16 v[16:19], a[80:83], a[64:67], v[16:19]
ds_read_b64_tr_b16 a[16:17], v129 offset:0
ds_read_b64_tr_b16 a[18:19], v129 offset:2048
v_mfma_f32_16x16x32_bf16 v[20:23], a[80:83], a[68:71], v[20:23]
ds_read_b64_tr_b16 a[20:21], v130 offset:0
ds_read_b64_tr_b16 a[22:23], v130 offset:2048
v_mfma_f32_16x16x32_bf16 v[24:27], a[80:83], a[72:75], v[24:27]
ds_read_b128 a[0:3], v128 offset:0
ds_read_b128 a[4:7], v128 offset:2048
v_mfma_f32_16x16x32_bf16 v[28:31], a[80:83], a[76:79], v[28:31]
ds_read_b128 a[8:11], v128 offset:4096
ds_read_b128 a[12:15], v128 offset:6144
v_mfma_f32_16x16x32_bf16 v[32:35], a[84:87], a[64:67], v[32:35]
ds_read_b64_tr_b16 a[48:49], v129 offset:4096
ds_read_b64_tr_b16 a[50:51], v129 offset:6144
v_mfma_f32_16x16x32_bf16 v[36:39], a[84:87], a[68:71], v[36:39]
ds_read_b64_tr_b16 a[52:53], v130 offset:4096
ds_read_b64_tr_b16 a[54:55], v130 offset:6144
v_mfma_f32_16x16x32_bf16 v[40:43], a[84:87], a[72:75], v[40:43]
ds_read_b128 a[32:35], v128 offset:1024
ds_read_b128 a[36:39], v128 offset:3072
v_mfma_f32_16x16x32_bf16 v[44:47], a[84:87], a[76:79], v[44:47]
ds_read_b128 a[40:43], v128 offset:5120
ds_read_b128 a[44:47], v128 offset:7168
v_mfma_f32_16x16x32_bf16 v[16:19], v[96:99], v[80:83], v[16:19]
v_mfma_f32_16x16x32_bf16 v[20:23], v[96:99], v[84:87], v[20:23]
v_mfma_f32_16x16x32_bf16 v[24:27], v[96:99], v[88:91], v[24:27]
v_mfma_f32_16x16x32_bf16 v[28:31], v[96:99], v[92:95], v[28:31]
v_mfma_f32_16x16x32_bf16 v[32:35], v[100:103], v[80:83], v[32:35]
v_mfma_f32_16x16x32_bf16 v[36:39], v[100:103], v[84:87], v[36:39]
v_mfma_f32_16x16x32_bf16 v[40:43], v[100:103], v[88:91], v[40:43]
v_mfma_f32_16x16x32_bf16 v[44:47], v[100:103], v[92:95], v[44:47]
s_waitcnt lgkmcnt(0)
s_barrier
v_mfma_f32_16x16x32_bf16 v[16:19], a[16:19], a[0:3], v[16:19]
ds_read_b64_tr_b16 a[80:81], v132 offset:0
ds_read_b64_tr_b16 a[82:83], v132 offset:2048
v_mfma_f32_16x16x32_bf16 v[20:23], a[16:19], a[4:7], v[20:23]
ds_read_b64_tr_b16 a[84:85], v133 offset:0
ds_read_b64_tr_b16 a[86:87], v133 offset:2048
v_mfma_f32_16x16x32_bf16 v[24:27], a[16:19], a[8:11], v[24:27]
ds_read_b128 a[64:67], v131 offset:0
ds_read_b128 a[68:71], v131 offset:2048
v_mfma_f32_16x16x32_bf16 v[28:31], a[16:19], a[12:15], v[28:31]
ds_read_b128 a[72:75], v131 offset:4096
ds_read_b128 a[76:79], v131 offset:6144
v_mfma_f32_16x16x32_bf16 v[32:35], a[20:23], a[0:3], v[32:35]
ds_read_b64_tr_b16 v[96:97], v132 offset:4096
ds_read_b64_tr_b16 v[98:99], v132 offset:6144
v_mfma_f32_16x16x32_bf16 v[36:39], a[20:23], a[4:7], v[36:39]
ds_read_b64_tr_b16 v[100:101], v133 offset:4096
ds_read_b64_tr_b16 v[102:103], v133 offset:6144
v_mfma_f32_16x16x32_bf16 v[40:43], a[20:23], a[8:11], v[40:43]
ds_read_b128 v[80:83], v131 offset:1024
ds_read_b128 v[84:87], v131 offset:3072
v_mfma_f32_16x16x32_bf16 v[44:47], a[20:23], a[12:15], v[44:47]
ds_read_b128 v[88:91], v131 offset:5120
ds_read_b128 v[92:95], v131 offset:7168
v_mfma_f32_16x16x32_bf16 v[16:19], a[48:51], a[32:35], v[16:19]
v_mfma_f32_16x16x32_bf16 v[20:23], a[48:51], a[36:39], v[20:23]
v_mfma_f32_16x16x32_bf16 v[24:27], a[48:51], a[40:43], v[24:27]
v_mfma_f32_16x16x32_bf16 v[28:31], a[48:51], a[44:47], v[28:31]
v_mfma_f32_16x16x32_bf16 v[32:35], a[52:55], a[32:35], v[32:35]
v_mfma_f32_16x16x32_bf16 v[36:39], a[52:55], a[36:39], v[36:39]
v_mfma_f32_16x16x32_bf16 v[40:43], a[52:55], a[40:43], v[40:43]
v_mfma_f32_16x16x32_bf16 v[44:47], a[52:55], a[44:47], v[44:47]
s_waitcnt lgkmcnt(0)
s_barrier
v_mfma_f32_16x16x32_bf16 v[16:19], a[80:83], a[64:67], v[16:19]
ds_read_b64_tr_b16 a[16:17], v135 offset:0
ds_read_b64_tr_b16 a[18:19], v135 offset:2048
v_mfma_f32_16x16x32_bf16 v[20:23], a[80:83], a[68:71], v[20:23]
ds_read_b64_tr_b16 a[20:21], v136 offset:0
ds_read_b64_tr_b16 a[22:23], v136 offset:2048
v_mfma_f32_16x16x32_bf16 v[24:27], a[80:83], a[72:75], v[24:27]
ds_read_b128 a[0:3], v134 offset:0
ds_read_b128 a[4:7], v134 offset:2048
v_mfma_f32_16x16x32_bf16 v[28:31], a[80:83], a[76:79], v[28:31]
ds_read_b128 a[8:11], v134 offset:4096
ds_read_b128 a[12:15], v134 offset:6144
v_mfma_f32_16x16x32_bf16 v[32:35], a[84:87], a[64:67], v[32:35]
ds_read_b64_tr_b16 a[48:49], v135 offset:4096
ds_read_b64_tr_b16 a[50:51], v135 offset:6144
v_mfma_f32_16x16x32_bf16 v[36:39], a[84:87], a[68:71], v[36:39]
ds_read_b64_tr_b16 a[52:53], v136 offset:4096
ds_read_b64_tr_b16 a[54:55], v136 offset:6144
v_mfma_f32_16x16x32_bf16 v[40:43], a[84:87], a[72:75], v[40:43]
ds_read_b128 a[32:35], v134 offset:1024
ds_read_b128 a[36:39], v134 offset:3072
v_mfma_f32_16x16x32_bf16 v[44:47], a[84:87], a[76:79], v[44:47]
ds_read_b128 a[40:43], v134 offset:5120
ds_read_b128 a[44:47], v134 offset:7168
v_mfma_f32_16x16x32_bf16 v[16:19], v[96:99], v[80:83], v[16:19]
v_mfma_f32_16x16x32_bf16 v[20:23], v[96:99], v[84:87], v[20:23]
v_mfma_f32_16x16x32_bf16 v[24:27], v[96:99], v[88:91], v[24:27]
v_mfma_f32_16x16x32_bf16 v[28:31], v[96:99], v[92:95], v[28:31]
v_mfma_f32_16x16x32_bf16 v[32:35], v[100:103], v[80:83], v[32:35]
v_mfma_f32_16x16x32_bf16 v[36:39], v[100:103], v[84:87], v[36:39]
v_mfma_f32_16x16x32_bf16 v[40:43], v[100:103], v[88:91], v[40:43]
v_mfma_f32_16x16x32_bf16 v[44:47], v[100:103], v[92:95], v[44:47]
s_waitcnt lgkmcnt(0)
s_barrier
s_mov_b32 s28, s84
s_and_b32 s29, s85, 0xffff
s_mov_b32 s30, 2048
s_mov_b32 s31, 0x20000
s_lshl_b32 s10, s8, 7
s_lshl_b32 s11, s44, 6
s_add_u32 s10, s10, s11
v_add_u32 v112, s10, v8
v_lshlrev_b32 v112, 4, v112
v_add_u32 v112, 27262976, v112
buffer_load_dwordx2 v[144:145], v112, s[24:27], 0 offen offset:0 sc1
buffer_load_dwordx2 v[146:147], v112, s[24:27], 0 offen offset:256 sc1
buffer_load_dwordx2 v[148:149], v112, s[24:27], 0 offen offset:512 sc1
buffer_load_dwordx2 v[150:151], v112, s[24:27], 0 offen offset:768 sc1
s_lshl_b32 s10, s9, 6
s_lshl_b32 s11, s45, 5
s_add_u32 s10, s10, s11
v_lshlrev_b32 v113, 2, v9
v_add_u32 v113, s10, v113
v_lshlrev_b32 v113, 1, v113
buffer_load_dwordx2 v[152:153], v113, s[28:31], 0 offen offset:0
buffer_load_dwordx2 v[154:155], v113, s[28:31], 0 offen offset:32
s_lshl_b32 s10, s44, 13
v_lshlrev_b32 v114, 7, v8
v_add_u32 v114, s10, v114
v_and_b32 v115, 1, v9
v_lshlrev_b32 v115, 3, v115
v_add_u32 v114, v114, v115
v_lshrrev_b32 v115, 1, v9
v_and_b32 v116, 7, v8
s_lshl_b32 s10, s45, 2
s_add_u32 s11, s10, 0
v_add_u32 v117, s11, v115
v_xor_b32 v117, v117, v116
v_lshlrev_b32 v117, 4, v117
v_add_u32 v118, v114, v117
v_add_u32 v118, 98304, v118
s_add_u32 s11, s10, 2
v_add_u32 v117, s11, v115
v_xor_b32 v117, v117, v116
v_lshlrev_b32 v117, 4, v117
v_add_u32 v119, v114, v117
v_add_u32 v119, 98304, v119
v_lshrrev_b32 v114, 2, v8
v_lshlrev_b32 v115, 2, v9
v_add_u32 v114, v114, v115
v_and_b32 v115, 7, v114
s_lshl_b32 s10, s45, 5
v_add_u32 v114, s10, v114
v_lshlrev_b32 v114, 8, v114
v_and_b32 v116, 3, v8
v_lshlrev_b32 v116, 3, v116
v_add_u32 v114, v114, v116
v_add_u32 v114, 114688, v114
s_lshl_b32 s10, s44, 2
s_add_u32 s11, s10, 0
v_xor_b32 v117, s11, v115
v_lshlrev_b32 v117, 5, v117
v_add_u32 v120, v114, v117
s_add_u32 s11, s10, 1
v_xor_b32 v117, s11, v115
v_lshlrev_b32 v117, 5, v117
v_add_u32 v121, v114, v117
s_add_u32 s11, s10, 2
v_xor_b32 v117, s11, v115
v_lshlrev_b32 v117, 5, v117
v_add_u32 v122, v114, v117
s_add_u32 s11, s10, 3
v_xor_b32 v117, s11, v115
v_lshlrev_b32 v117, 5, v117
v_add_u32 v123, v114, v117
v_mfma_f32_16x16x32_bf16 v[16:19], a[16:19], a[0:3], v[16:19]
ds_read_b64_tr_b16 a[80:81], v138 offset:0
ds_read_b64_tr_b16 a[82:83], v138 offset:2048
v_mfma_f32_16x16x32_bf16 v[20:23], a[16:19], a[4:7], v[20:23]
ds_read_b64_tr_b16 a[84:85], v139 offset:0
ds_read_b64_tr_b16 a[86:87], v139 offset:2048
v_mfma_f32_16x16x32_bf16 v[24:27], a[16:19], a[8:11], v[24:27]
ds_read_b128 a[64:67], v137 offset:0
ds_read_b128 a[68:71], v137 offset:2048
v_mfma_f32_16x16x32_bf16 v[28:31], a[16:19], a[12:15], v[28:31]
ds_read_b128 a[72:75], v137 offset:4096
ds_read_b128 a[76:79], v137 offset:6144
v_mfma_f32_16x16x32_bf16 v[32:35], a[20:23], a[0:3], v[32:35]
ds_read_b64_tr_b16 v[96:97], v138 offset:4096
ds_read_b64_tr_b16 v[98:99], v138 offset:6144
v_mfma_f32_16x16x32_bf16 v[36:39], a[20:23], a[4:7], v[36:39]
ds_read_b64_tr_b16 v[100:101], v139 offset:4096
ds_read_b64_tr_b16 v[102:103], v139 offset:6144
v_mfma_f32_16x16x32_bf16 v[40:43], a[20:23], a[8:11], v[40:43]
ds_read_b128 v[80:83], v137 offset:1024
ds_read_b128 v[84:87], v137 offset:3072
v_mfma_f32_16x16x32_bf16 v[44:47], a[20:23], a[12:15], v[44:47]
ds_read_b128 v[88:91], v137 offset:5120
ds_read_b128 v[92:95], v137 offset:7168
v_mfma_f32_16x16x32_bf16 v[16:19], a[48:51], a[32:35], v[16:19]
v_mfma_f32_16x16x32_bf16 v[20:23], a[48:51], a[36:39], v[20:23]
v_mfma_f32_16x16x32_bf16 v[24:27], a[48:51], a[40:43], v[24:27]
v_mfma_f32_16x16x32_bf16 v[28:31], a[48:51], a[44:47], v[28:31]
v_mfma_f32_16x16x32_bf16 v[32:35], a[52:55], a[32:35], v[32:35]
v_mfma_f32_16x16x32_bf16 v[36:39], a[52:55], a[36:39], v[36:39]
v_mfma_f32_16x16x32_bf16 v[40:43], a[52:55], a[40:43], v[40:43]
v_mfma_f32_16x16x32_bf16 v[44:47], a[52:55], a[44:47], v[44:47]
s_waitcnt lgkmcnt(0)
s_barrier
v_mfma_f32_16x16x32_bf16 v[16:19], a[80:83], a[64:67], v[16:19]
v_mfma_f32_16x16x32_bf16 v[20:23], a[80:83], a[68:71], v[20:23]
v_mfma_f32_16x16x32_bf16 v[24:27], a[80:83], a[72:75], v[24:27]
v_mfma_f32_16x16x32_bf16 v[28:31], a[80:83], a[76:79], v[28:31]
v_mfma_f32_16x16x32_bf16 v[32:35], a[84:87], a[64:67], v[32:35]
v_mfma_f32_16x16x32_bf16 v[36:39], a[84:87], a[68:71], v[36:39]
v_mfma_f32_16x16x32_bf16 v[40:43], a[84:87], a[72:75], v[40:43]
v_mfma_f32_16x16x32_bf16 v[44:47], a[84:87], a[76:79], v[44:47]
v_mfma_f32_16x16x32_bf16 v[16:19], v[96:99], v[80:83], v[16:19]
v_mfma_f32_16x16x32_bf16 v[20:23], v[96:99], v[84:87], v[20:23]
v_mfma_f32_16x16x32_bf16 v[24:27], v[96:99], v[88:91], v[24:27]
v_mfma_f32_16x16x32_bf16 v[28:31], v[96:99], v[92:95], v[28:31]
v_mfma_f32_16x16x32_bf16 v[32:35], v[100:103], v[80:83], v[32:35]
v_mfma_f32_16x16x32_bf16 v[36:39], v[100:103], v[84:87], v[36:39]
v_mfma_f32_16x16x32_bf16 v[40:43], v[100:103], v[88:91], v[40:43]
v_mfma_f32_16x16x32_bf16 v[44:47], v[100:103], v[92:95], v[44:47]
s_waitcnt lgkmcnt(0)
s_barrier
s_sub_u32 s10, s5, 1
s_lshl_b32 s10, s10, 15
s_cmp_eq_u32 s5, 0
s_cselect_b32 s10, 131072, s10
s_add_u32 s10, s10, 24576
v_lshlrev_b32 v98, 4, v1
v_add_u32 v98, s10, v98
ds_read_b128 v[48:51], v98 offset:0
ds_read_b128 v[52:55], v98 offset:1024
ds_read_b128 v[56:59], v98 offset:2048
ds_read_b128 v[60:63], v98 offset:3072
ds_read_b128 v[64:67], v98 offset:4096
ds_read_b128 v[68:71], v98 offset:5120
ds_read_b128 v[72:75], v98 offset:6144
ds_read_b128 v[76:79], v98 offset:7168
s_waitcnt vmcnt(0)
s_waitcnt lgkmcnt(7)
v_pk_add_f32 v[16:17], v[16:17], v[48:49]
v_pk_add_f32 v[18:19], v[18:19], v[50:51]
s_waitcnt lgkmcnt(6)
v_pk_add_f32 v[20:21], v[20:21], v[52:53]
v_pk_add_f32 v[22:23], v[22:23], v[54:55]
s_waitcnt lgkmcnt(5)
v_pk_add_f32 v[24:25], v[24:25], v[56:57]
v_pk_add_f32 v[26:27], v[26:27], v[58:59]
s_waitcnt lgkmcnt(4)
v_pk_add_f32 v[28:29], v[28:29], v[60:61]
v_pk_add_f32 v[30:31], v[30:31], v[62:63]
s_waitcnt lgkmcnt(3)
v_pk_add_f32 v[32:33], v[32:33], v[64:65]
v_pk_add_f32 v[34:35], v[34:35], v[66:67]
s_waitcnt lgkmcnt(2)
v_pk_add_f32 v[36:37], v[36:37], v[68:69]
v_pk_add_f32 v[38:39], v[38:39], v[70:71]
s_waitcnt lgkmcnt(1)
v_pk_add_f32 v[40:41], v[40:41], v[72:73]
v_pk_add_f32 v[42:43], v[42:43], v[74:75]
s_waitcnt lgkmcnt(0)
v_pk_add_f32 v[44:45], v[44:45], v[76:77]
v_pk_add_f32 v[46:47], v[46:47], v[78:79]
ds_read_b64 v[80:81], v118 offset:0
ds_read_b64_tr_b16 v[82:83], v120 offset:0
v_lshlrev_b32 v124, 16, v152
v_and_b32 v125, 0xffff0000, v152
v_lshlrev_b32 v126, 16, v153
v_and_b32 v127, 0xffff0000, v153
ds_read_b64 v[84:85], v118 offset:2048
ds_read_b64_tr_b16 v[86:87], v121 offset:0
s_waitcnt lgkmcnt(2)
v_lshlrev_b32 v88, 16, v80
v_and_b32 v89, 0xffff0000, v80
v_lshlrev_b32 v90, 16, v81
v_and_b32 v91, 0xffff0000, v81
v_lshlrev_b32 v92, 16, v82
v_and_b32 v93, 0xffff0000, v82
v_lshlrev_b32 v94, 16, v83
v_and_b32 v95, 0xffff0000, v83
v_pk_add_f32 v[16:17], v[16:17], v[124:125]
v_pk_add_f32 v[18:19], v[18:19], v[126:127]
v_pk_add_f32 v[16:17], v[16:17], v[88:89]
v_pk_add_f32 v[18:19], v[18:19], v[90:91]
v_pk_add_f32 v[88:89], v[88:89], v[144:145] op_sel:[0,0] op_sel_hi:[1,0] neg_lo:[0,1] neg_hi:[0,1]
v_pk_add_f32 v[90:91], v[90:91], v[144:145] op_sel:[0,0] op_sel_hi:[1,0] neg_lo:[0,1] neg_hi:[0,1]
v_pk_mul_f32 v[88:89], v[88:89], v[144:145] op_sel:[0,1] op_sel_hi:[1,1]
v_pk_mul_f32 v[90:91], v[90:91], v[144:145] op_sel:[0,1] op_sel_hi:[1,1]
v_pk_fma_f32 v[16:17], v[88:89], v[92:93], v[16:17]
v_pk_fma_f32 v[18:19], v[90:91], v[94:95], v[18:19]
v_cvt_pk_bf16_f32 v96, v16, v17
v_cvt_pk_bf16_f32 v97, v18, v19
ds_write_b64 v118, v[96:97] offset:0
ds_read_b64 v[80:81], v118 offset:4096
ds_read_b64_tr_b16 v[82:83], v122 offset:0
s_waitcnt lgkmcnt(3)
v_lshlrev_b32 v88, 16, v84
v_and_b32 v89, 0xffff0000, v84
v_lshlrev_b32 v90, 16, v85
v_and_b32 v91, 0xffff0000, v85
v_lshlrev_b32 v92, 16, v86
v_and_b32 v93, 0xffff0000, v86
v_lshlrev_b32 v94, 16, v87
v_and_b32 v95, 0xffff0000, v87
v_pk_add_f32 v[20:21], v[20:21], v[124:125]
v_pk_add_f32 v[22:23], v[22:23], v[126:127]
v_pk_add_f32 v[20:21], v[20:21], v[88:89]
v_pk_add_f32 v[22:23], v[22:23], v[90:91]
v_pk_add_f32 v[88:89], v[88:89], v[146:147] op_sel:[0,0] op_sel_hi:[1,0] neg_lo:[0,1] neg_hi:[0,1]
v_pk_add_f32 v[90:91], v[90:91], v[146:147] op_sel:[0,0] op_sel_hi:[1,0] neg_lo:[0,1] neg_hi:[0,1]
v_pk_mul_f32 v[88:89], v[88:89], v[146:147] op_sel:[0,1] op_sel_hi:[1,1]
v_pk_mul_f32 v[90:91], v[90:91], v[146:147] op_sel:[0,1] op_sel_hi:[1,1]
v_pk_fma_f32 v[20:21], v[88:89], v[92:93], v[20:21]
v_pk_fma_f32 v[22:23], v[90:91], v[94:95], v[22:23]
v_cvt_pk_bf16_f32 v96, v20, v21
v_cvt_pk_bf16_f32 v97, v22, v23
ds_write_b64 v118, v[96:97] offset:2048
ds_read_b64 v[84:85], v118 offset:6144
ds_read_b64_tr_b16 v[86:87], v123 offset:0
s_waitcnt lgkmcnt(3)
v_lshlrev_b32 v88, 16, v80
v_and_b32 v89, 0xffff0000, v80
v_lshlrev_b32 v90, 16, v81
v_and_b32 v91, 0xffff0000, v81
v_lshlrev_b32 v92, 16, v82
v_and_b32 v93, 0xffff0000, v82
v_lshlrev_b32 v94, 16, v83
v_and_b32 v95, 0xffff0000, v83
v_pk_add_f32 v[24:25], v[24:25], v[124:125]
v_pk_add_f32 v[26:27], v[26:27], v[126:127]
v_pk_add_f32 v[24:25], v[24:25], v[88:89]
v_pk_add_f32 v[26:27], v[26:27], v[90:91]
v_pk_add_f32 v[88:89], v[88:89], v[148:149] op_sel:[0,0] op_sel_hi:[1,0] neg_lo:[0,1] neg_hi:[0,1]
v_pk_add_f32 v[90:91], v[90:91], v[148:149] op_sel:[0,0] op_sel_hi:[1,0] neg_lo:[0,1] neg_hi:[0,1]
v_pk_mul_f32 v[88:89], v[88:89], v[148:149] op_sel:[0,1] op_sel_hi:[1,1]
v_pk_mul_f32 v[90:91], v[90:91], v[148:149] op_sel:[0,1] op_sel_hi:[1,1]
v_pk_fma_f32 v[24:25], v[88:89], v[92:93], v[24:25]
v_pk_fma_f32 v[26:27], v[90:91], v[94:95], v[26:27]
v_cvt_pk_bf16_f32 v96, v24, v25
v_cvt_pk_bf16_f32 v97, v26, v27
ds_write_b64 v118, v[96:97] offset:4096
ds_read_b64 v[80:81], v119 offset:0
ds_read_b64_tr_b16 v[82:83], v120 offset:4096
s_waitcnt lgkmcnt(3)
v_lshlrev_b32 v88, 16, v84
v_and_b32 v89, 0xffff0000, v84
v_lshlrev_b32 v90, 16, v85
v_and_b32 v91, 0xffff0000, v85
v_lshlrev_b32 v92, 16, v86
v_and_b32 v93, 0xffff0000, v86
v_lshlrev_b32 v94, 16, v87
v_and_b32 v95, 0xffff0000, v87
v_pk_add_f32 v[28:29], v[28:29], v[124:125]
v_pk_add_f32 v[30:31], v[30:31], v[126:127]
v_pk_add_f32 v[28:29], v[28:29], v[88:89]
v_pk_add_f32 v[30:31], v[30:31], v[90:91]
v_pk_add_f32 v[88:89], v[88:89], v[150:151] op_sel:[0,0] op_sel_hi:[1,0] neg_lo:[0,1] neg_hi:[0,1]
v_pk_add_f32 v[90:91], v[90:91], v[150:151] op_sel:[0,0] op_sel_hi:[1,0] neg_lo:[0,1] neg_hi:[0,1]
v_pk_mul_f32 v[88:89], v[88:89], v[150:151] op_sel:[0,1] op_sel_hi:[1,1]
v_pk_mul_f32 v[90:91], v[90:91], v[150:151] op_sel:[0,1] op_sel_hi:[1,1]
v_pk_fma_f32 v[28:29], v[88:89], v[92:93], v[28:29]
v_pk_fma_f32 v[30:31], v[90:91], v[94:95], v[30:31]
v_cvt_pk_bf16_f32 v96, v28, v29
v_cvt_pk_bf16_f32 v97, v30, v31
ds_write_b64 v118, v[96:97] offset:6144
v_lshlrev_b32 v124, 16, v154
v_and_b32 v125, 0xffff0000, v154
v_lshlrev_b32 v126, 16, v155
v_and_b32 v127, 0xffff0000, v155
ds_read_b64 v[84:85], v119 offset:2048
ds_read_b64_tr_b16 v[86:87], v121 offset:4096
s_waitcnt lgkmcnt(3)
v_lshlrev_b32 v88, 16, v80
v_and_b32 v89, 0xffff0000, v80
v_lshlrev_b32 v90, 16, v81
v_and_b32 v91, 0xffff0000, v81
v_lshlrev_b32 v92, 16, v82
v_and_b32 v93, 0xffff0000, v82
v_lshlrev_b32 v94, 16, v83
v_and_b32 v95, 0xffff0000, v83
v_pk_add_f32 v[32:33], v[32:33], v[124:125]
v_pk_add_f32 v[34:35], v[34:35], v[126:127]
v_pk_add_f32 v[32:33], v[32:33], v[88:89]
v_pk_add_f32 v[34:35], v[34:35], v[90:91]
v_pk_add_f32 v[88:89], v[88:89], v[144:145] op_sel:[0,0] op_sel_hi:[1,0] neg_lo:[0,1] neg_hi:[0,1]
v_pk_add_f32 v[90:91], v[90:91], v[144:145] op_sel:[0,0] op_sel_hi:[1,0] neg_lo:[0,1] neg_hi:[0,1]
v_pk_mul_f32 v[88:89], v[88:89], v[144:145] op_sel:[0,1] op_sel_hi:[1,1]
v_pk_mul_f32 v[90:91], v[90:91], v[144:145] op_sel:[0,1] op_sel_hi:[1,1]
v_pk_fma_f32 v[32:33], v[88:89], v[92:93], v[32:33]
v_pk_fma_f32 v[34:35], v[90:91], v[94:95], v[34:35]
v_cvt_pk_bf16_f32 v96, v32, v33
v_cvt_pk_bf16_f32 v97, v34, v35
ds_write_b64 v119, v[96:97] offset:0
ds_read_b64 v[80:81], v119 offset:4096
ds_read_b64_tr_b16 v[82:83], v122 offset:4096
s_waitcnt lgkmcnt(3)
v_lshlrev_b32 v88, 16, v84
v_and_b32 v89, 0xffff0000, v84
v_lshlrev_b32 v90, 16, v85
v_and_b32 v91, 0xffff0000, v85
v_lshlrev_b32 v92, 16, v86
v_and_b32 v93, 0xffff0000, v86
v_lshlrev_b32 v94, 16, v87
v_and_b32 v95, 0xffff0000, v87
v_pk_add_f32 v[36:37], v[36:37], v[124:125]
v_pk_add_f32 v[38:39], v[38:39], v[126:127]
v_pk_add_f32 v[36:37], v[36:37], v[88:89]
v_pk_add_f32 v[38:39], v[38:39], v[90:91]
v_pk_add_f32 v[88:89], v[88:89], v[146:147] op_sel:[0,0] op_sel_hi:[1,0] neg_lo:[0,1] neg_hi:[0,1]
v_pk_add_f32 v[90:91], v[90:91], v[146:147] op_sel:[0,0] op_sel_hi:[1,0] neg_lo:[0,1] neg_hi:[0,1]
v_pk_mul_f32 v[88:89], v[88:89], v[146:147] op_sel:[0,1] op_sel_hi:[1,1]
v_pk_mul_f32 v[90:91], v[90:91], v[146:147] op_sel:[0,1] op_sel_hi:[1,1]
v_pk_fma_f32 v[36:37], v[88:89], v[92:93], v[36:37]
v_pk_fma_f32 v[38:39], v[90:91], v[94:95], v[38:39]
v_cvt_pk_bf16_f32 v96, v36, v37
v_cvt_pk_bf16_f32 v97, v38, v39
ds_write_b64 v119, v[96:97] offset:2048
ds_read_b64 v[84:85], v119 offset:6144
ds_read_b64_tr_b16 v[86:87], v123 offset:4096
s_waitcnt lgkmcnt(3)
v_lshlrev_b32 v88, 16, v80
v_and_b32 v89, 0xffff0000, v80
v_lshlrev_b32 v90, 16, v81
v_and_b32 v91, 0xffff0000, v81
v_lshlrev_b32 v92, 16, v82
v_and_b32 v93, 0xffff0000, v82
v_lshlrev_b32 v94, 16, v83
v_and_b32 v95, 0xffff0000, v83
v_pk_add_f32 v[40:41], v[40:41], v[124:125]
v_pk_add_f32 v[42:43], v[42:43], v[126:127]
v_pk_add_f32 v[40:41], v[40:41], v[88:89]
v_pk_add_f32 v[42:43], v[42:43], v[90:91]
v_pk_add_f32 v[88:89], v[88:89], v[148:149] op_sel:[0,0] op_sel_hi:[1,0] neg_lo:[0,1] neg_hi:[0,1]
v_pk_add_f32 v[90:91], v[90:91], v[148:149] op_sel:[0,0] op_sel_hi:[1,0] neg_lo:[0,1] neg_hi:[0,1]
v_pk_mul_f32 v[88:89], v[88:89], v[148:149] op_sel:[0,1] op_sel_hi:[1,1]
v_pk_mul_f32 v[90:91], v[90:91], v[148:149] op_sel:[0,1] op_sel_hi:[1,1]
v_pk_fma_f32 v[40:41], v[88:89], v[92:93], v[40:41]
v_pk_fma_f32 v[42:43], v[90:91], v[94:95], v[42:43]
v_cvt_pk_bf16_f32 v96, v40, v41
v_cvt_pk_bf16_f32 v97, v42, v43
ds_write_b64 v119, v[96:97] offset:4096
s_waitcnt lgkmcnt(1)
v_lshlrev_b32 v88, 16, v84
v_and_b32 v89, 0xffff0000, v84
v_lshlrev_b32 v90, 16, v85
v_and_b32 v91, 0xffff0000, v85
v_lshlrev_b32 v92, 16, v86
v_and_b32 v93, 0xffff0000, v86
v_lshlrev_b32 v94, 16, v87
v_and_b32 v95, 0xffff0000, v87
v_pk_add_f32 v[44:45], v[44:45], v[124:125]
v_pk_add_f32 v[46:47], v[46:47], v[126:127]
v_pk_add_f32 v[44:45], v[44:45], v[88:89]
v_pk_add_f32 v[46:47], v[46:47], v[90:91]
v_pk_add_f32 v[88:89], v[88:89], v[150:151] op_sel:[0,0] op_sel_hi:[1,0] neg_lo:[0,1] neg_hi:[0,1]
v_pk_add_f32 v[90:91], v[90:91], v[150:151] op_sel:[0,0] op_sel_hi:[1,0] neg_lo:[0,1] neg_hi:[0,1]
v_pk_mul_f32 v[88:89], v[88:89], v[150:151] op_sel:[0,1] op_sel_hi:[1,1]
v_pk_mul_f32 v[90:91], v[90:91], v[150:151] op_sel:[0,1] op_sel_hi:[1,1]
v_pk_fma_f32 v[44:45], v[88:89], v[92:93], v[44:45]
v_pk_fma_f32 v[46:47], v[90:91], v[94:95], v[46:47]
v_cvt_pk_bf16_f32 v96, v44, v45
v_cvt_pk_bf16_f32 v97, v46, v47
ds_write_b64 v119, v[96:97] offset:6144
s_waitcnt lgkmcnt(0)
s_barrier
s_mov_b32 s32, s86
s_and_b32 s33, s87, 0xffff
s_mov_b32 s34, 4194304
s_mov_b32 s35, 0x20000
v_lshrrev_b32 v8, 3, v1
v_and_b32 v9, 7, v1
s_lshl_b32 s10, s4, 4
v_add_u32 v10, s10, v8
v_lshlrev_b32 v11, 7, v10
v_xor_b32 v12, v9, v8
v_lshlrev_b32 v12, 4, v12
v_add_u32 v11, v11, v12
v_add_u32 v11, 98304, v11
s_lshl_b32 s10, s8, 7
v_add_u32 v10, s10, v10
v_lshlrev_b32 v10, 11, v10
v_lshlrev_b32 v9, 4, v9
v_add_u32 v10, v10, v9
s_lshl_b32 s10, s9, 7
ds_read_b128 v[16:19], v11 offset:0
ds_read_b128 v[20:23], v11 offset:1024
s_waitcnt lgkmcnt(1)
s_add_u32 s11, s10, 0
buffer_store_dwordx4 v[16:19], v10, s[32:35], s11 offen
s_waitcnt lgkmcnt(0)
s_add_u32 s11, s10, 16384
buffer_store_dwordx4 v[20:23], v10, s[32:35], s11 offen
s_branch L_end_parallel_sum__ssm_conv_h3__mixer_channel_mlp__prompt_kernel
L_loader_parallel_sum__ssm_conv_h3__mixer_channel_mlp__prompt_kernel:
v_mov_b32 v2, 0
s_mov_b32 s12, 27688960
buffer_load_dword v132, v2, s[24:27], s12 offen sc1
s_cmp_eq_u32 s5, 2
s_cbranch_scc0 L_ipf_9
s_getpc_b64 s[10:11]
L_here_10:
s_sub_u32 s10, s10, L_here_10-parallel_sum__ssm_conv_h3__mixer_channel_mlp__prompt_kernel
s_subb_u32 s11, s11, 0
s_lshr_b32 s3, s2, 3
s_lshl_b32 s3, s3, 4
v_and_b32 v58, 15, v1
v_add_u32 v58, s3, v58
v_lshlrev_b32 v58, 7, v58
v_min_u32 v58, L_end_parallel_sum__ssm_conv_h3__mixer_channel_mlp__prompt_kernel-parallel_sum__ssm_conv_h3__mixer_channel_mlp__prompt_kernel, v58
v_mov_b32 v59, s11
v_add_co_u32 v58, vcc, s10, v58
s_nop 1
v_addc_co_u32 v59, vcc, 0, v59, vcc
s_mov_b64 s[98:99], exec
s_mov_b64 exec, 0xffff
global_load_dword v139, v[58:59], off
s_mov_b64 exec, s[98:99]
L_ipf_9:
s_and_b32 s53, s2, 7
s_lshr_b32 s58, s2, 3
s_lshl_b32 s61, s5, 6
v_add_u32 v143, s61, v1
s_and_b32 s61, s53, 1
s_lshl_b32 s61, s61, 10
s_lshl_b32 s62, s58, 5
s_add_u32 s61, s61, s62
v_and_b32 v48, 31, v143
v_add_u32 v48, s61, v48
v_lshlrev_b32 v48, 11, v48
v_lshrrev_b32 v49, 5, v143
v_lshlrev_b32 v49, 7, v49
v_add_u32 v140, v48, v49
v_mul_u32_u24 v48, 2341, v143
v_lshrrev_b32 v48, 16, v48
v_mul_u32_u24 v49, 28, v48
v_sub_u32 v49, v143, v49
v_cmp_lt_u32 vcc, 13, v49
v_lshlrev_b32 v48, 6, v48
s_nop 0
v_cndmask_b32 v50, 0, 1, vcc
v_add_u32 v48, v48, v50
v_mul_u32_u24 v50, 14, v50
v_sub_u32 v49, v49, v50
s_lshl_b32 s61, s58, 1
v_add_u32 v48, s61, v48
v_mul_u32_u24 v48, 7168, v48
v_lshlrev_b32 v49, 7, v49
v_add_u32 v48, v48, v49
s_lshr_b32 s61, s53, 1
s_mul_i32 s61, s61, 1792
v_add_u32 v141, s61, v48
v_lshlrev_b32 v142, 7, v143
v_cmp_gt_u32 vcc, 56, v143
v_mov_b32 v6, 0x7fffffff
s_mov_b32 s61, 1376256
v_cndmask_b32 v5, v6, v141, vcc
buffer_load_dword v139, v5, s[20:23], s61 offen
s_mov_b32 s28, s66
s_and_b32 s29, s67, 0xffff
s_mov_b32 s30, 4194304
s_mov_b32 s31, 0x20000
s_mov_b32 s32, s68
s_and_b32 s33, s69, 0xffff
s_mov_b32 s34, 4194304
s_mov_b32 s35, 0x20000
s_mov_b32 s36, s70
s_and_b32 s37, s71, 0xffff
s_mov_b32 s38, 8192
s_mov_b32 s39, 0x20000
s_lshl_b32 s61, s6, 7
s_lshl_b32 s62, s7, 3
s_add_u32 s61, s61, s62
s_lshl_b32 s62, s5, 1
s_add_u32 s50, s61, s62
s_lshr_b32 s51, s2, 4
s_and_b32 s52, s2, 15
v_and_b32 v146, 7, v1
v_lshrrev_b32 v147, 3, v1
s_lshl_b32 s61, s5, 3
v_add_u32 v147, s61, v147
v_lshlrev_b32 v48, 2, v147
s_lshl_b32 s61, s51, 7
v_add_u32 v48, s61, v48
v_lshlrev_b32 v49, 4, v146
s_lshl_b32 s61, s52, 7
v_add_u32 v49, s61, v49
v_lshlrev_b32 v48, 11, v48
v_add_u32 v145, v48, v49
v_sub_u32 v48, 31, v147
v_lshlrev_b32 v49, 1, v146
v_xor_b32 v48, v48, v49
v_lshlrev_b32 v48, 3, v48
v_lshlrev_b32 v49, 10, v146
v_add_u32 v48, v48, v49
v_add_u32 v133, 151552, v48
v_lshrrev_b32 v48, 4, v1
s_lshl_b32 s61, s5, 3
v_add_u32 v48, s61, v48
v_and_b32 v49, 15, v1
v_add_u32 v50, 0, v48
v_lshrrev_b32 v51, 2, v50
v_xor_b32 v52, v51, v49
v_lshlrev_b32 v52, 4, v52
v_lshlrev_b32 v53, 8, v50
v_add_u32 v52, v52, v53
v_add_u32 v134, 151552, v52
v_lshlrev_b32 v51, 3, v51
v_and_b32 v50, 3, v50
v_add_u32 v51, v51, v50
v_mul_u32_u24 v51, 4224, v51
v_lshlrev_b32 v53, 4, v49
v_add_u32 v136, v51, v53
v_add_u32 v50, 4, v48
v_lshrrev_b32 v51, 2, v50
v_xor_b32 v52, v51, v49
v_lshlrev_b32 v52, 4, v52
v_lshlrev_b32 v53, 8, v50
v_add_u32 v52, v52, v53
v_add_u32 v135, 151552, v52
v_lshlrev_b32 v51, 3, v51
v_and_b32 v50, 3, v50
v_add_u32 v51, v51, v50
v_mul_u32_u24 v51, 4224, v51
v_lshlrev_b32 v53, 4, v49
v_add_u32 v137, v51, v53
s_lshl_b32 s61, s52, 6
s_mul_i32 s61, s61, 4224
s_add_u32 s61, s61, 16781056
s_lshl_b32 s62, s51, 8
s_sub_u32 s60, s61, s62
s_lshl_b32 s61, s50, 11
v_lshlrev_b32 v2, 4, v1
buffer_load_dwordx4 v[8:11], v2, s[16:19], s61 offen offset:0
buffer_load_dwordx4 v[12:15], v2, s[16:19], s61 offen offset:1024
buffer_load_dwordx4 v[16:19], v2, s[16:19], s61 offen offset:2048
buffer_load_dwordx4 v[20:23], v2, s[16:19], s61 offen offset:3072
s_cmp_ge_u32 s58, 14
s_cselect_b32 s61, 1, 0
s_cmp_ge_u32 s58, 28
s_cselect_b32 s61, 0, s61
s_mul_i32 s62, s61, 14
s_sub_u32 s62, s58, s62
s_min_u32 s62, s62, 13
s_lshr_b32 s63, s53, 1
s_mul_i32 s63, s63, 14
s_add_u32 s62, s62, s63
s_and_b32 s63, s53, 1
s_lshl_b32 s63, s63, 1
s_add_u32 s61, s61, s63
s_lshl_b32 s55, s61, 2
s_add_u32 s55, s55, s5
s_lshl_b32 s55, s55, 6
s_mul_i32 s55, s55, 7168
s_lshl_b32 s63, s62, 7
s_add_u32 s55, s55, s63
s_mul_i32 s61, s61, 3584
s_lshl_b32 s63, s62, 6
s_add_u32 s61, s61, s63
s_lshl_b32 s61, s61, 2
s_add_u32 s54, s61, 27328512
v_lshrrev_b32 v48, 4, v1
v_lshlrev_b32 v48, 1, v48
v_bfe_u32 v49, v1, 3, 1
v_add_u32 v48, v48, v49
v_mul_u32_u24 v48, 7168, v48
v_and_b32 v49, 7, v1
v_lshlrev_b32 v49, 4, v49
v_add_u32 v144, v48, v49
v_and_b32 v49, 7, v1
v_lshlrev_b32 v49, 5, v49
v_lshrrev_b32 v50, 4, v1
v_lshlrev_b32 v48, 4, v50
v_add_u32 v49, v49, v48
s_cmp_lt_u32 s58, 28
s_cselect_b32 s61, 0, 0x20000000
v_add_u32 v138, s61, v49
v_bfe_u32 v48, v1, 3, 1
v_cmp_gt_u32 vcc, 2, v50
v_cmp_eq_u32 s[48:49], 1, v48
s_nop 1
s_and_b64 s[48:49], vcc, s[48:49]
v_and_b32 v48, 15, v1
v_and_b32 v49, 1, v48
v_lshlrev_b32 v49, 4, v49
v_mov_b32 v50, 0x3f80
v_lshlrev_b32 v49, v49, v50
v_lshrrev_b32 v48, 1, v48
v_cmp_eq_u32 vcc, 0, v48
s_nop 1
v_cndmask_b32 v148, 0, v49, vcc
v_cmp_eq_u32 vcc, 1, v48
s_nop 1
v_cndmask_b32 v149, 0, v49, vcc
v_cmp_eq_u32 vcc, 2, v48
s_nop 1
v_cndmask_b32 v150, 0, v49, vcc
v_cmp_eq_u32 vcc, 3, v48
s_nop 1
v_cndmask_b32 v151, 0, v49, vcc
s_barrier
s_barrier
s_waitcnt vmcnt(5)
s_cmp_eq_u32 s5, 0
s_cbranch_scc0 L_w0_11
v_add_u32 v3, 1, v132
v_mov_b32 v2, 163328
ds_write_b32 v2, v3
s_waitcnt lgkmcnt(0)
L_w0_11:
v_subrev_u32 v7, 6144, v145
buffer_load_dwordx4 v[72:75], v7, s[28:31], 0 offen nt
v_subrev_u32 v7, 4096, v145
buffer_load_dwordx4 v[76:79], v7, s[28:31], 0 offen nt
v_subrev_u32 v7, 2048, v145
buffer_load_dwordx4 v[80:83], v7, s[28:31], 0 offen nt
v_add_u32 v7, 0, v145
buffer_load_dwordx4 v[84:87], v7, s[28:31], 0 offen nt
s_barrier
v_mov_b32 v2, 163328
ds_read_b32 v3, v2
s_waitcnt lgkmcnt(0)
v_readfirstlane_b32 s97, v3
s_lshl_b32 s10, s2, 2
s_add_u32 s10, s10, s5
s_lshl_b32 s10, s10, 2
s_add_u32 s59, s10, 27664384
v_add_u32 v7, 2048, v145
buffer_load_dwordx4 v[88:91], v7, s[28:31], 0 offen nt
v_add_u32 v7, 4096, v145
buffer_load_dwordx4 v[92:95], v7, s[28:31], 0 offen nt
v_add_u32 v7, 6144, v145
buffer_load_dwordx4 v[96:99], v7, s[28:31], 0 offen nt
v_lshlrev_b32 v7, 6, v146
s_lshl_b32 s61, s52, 9
v_add_u32 v7, s61, v7
buffer_load_dwordx4 v[116:119], v7, s[36:39], 0 offen offset:0
buffer_load_dwordx4 v[120:123], v7, s[36:39], 0 offen offset:16
buffer_load_dwordx4 v[124:127], v7, s[36:39], 0 offen offset:32
buffer_load_dwordx4 v[128:131], v7, s[36:39], 0 offen offset:48
s_waitcnt vmcnt(11)
v_mov_b32 v24, 0x3f803f80
v_mov_b32 v26, 0
v_mov_b32 v27, 0
v_mov_b32 v28, 0
v_mov_b32 v29, 0
v_dot2c_f32_bf16 v26, v8, v24
v_dot2c_f32_bf16 v28, v8, v8
v_dot2c_f32_bf16 v27, v16, v24
v_dot2c_f32_bf16 v29, v16, v16
v_dot2c_f32_bf16 v26, v9, v24
v_dot2c_f32_bf16 v28, v9, v9
v_dot2c_f32_bf16 v27, v17, v24
v_dot2c_f32_bf16 v29, v17, v17
v_dot2c_f32_bf16 v26, v10, v24
v_dot2c_f32_bf16 v28, v10, v10
v_dot2c_f32_bf16 v27, v18, v24
v_dot2c_f32_bf16 v29, v18, v18
v_dot2c_f32_bf16 v26, v11, v24
v_dot2c_f32_bf16 v28, v11, v11
v_dot2c_f32_bf16 v27, v19, v24
v_dot2c_f32_bf16 v29, v19, v19
v_dot2c_f32_bf16 v26, v12, v24
v_dot2c_f32_bf16 v28, v12, v12
v_dot2c_f32_bf16 v27, v20, v24
v_dot2c_f32_bf16 v29, v20, v20
v_dot2c_f32_bf16 v26, v13, v24
v_dot2c_f32_bf16 v28, v13, v13
s_barrier
v_add_u32 v7, 0, v145
buffer_load_dwordx4 v[100:103], v7, s[32:35], 0 offen nt
v_add_u32 v7, 2048, v145
buffer_load_dwordx4 v[104:107], v7, s[32:35], 0 offen nt
v_add_u32 v7, 4096, v145
buffer_load_dwordx4 v[108:111], v7, s[32:35], 0 offen nt
v_add_u32 v7, 6144, v145
buffer_load_dwordx4 v[112:115], v7, s[32:35], 0 offen nt
v_dot2c_f32_bf16 v27, v21, v24
v_dot2c_f32_bf16 v29, v21, v21
v_dot2c_f32_bf16 v26, v14, v24
v_dot2c_f32_bf16 v28, v14, v14
v_dot2c_f32_bf16 v27, v22, v24
v_dot2c_f32_bf16 v29, v22, v22
v_dot2c_f32_bf16 v26, v15, v24
v_dot2c_f32_bf16 v28, v15, v15
v_dot2c_f32_bf16 v27, v23, v24
v_dot2c_f32_bf16 v29, v23, v23
s_nop 3
v_add_f32_dpp v26, v26, v26 row_shr:1 row_mask:0xf bank_mask:0xf bound_ctrl:1
v_add_f32_dpp v27, v27, v27 row_shr:1 row_mask:0xf bank_mask:0xf bound_ctrl:1
v_add_f32_dpp v28, v28, v28 row_shr:1 row_mask:0xf bank_mask:0xf bound_ctrl:1
v_add_f32_dpp v29, v29, v29 row_shr:1 row_mask:0xf bank_mask:0xf bound_ctrl:1
v_add_f32_dpp v26, v26, v26 row_shr:2 row_mask:0xf bank_mask:0xf bound_ctrl:1
v_add_f32_dpp v27, v27, v27 row_shr:2 row_mask:0xf bank_mask:0xf bound_ctrl:1
v_add_f32_dpp v28, v28, v28 row_shr:2 row_mask:0xf bank_mask:0xf bound_ctrl:1
v_add_f32_dpp v29, v29, v29 row_shr:2 row_mask:0xf bank_mask:0xf bound_ctrl:1
v_add_f32_dpp v26, v26, v26 row_shr:4 row_mask:0xf bank_mask:0xf bound_ctrl:1
v_add_f32_dpp v27, v27, v27 row_shr:4 row_mask:0xf bank_mask:0xf bound_ctrl:1
v_add_f32_dpp v28, v28, v28 row_shr:4 row_mask:0xf bank_mask:0xf bound_ctrl:1
v_add_f32_dpp v29, v29, v29 row_shr:4 row_mask:0xf bank_mask:0xf bound_ctrl:1
v_add_f32_dpp v26, v26, v26 row_shr:8 row_mask:0xf bank_mask:0xf bound_ctrl:1
v_add_f32_dpp v27, v27, v27 row_shr:8 row_mask:0xf bank_mask:0xf bound_ctrl:1
v_add_f32_dpp v28, v28, v28 row_shr:8 row_mask:0xf bank_mask:0xf bound_ctrl:1
v_add_f32_dpp v29, v29, v29 row_shr:8 row_mask:0xf bank_mask:0xf bound_ctrl:1
v_add_f32_dpp v26, v26, v26 row_bcast:15 row_mask:0xa bank_mask:0xf
v_add_f32_dpp v27, v27, v27 row_bcast:15 row_mask:0xa bank_mask:0xf
v_add_f32_dpp v28, v28, v28 row_bcast:15 row_mask:0xa bank_mask:0xf
v_add_f32_dpp v29, v29, v29 row_bcast:15 row_mask:0xa bank_mask:0xf
v_add_f32_dpp v26, v26, v26 row_bcast:31 row_mask:0xc bank_mask:0xf
v_add_f32_dpp v27, v27, v27 row_bcast:31 row_mask:0xc bank_mask:0xf
v_add_f32_dpp v28, v28, v28 row_bcast:31 row_mask:0xc bank_mask:0xf
v_add_f32_dpp v29, v29, v29 row_bcast:31 row_mask:0xc bank_mask:0xf
s_nop 1
v_readlane_b32 s61, v26, 63
v_readlane_b32 s62, v27, 63
v_mov_b32 v30, 0x3a800000
s_nop 0
v_mul_f32 v26, s61, v30
v_mul_f32 v27, s62, v30
v_readlane_b32 s61, v28, 63
v_readlane_b32 s62, v29, 63
v_mov_b32 v31, 0x3727c5ac
s_nop 0
v_mul_f32 v28, s61, v30
v_mul_f32 v29, s62, v30
v_fma_f32 v28, -v26, v26, v28
v_fma_f32 v29, -v27, v27, v29
s_barrier
v_max_f32 v28, 0, v28
v_max_f32 v29, 0, v29
v_add_f32 v32, v28, v31
v_add_f32 v33, v29, v31
v_rsq_f32 v32, v32
v_rsq_f32 v33, v33
v_mov_b32 v36, v26
v_mov_b32 v40, v27
v_mul_f32 v34, v32, v32
v_mul_f32 v35, v33, v33
v_fma_f32 v34, v34, v28, v31
v_fma_f32 v35, v35, v29, v31
v_rsq_f32 v34, v34
v_rsq_f32 v35, v35
v_mov_b32 v37, v32
v_mov_b32 v41, v33
v_mul_f32 v38, v32, v34
v_mul_f32 v42, v33, v35
v_mul_f32 v39, v38, v26
v_mul_f32 v43, v42, v27
v_cmp_eq_u32 vcc, 1, v1
v_add_u32 v32, s50, v1
v_lshlrev_b32 v32, 4, v32
v_cndmask_b32 v36, v36, v40, vcc
v_cndmask_b32 v37, v37, v41, vcc
v_cndmask_b32 v38, v38, v42, vcc
v_cndmask_b32 v39, v39, v43, vcc
v_add_u32 v32, 27262976, v32
v_cmp_gt_u32 vcc, 2, v1
s_and_saveexec_b64 s[98:99], vcc
buffer_store_dwordx4 v[36:39], v32, s[24:27], 0 offen sc1
s_mov_b64 exec, s[98:99]
s_barrier
s_waitcnt vmcnt(1)
v_lshlrev_b32 v44, 16, v72
v_and_b32 v51, 0xffff0000, v72
v_lshlrev_b32 v45, 16, v76
v_and_b32 v52, 0xffff0000, v76
v_lshlrev_b32 v46, 16, v80
v_and_b32 v53, 0xffff0000, v80
v_lshlrev_b32 v47, 16, v84
v_and_b32 v54, 0xffff0000, v84
v_lshlrev_b32 v48, 16, v88
v_and_b32 v55, 0xffff0000, v88
v_lshlrev_b32 v49, 16, v92
v_and_b32 v56, 0xffff0000, v92
v_lshlrev_b32 v50, 16, v96
v_and_b32 v57, 0xffff0000, v96
v_lshlrev_b32 v8, 16, v116
v_and_b32 v9, 0xffff0000, v116
v_lshlrev_b32 v10, 16, v117
v_and_b32 v11, 0xffff0000, v117
v_lshlrev_b32 v12, 16, v118
v_and_b32 v13, 0xffff0000, v118
v_lshlrev_b32 v14, 16, v119
v_and_b32 v15, 0xffff0000, v119
v_lshlrev_b32 v16, 16, v100
v_and_b32 v20, 0xffff0000, v100
v_lshlrev_b32 v17, 16, v104
v_and_b32 v21, 0xffff0000, v104
v_lshlrev_b32 v18, 16, v108
v_and_b32 v22, 0xffff0000, v108
v_lshlrev_b32 v19, 16, v112
v_and_b32 v23, 0xffff0000, v112
v_mul_f32 v24, v44, v11
v_mul_f32 v25, v45, v11
v_mul_f32 v26, v46, v11
v_mul_f32 v27, v47, v11
v_mul_f32 v28, v51, v15
v_mul_f32 v29, v52, v15
v_mul_f32 v30, v53, v15
v_mul_f32 v31, v54, v15
v_fmac_f32 v24, v45, v10
v_fmac_f32 v25, v46, v10
v_fmac_f32 v26, v47, v10
v_fmac_f32 v27, v48, v10
v_fmac_f32 v28, v52, v14
v_fmac_f32 v29, v53, v14
v_fmac_f32 v30, v54, v14
v_fmac_f32 v31, v55, v14
v_fmac_f32 v24, v46, v9
v_fmac_f32 v25, v47, v9
v_fmac_f32 v26, v48, v9
v_fmac_f32 v27, v49, v9
v_fmac_f32 v28, v53, v13
v_fmac_f32 v29, v54, v13
v_fmac_f32 v30, v55, v13
v_fmac_f32 v31, v56, v13
v_fmac_f32 v24, v47, v8
v_fmac_f32 v25, v48, v8
v_fmac_f32 v26, v49, v8
v_fmac_f32 v27, v50, v8
v_fmac_f32 v28, v54, v12
v_fmac_f32 v29, v55, v12
v_fmac_f32 v30, v56, v12
v_fmac_f32 v31, v57, v12
v_mul_f32 v24, v24, v16
v_mul_f32 v25, v25, v17
v_mul_f32 v26, v26, v18
v_mul_f32 v27, v27, v19
v_mul_f32 v28, v28, v20
v_mul_f32 v29, v29, v21
v_mul_f32 v30, v30, v22
v_mul_f32 v31, v31, v23
s_waitcnt vmcnt(0)
s_barrier
s_cmp_eq_u32 s5, 0
s_cbranch_scc0 L_w0_12
s_lshl_b32 s10, s6, 4
s_add_u32 s10, s10, s7
s_lshl_b32 s10, s10, 2
s_add_u32 s10, s10, 27656192
v_mov_b32 v2, 0
v_mov_b32 v3, s97
buffer_store_dword v3, v2, s[24:27], s10 offen sc1
L_w0_12:
s_add_u32 s61, s55, 0
buffer_load_dwordx4 a[0:3], v144, s[20:23], s61 offen
s_add_u32 s61, s55, 57344
buffer_load_dwordx4 a[4:7], v144, s[20:23], s61 offen
s_add_u32 s61, s55, 114688
buffer_load_dwordx4 a[8:11], v144, s[20:23], s61 offen
s_add_u32 s61, s55, 172032
buffer_load_dwordx4 a[12:15], v144, s[20:23], s61 offen
s_add_u32 s61, s55, 229376
buffer_load_dwordx4 a[16:19], v144, s[20:23], s61 offen
s_add_u32 s61, s55, 286720
buffer_load_dwordx4 a[20:23], v144, s[20:23], s61 offen
s_add_u32 s61, s55, 344064
buffer_load_dwordx4 a[24:27], v144, s[20:23], s61 offen
s_add_u32 s61, s55, 401408
buffer_load_dwordx4 a[28:31], v144, s[20:23], s61 offen
v_cvt_pk_bf16_f32 v60, v27, v26
v_cvt_pk_bf16_f32 v61, v25, v24
v_cvt_pk_bf16_f32 v62, v31, v30
v_cvt_pk_bf16_f32 v63, v29, v28
v_lshlrev_b32 v44, 16, v73
v_and_b32 v51, 0xffff0000, v73
v_lshlrev_b32 v45, 16, v77
v_and_b32 v52, 0xffff0000, v77
v_lshlrev_b32 v46, 16, v81
v_and_b32 v53, 0xffff0000, v81
v_lshlrev_b32 v47, 16, v85
v_and_b32 v54, 0xffff0000, v85
v_lshlrev_b32 v48, 16, v89
v_and_b32 v55, 0xffff0000, v89
v_lshlrev_b32 v49, 16, v93
v_and_b32 v56, 0xffff0000, v93
v_lshlrev_b32 v50, 16, v97
v_and_b32 v57, 0xffff0000, v97
v_lshlrev_b32 v8, 16, v120
v_and_b32 v9, 0xffff0000, v120
v_lshlrev_b32 v10, 16, v121
v_and_b32 v11, 0xffff0000, v121
v_lshlrev_b32 v12, 16, v122
v_and_b32 v13, 0xffff0000, v122
v_lshlrev_b32 v14, 16, v123
v_and_b32 v15, 0xffff0000, v123
v_lshlrev_b32 v16, 16, v101
v_and_b32 v20, 0xffff0000, v101
v_lshlrev_b32 v17, 16, v105
v_and_b32 v21, 0xffff0000, v105
v_lshlrev_b32 v18, 16, v109
v_and_b32 v22, 0xffff0000, v109
v_lshlrev_b32 v19, 16, v113
v_and_b32 v23, 0xffff0000, v113
v_mul_f32 v24, v44, v11
v_mul_f32 v25, v45, v11
v_mul_f32 v26, v46, v11
v_mul_f32 v27, v47, v11
v_mul_f32 v28, v51, v15
v_mul_f32 v29, v52, v15
v_mul_f32 v30, v53, v15
v_mul_f32 v31, v54, v15
v_fmac_f32 v24, v45, v10
v_fmac_f32 v25, v46, v10
v_fmac_f32 v26, v47, v10
v_fmac_f32 v27, v48, v10
v_fmac_f32 v28, v52, v14
v_fmac_f32 v29, v53, v14
v_fmac_f32 v30, v54, v14
v_fmac_f32 v31, v55, v14
s_barrier
v_fmac_f32 v24, v46, v9
v_fmac_f32 v25, v47, v9
v_fmac_f32 v26, v48, v9
v_fmac_f32 v27, v49, v9
v_fmac_f32 v28, v53, v13
v_fmac_f32 v29, v54, v13
v_fmac_f32 v30, v55, v13
v_fmac_f32 v31, v56, v13
v_fmac_f32 v24, v47, v8
v_fmac_f32 v25, v48, v8
v_fmac_f32 v26, v49, v8
v_fmac_f32 v27, v50, v8
v_fmac_f32 v28, v54, v12
v_fmac_f32 v29, v55, v12
v_fmac_f32 v30, v56, v12
v_fmac_f32 v31, v57, v12
v_mul_f32 v24, v24, v16
v_mul_f32 v25, v25, v17
v_mul_f32 v26, v26, v18
v_mul_f32 v27, v27, v19
v_mul_f32 v28, v28, v20
v_mul_f32 v29, v29, v21
v_mul_f32 v30, v30, v22
v_mul_f32 v31, v31, v23
v_cvt_pk_bf16_f32 v64, v27, v26
v_cvt_pk_bf16_f32 v65, v25, v24
v_cvt_pk_bf16_f32 v66, v31, v30
v_cvt_pk_bf16_f32 v67, v29, v28
ds_write_b64 v133, v[60:61] offset:0
ds_write_b64 v133, v[62:63] offset:256
ds_write_b64 v133, v[64:65] offset:512
ds_write_b64 v133, v[66:67] offset:768
s_waitcnt lgkmcnt(0)
s_barrier
ds_read_b128 v[32:35], v134
ds_read_b128 v[36:39], v135
s_add_u32 s61, s60, 0
s_waitcnt lgkmcnt(0)
buffer_store_dwordx4 v[32:35], v136, s[24:27], s61 offen sc1
buffer_store_dwordx4 v[36:39], v137, s[24:27], s61 offen sc1
s_waitcnt vmcnt(2)
v_mfma_f32_16x16x32_bf16 v[152:155], v[148:151], a[0:3], 0
v_mfma_f32_16x16x32_bf16 v[152:155], v[148:151], a[4:7], v[152:155]
v_mfma_f32_16x16x32_bf16 v[152:155], v[148:151], a[8:11], v[152:155]
v_mfma_f32_16x16x32_bf16 v[152:155], v[148:151], a[12:15], v[152:155]
v_mfma_f32_16x16x32_bf16 v[152:155], v[148:151], a[16:19], v[152:155]
v_mfma_f32_16x16x32_bf16 v[152:155], v[148:151], a[20:23], v[152:155]
v_mfma_f32_16x16x32_bf16 v[152:155], v[148:151], a[24:27], v[152:155]
v_mfma_f32_16x16x32_bf16 v[152:155], v[148:151], a[28:31], v[152:155]
s_nop 7
s_nop 0
v_add_f32_dpp v152, v152, v152 row_shr:8 row_mask:0xf bank_mask:0xf bound_ctrl:1
v_add_f32_dpp v153, v153, v153 row_shr:8 row_mask:0xf bank_mask:0xf bound_ctrl:1
v_add_f32_dpp v154, v154, v154 row_shr:8 row_mask:0xf bank_mask:0xf bound_ctrl:1
v_add_f32_dpp v155, v155, v155 row_shr:8 row_mask:0xf bank_mask:0xf bound_ctrl:1
s_lshl_b32 s61, s5, 8
s_add_u32 s61, s61, 159744
v_and_b32 v5, 0xff, v138
v_add_u32 v5, s61, v5
s_mov_b64 s[98:99], exec
s_mov_b64 exec, s[48:49]
ds_write_b128 v5, v[152:155]
s_mov_b64 exec, s[98:99]
s_waitcnt lgkmcnt(0)
s_barrier
v_and_b32 v5, 0xff, v138
v_add_u32 v5, 159744, v5
ds_read_b128 v[8:11], v5 offset:0
ds_read_b128 v[12:15], v5 offset:256
ds_read_b128 v[16:19], v5 offset:512
ds_read_b128 v[20:23], v5 offset:768
s_waitcnt lgkmcnt(0)
v_add_f32 v8, v8, v12
v_add_f32 v9, v9, v13
v_add_f32 v10, v10, v14
v_add_f32 v11, v11, v15
v_add_f32 v16, v16, v20
v_add_f32 v17, v17, v21
v_add_f32 v18, v18, v22
v_add_f32 v19, v19, v23
v_add_f32 v8, v8, v16
v_add_f32 v9, v9, v17
v_add_f32 v10, v10, v18
v_add_f32 v11, v11, v19
s_cmp_eq_u32 s5, 0
s_cselect_b32 s61, 0, 0x20000000
v_add_u32 v5, s61, v138
s_mov_b64 s[98:99], exec
s_mov_b64 exec, s[48:49]
buffer_store_dwordx4 v[8:11], v5, s[24:27], s54 offen sc1
s_mov_b64 exec, s[98:99]
v_lshlrev_b32 v44, 16, v74
v_and_b32 v51, 0xffff0000, v74
v_lshlrev_b32 v45, 16, v78
v_and_b32 v52, 0xffff0000, v78
v_lshlrev_b32 v46, 16, v82
v_and_b32 v53, 0xffff0000, v82
v_lshlrev_b32 v47, 16, v86
v_and_b32 v54, 0xffff0000, v86
v_lshlrev_b32 v48, 16, v90
v_and_b32 v55, 0xffff0000, v90
v_lshlrev_b32 v49, 16, v94
v_and_b32 v56, 0xffff0000, v94
v_lshlrev_b32 v50, 16, v98
v_and_b32 v57, 0xffff0000, v98
v_lshlrev_b32 v8, 16, v124
v_and_b32 v9, 0xffff0000, v124
v_lshlrev_b32 v10, 16, v125
v_and_b32 v11, 0xffff0000, v125
v_lshlrev_b32 v12, 16, v126
v_and_b32 v13, 0xffff0000, v126
v_lshlrev_b32 v14, 16, v127
v_and_b32 v15, 0xffff0000, v127
v_lshlrev_b32 v16, 16, v102
v_and_b32 v20, 0xffff0000, v102
v_lshlrev_b32 v17, 16, v106
v_and_b32 v21, 0xffff0000, v106
v_lshlrev_b32 v18, 16, v110
v_and_b32 v22, 0xffff0000, v110
v_lshlrev_b32 v19, 16, v114
v_and_b32 v23, 0xffff0000, v114
v_mul_f32 v24, v44, v11
v_mul_f32 v25, v45, v11
v_mul_f32 v26, v46, v11
v_mul_f32 v27, v47, v11
v_mul_f32 v28, v51, v15
v_mul_f32 v29, v52, v15
v_mul_f32 v30, v53, v15
v_mul_f32 v31, v54, v15
v_fmac_f32 v24, v45, v10
v_fmac_f32 v25, v46, v10
v_fmac_f32 v26, v47, v10
v_fmac_f32 v27, v48, v10
s_barrier
v_fmac_f32 v28, v52, v14
v_fmac_f32 v29, v53, v14
v_fmac_f32 v30, v54, v14
v_fmac_f32 v31, v55, v14
v_fmac_f32 v24, v46, v9
v_fmac_f32 v25, v47, v9
v_fmac_f32 v26, v48, v9
v_fmac_f32 v27, v49, v9
v_fmac_f32 v28, v53, v13
v_fmac_f32 v29, v54, v13
v_fmac_f32 v30, v55, v13
v_fmac_f32 v31, v56, v13
v_fmac_f32 v24, v47, v8
v_fmac_f32 v25, v48, v8
v_fmac_f32 v26, v49, v8
v_fmac_f32 v27, v50, v8
v_fmac_f32 v28, v54, v12
v_fmac_f32 v29, v55, v12
v_fmac_f32 v30, v56, v12
v_fmac_f32 v31, v57, v12
v_mul_f32 v24, v24, v16
v_mul_f32 v25, v25, v17
v_mul_f32 v26, v26, v18
v_mul_f32 v27, v27, v19
v_mul_f32 v28, v28, v20
v_mul_f32 v29, v29, v21
v_mul_f32 v30, v30, v22
v_mul_f32 v31, v31, v23
v_cvt_pk_bf16_f32 v60, v27, v26
v_cvt_pk_bf16_f32 v61, v25, v24
v_cvt_pk_bf16_f32 v62, v31, v30
v_cvt_pk_bf16_f32 v63, v29, v28
v_lshlrev_b32 v44, 16, v75
v_and_b32 v51, 0xffff0000, v75
v_lshlrev_b32 v45, 16, v79
v_and_b32 v52, 0xffff0000, v79
v_lshlrev_b32 v46, 16, v83
v_and_b32 v53, 0xffff0000, v83
v_lshlrev_b32 v47, 16, v87
v_and_b32 v54, 0xffff0000, v87
v_lshlrev_b32 v48, 16, v91
v_and_b32 v55, 0xffff0000, v91
v_lshlrev_b32 v49, 16, v95
v_and_b32 v56, 0xffff0000, v95
v_lshlrev_b32 v50, 16, v99
v_and_b32 v57, 0xffff0000, v99
v_lshlrev_b32 v8, 16, v128
v_and_b32 v9, 0xffff0000, v128
v_lshlrev_b32 v10, 16, v129
v_and_b32 v11, 0xffff0000, v129
v_lshlrev_b32 v12, 16, v130
v_and_b32 v13, 0xffff0000, v130
v_lshlrev_b32 v14, 16, v131
v_and_b32 v15, 0xffff0000, v131
v_lshlrev_b32 v16, 16, v103
v_and_b32 v20, 0xffff0000, v103
v_lshlrev_b32 v17, 16, v107
v_and_b32 v21, 0xffff0000, v107
v_lshlrev_b32 v18, 16, v111
v_and_b32 v22, 0xffff0000, v111
v_lshlrev_b32 v19, 16, v115
v_and_b32 v23, 0xffff0000, v115
v_mul_f32 v24, v44, v11
v_mul_f32 v25, v45, v11
v_mul_f32 v26, v46, v11
v_mul_f32 v27, v47, v11
v_mul_f32 v28, v51, v15
v_mul_f32 v29, v52, v15
v_mul_f32 v30, v53, v15
v_mul_f32 v31, v54, v15
s_waitcnt vmcnt(0)
s_barrier
s_cmp_eq_u32 s5, 0
s_cbranch_scc0 L_w0_13
s_and_b32 s11, s53, 1
s_mul_i32 s13, s11, 28
s_add_u32 s13, s13, s58
s_lshl_b32 s11, s11, 2
s_add_u32 s11, s11, s58
s_add_u32 s11, s11, 28
s_cmp_lt_u32 s58, 28
s_cselect_b32 s11, s13, s11
s_lshr_b32 s10, s53, 1
s_lshl_b32 s10, s10, 6
s_add_u32 s10, s10, s11
s_lshl_b32 s10, s10, 2
s_add_u32 s10, s10, 27658240
v_mov_b32 v2, 0
v_mov_b32 v3, s97
buffer_store_dword v3, v2, s[24:27], s10 offen sc1
L_w0_13:
v_fmac_f32 v24, v45, v10
v_fmac_f32 v25, v46, v10
v_fmac_f32 v26, v47, v10
v_fmac_f32 v27, v48, v10
v_fmac_f32 v28, v52, v14
v_fmac_f32 v29, v53, v14
v_fmac_f32 v30, v54, v14
v_fmac_f32 v31, v55, v14
v_fmac_f32 v24, v46, v9
v_fmac_f32 v25, v47, v9
v_fmac_f32 v26, v48, v9
v_fmac_f32 v27, v49, v9
v_fmac_f32 v28, v53, v13
v_fmac_f32 v29, v54, v13
v_fmac_f32 v30, v55, v13
v_fmac_f32 v31, v56, v13
v_fmac_f32 v24, v47, v8
v_fmac_f32 v25, v48, v8
v_fmac_f32 v26, v49, v8
v_fmac_f32 v27, v50, v8
v_fmac_f32 v28, v54, v12
v_fmac_f32 v29, v55, v12
v_fmac_f32 v30, v56, v12
v_fmac_f32 v31, v57, v12
v_mul_f32 v24, v24, v16
v_mul_f32 v25, v25, v17
v_mul_f32 v26, v26, v18
v_mul_f32 v27, v27, v19
v_mul_f32 v28, v28, v20
v_mul_f32 v29, v29, v21
v_mul_f32 v30, v30, v22
v_mul_f32 v31, v31, v23
v_cvt_pk_bf16_f32 v64, v27, v26
v_cvt_pk_bf16_f32 v65, v25, v24
v_cvt_pk_bf16_f32 v66, v31, v30
v_cvt_pk_bf16_f32 v67, v29, v28
ds_write_b64 v133, v[60:61] offset:0
ds_write_b64 v133, v[62:63] offset:256
ds_write_b64 v133, v[64:65] offset:512
ds_write_b64 v133, v[66:67] offset:768
s_waitcnt lgkmcnt(0)
s_barrier
ds_read_b128 v[32:35], v134
ds_read_b128 v[36:39], v135
s_add_u32 s61, s60, 16896
s_waitcnt lgkmcnt(0)
buffer_store_dwordx4 v[32:35], v136, s[24:27], s61 offen sc1
buffer_store_dwordx4 v[36:39], v137, s[24:27], s61 offen sc1
s_mov_b32 s40, s72
s_and_b32 s41, s73, 0xffff
s_mov_b32 s42, 4194304
s_mov_b32 s43, 0x20000
v_cmp_gt_u32 vcc, 128, v143
v_mov_b32 v6, 0x7fffffff
s_mul_i32 s62, s2, 16384
v_cndmask_b32 v5, v6, v142, vcc
s_add_u32 s62, s62, 0
buffer_load_dword v139, v5, s[40:43], s62 offen
s_barrier
s_mov_b32 s40, s82
s_and_b32 s41, s83, 0xffff
s_mov_b32 s42, 7340032
s_mov_b32 s43, 0x20000
v_cmp_gt_u32 vcc, 56, v143
v_mov_b32 v6, 0x7fffffff
s_mul_i32 s62, s2, 28672
v_cndmask_b32 v5, v6, v142, vcc
s_add_u32 s62, s62, 0
buffer_load_dword v139, v5, s[40:43], s62 offen
s_waitcnt vmcnt(2)
s_lshl_b32 s10, s52, 4
s_add_u32 s10, s10, s51
s_lshl_b32 s10, s10, 2
s_add_u32 s10, s10, s5
s_lshl_b32 s10, s10, 2
s_add_u32 s10, s10, 27672576
v_mov_b32 v2, 0
v_mov_b32 v3, s97
buffer_store_dword v3, v2, s[24:27], s10 offen sc1
s_barrier
s_mov_b32 s40, s82
s_and_b32 s41, s83, 0xffff
s_mov_b32 s42, 7340032
s_mov_b32 s43, 0x20000
v_cmp_gt_u32 vcc, 56, v143
v_mov_b32 v6, 0x7fffffff
s_mul_i32 s62, s2, 28672
v_cndmask_b32 v5, v6, v142, vcc
s_add_u32 s62, s62, 7168
buffer_load_dword v139, v5, s[40:43], s62 offen
s_cmp_eq_u32 s5, 3
s_cbranch_scc0 L_ipf_14
s_getpc_b64 s[10:11]
L_here_15:
s_sub_u32 s10, s10, L_here_15-parallel_sum__ssm_conv_h3__mixer_channel_mlp__prompt_kernel
s_subb_u32 s11, s11, 0
s_lshr_b32 s3, s2, 3
s_lshl_b32 s3, s3, 4
v_and_b32 v58, 15, v1
v_add_u32 v58, s3, v58
v_lshlrev_b32 v58, 7, v58
v_min_u32 v58, L_end_parallel_sum__ssm_conv_h3__mixer_channel_mlp__prompt_kernel-parallel_sum__ssm_conv_h3__mixer_channel_mlp__prompt_kernel, v58
v_mov_b32 v59, s11
v_add_co_u32 v58, vcc, s10, v58
s_nop 1
v_addc_co_u32 v59, vcc, 0, v59, vcc
s_mov_b64 s[98:99], exec
s_mov_b64 exec, 0xffff
global_load_dword v139, v[58:59], off
s_mov_b64 exec, s[98:99]
L_ipf_14:
v_and_b32 v41, 15, v1
v_lshlrev_b32 v41, 2, v41
s_lshl_b32 s12, s6, 6
s_add_u32 s12, s12, 27656192
buffer_load_dword v40, v41, s[24:27], s12 offen sc1
v_lshlrev_b32 v43, 2, v1
s_lshr_b32 s13, s7, 2
s_lshl_b32 s13, s13, 8
s_add_u32 s13, s13, 27658240
buffer_load_dword v42, v43, s[24:27], s13 offen sc1
s_barrier
s_mov_b32 s40, s82
s_and_b32 s41, s83, 0xffff
s_mov_b32 s42, 7340032
s_mov_b32 s43, 0x20000
v_cmp_gt_u32 vcc, 56, v143
v_mov_b32 v6, 0x7fffffff
s_mul_i32 s62, s2, 28672
v_cndmask_b32 v5, v6, v142, vcc
s_add_u32 s62, s62, 14336
buffer_load_dword v139, v5, s[40:43], s62 offen
s_waitcnt vmcnt(1)
v_cmp_ne_u32 vcc, s97, v40
s_nop 0
s_cbranch_vccz L_ok_16
s_mov_b32 s14, 0x200000
L_poll_17:
buffer_load_dword v40, v41, s[24:27], s12 offen sc1
s_waitcnt vmcnt(0)
v_cmp_ne_u32 vcc, s97, v40
s_sub_u32 s14, s14, 1
s_cmp_eq_u32 s14, 0
s_cbranch_scc1 L_pollx_18
s_cbranch_vccz L_pollx_18
s_sleep 8
s_branch L_poll_17
L_pollx_18:
L_ok_16:
v_cmp_ne_u32 vcc, s97, v42
s_nop 0
s_cbranch_vccz L_ok_19
s_mov_b32 s14, 0x200000
L_poll_20:
buffer_load_dword v42, v43, s[24:27], s13 offen sc1
s_waitcnt vmcnt(0)
v_cmp_ne_u32 vcc, s97, v42
s_sub_u32 s14, s14, 1
s_cmp_eq_u32 s14, 0
s_cbranch_scc1 L_pollx_21
s_cbranch_vccz L_pollx_21
s_sleep 8
s_branch L_poll_20
L_pollx_21:
L_ok_19:
s_lshl_b32 s10, s5, 6
v_add_u32 v72, s10, v1
s_mul_i32 s11, s7, 224
v_add_u32 v73, s11, v72
v_lshlrev_b32 v74, 2, v73
v_add_u32 v74, 27328512, v74
s_mov_b32 s10, 0
buffer_load_dword v76, v74, s[24:27], s10 offen sc1
s_mov_b32 s10, 14336
buffer_load_dword v77, v74, s[24:27], s10 offen sc1
s_mov_b32 s10, 28672
buffer_load_dword v78, v74, s[24:27], s10 offen sc1
s_mov_b32 s10, 43008
buffer_load_dword v79, v74, s[24:27], s10 offen sc1
v_lshlrev_b32 v75, 1, v73
s_mov_b32 s40, s80
s_and_b32 s41, s81, 0xffff
s_mov_b32 s42, 7168
s_mov_b32 s43, 0x20000
buffer_load_ushort v92, v75, s[40:43], 0 offen
v_lshlrev_b32 v10, 2, v1
s_lshr_b32 s15, s2, 4
s_lshl_b32 s15, s15, 8
s_add_u32 s15, s15, 27672576
buffer_load_dword v12, v10, s[24:27], s15 offen sc1
s_barrier
s_mov_b32 s40, s82
s_and_b32 s41, s83, 0xffff
s_mov_b32 s42, 7340032
s_mov_b32 s43, 0x20000
v_cmp_gt_u32 vcc, 56, v143
v_mov_b32 v6, 0x7fffffff
s_mul_i32 s62, s2, 28672
v_cndmask_b32 v5, v6, v142, vcc
s_add_u32 s62, s62, 21504
buffer_load_dword v139, v5, s[40:43], s62 offen
s_waitcnt vmcnt(1)
v_add_f32 v76, v76, v77
v_add_f32 v78, v78, v79
v_add_f32 v76, v76, v78
v_lshlrev_b32 v92, 16, v92
v_lshlrev_b32 v72, 2, v72
v_add_u32 v72, 75264, v72
v_cmp_gt_u32 vcc, 0x12980, v72
s_and_saveexec_b64 s[98:99], vcc
s_cbranch_execz L_x_22
ds_write_b32 v72, v76
ds_write_b32 v72, v92 offset:896
L_x_22:
s_mov_b64 exec, s[98:99]
s_waitcnt lgkmcnt(0)
v_cmp_ne_u32 vcc, s97, v12
s_nop 0
s_cbranch_vccz L_ok_23
s_mov_b32 s14, 0x200000
L_poll_24:
buffer_load_dword v12, v10, s[24:27], s15 offen sc1
s_waitcnt vmcnt(0)
v_cmp_ne_u32 vcc, s97, v12
s_sub_u32 s14, s14, 1
s_cmp_eq_u32 s14, 0
s_cbranch_scc1 L_pollx_25
s_cbranch_vccz L_pollx_25
s_sleep 8
s_branch L_poll_24
L_pollx_25:
L_ok_23:
s_lshl_b32 s56, s2, 2
s_add_u32 s56, s56, s5
s_mul_i32 s57, s5, 21248
s_add_u32 s57, s57, 32768
s_cmp_ge_u32 s5, 2
s_cselect_b32 s10, 10752, 0
s_add_u32 s57, s57, s10
s_mov_b32 s28, s72
s_and_b32 s29, s73, 0xffff
s_mov_b32 s30, 4194304
s_mov_b32 s31, 0x20000
s_mov_b32 s32, s74
s_and_b32 s33, s75, 0xffff
s_mov_b32 s34, 2048
s_mov_b32 s35, 0x20000
v_lshlrev_b32 v2, 4, v1
v_mov_b32 v4, 0
v_mov_b32 v5, 0
v_lshlrev_b32 v3, 3, v1
v_add_u32 v3, s57, v3
ds_write_b64 v3, v[4:5] offset:16640
v_lshrrev_b32 v6, 3, v1
v_and_b32 v6, 3, v6
v_mul_u32_u24 v6, 4160, v6
v_and_b32 v7, 7, v1
v_lshlrev_b32 v7, 3, v7
v_add_u32 v6, v6, v7
v_add_u32 v6, s57, v6
ds_write_b64 v6, v[4:5] offset:4096
s_add_u32 m0, s57, 17152
s_lshl_b32 s10, s56, 12
buffer_load_dwordx4 v2, s[28:31], s10 offen offset:0 lds
buffer_load_dwordx4 v2, s[28:31], s10 offen offset:1024 lds
buffer_load_dwordx4 v2, s[28:31], s10 offen offset:2048 lds
buffer_load_dwordx4 v2, s[28:31], s10 offen offset:3072 lds
s_mul_i32 s58, s56, 4224
s_add_u32 s58, s58, 16777216
s_add_u32 m0, s57, 0
s_add_u32 s10, s58, 0
buffer_load_dwordx4 v2, s[24:27], s10 offen offset:0 sc1 lds
buffer_load_dwordx4 v2, s[24:27], s10 offen offset:1024 sc1 lds
buffer_load_dwordx4 v2, s[24:27], s10 offen offset:2048 sc1 lds
buffer_load_dwordx4 v2, s[24:27], s10 offen offset:3072 sc1 lds
s_lshl_b32 s10, s56, 1
v_mov_b32 v12, s10
buffer_load_ushort v13, v12, s[32:35], 0 offen
s_barrier
s_waitcnt vmcnt(0)
s_waitcnt lgkmcnt(0)
v_lshlrev_b32 v2, 4, v1
v_add_u32 v2, s57, v2
ds_read_b128 v[16:19], v2 offset:0
ds_read_b64 v[20:21], v2 offset:16
ds_read_b128 v[24:27], v2 offset:1024
ds_read_b64 v[28:29], v2 offset:1040
ds_read_b128 v[32:35], v2 offset:2048
ds_read_b64 v[36:37], v2 offset:2064
ds_read_b128 v[40:43], v2 offset:3072
ds_read_b64 v[44:45], v2 offset:3088
s_waitcnt lgkmcnt(0)
v_alignbyte_b32 v48, v17, v16, 2
v_alignbyte_b32 v49, v18, v17, 2
v_alignbyte_b32 v50, v19, v18, 2
v_alignbyte_b32 v51, v20, v19, 2
v_alignbyte_b32 v52, v18, v17, 2
v_alignbyte_b32 v53, v19, v18, 2
v_alignbyte_b32 v54, v20, v19, 2
v_alignbyte_b32 v55, v21, v20, 2
v_mov_b32 v56, v17
v_mov_b32 v57, v18
v_mov_b32 v58, v19
v_mov_b32 v59, v20
ds_write_b128 v2, v[48:51] offset:4160
ds_write_b128 v2, v[52:55] offset:12480
ds_write_b128 v2, v[56:59] offset:8320
v_alignbyte_b32 v60, v25, v24, 2
v_alignbyte_b32 v61, v26, v25, 2
v_alignbyte_b32 v62, v27, v26, 2
v_alignbyte_b32 v63, v28, v27, 2
v_alignbyte_b32 v64, v26, v25, 2
v_alignbyte_b32 v65, v27, v26, 2
v_alignbyte_b32 v66, v28, v27, 2
v_alignbyte_b32 v67, v29, v28, 2
v_mov_b32 v68, v25
v_mov_b32 v69, v26
v_mov_b32 v70, v27
v_mov_b32 v71, v28
ds_write_b128 v2, v[60:63] offset:5184
ds_write_b128 v2, v[64:67] offset:13504
ds_write_b128 v2, v[68:71] offset:9344
v_alignbyte_b32 v48, v33, v32, 2
v_alignbyte_b32 v49, v34, v33, 2
v_alignbyte_b32 v50, v35, v34, 2
v_alignbyte_b32 v51, v36, v35, 2
v_alignbyte_b32 v52, v34, v33, 2
v_alignbyte_b32 v53, v35, v34, 2
v_alignbyte_b32 v54, v36, v35, 2
v_alignbyte_b32 v55, v37, v36, 2
v_mov_b32 v56, v33
v_mov_b32 v57, v34
v_mov_b32 v58, v35
v_mov_b32 v59, v36
ds_write_b128 v2, v[48:51] offset:6208
ds_write_b128 v2, v[52:55] offset:14528
ds_write_b128 v2, v[56:59] offset:10368
v_alignbyte_b32 v60, v41, v40, 2
v_alignbyte_b32 v61, v42, v41, 2
v_alignbyte_b32 v62, v43, v42, 2
v_alignbyte_b32 v63, v44, v43, 2
v_alignbyte_b32 v64, v42, v41, 2
v_alignbyte_b32 v65, v43, v42, 2
v_alignbyte_b32 v66, v44, v43, 2
v_alignbyte_b32 v67, v45, v44, 2
v_mov_b32 v68, v41
v_mov_b32 v69, v42
v_mov_b32 v70, v43
v_mov_b32 v71, v44
ds_write_b128 v2, v[60:63] offset:7232
ds_write_b128 v2, v[64:67] offset:15552
ds_write_b128 v2, v[68:71] offset:11392
s_barrier
s_barrier
v_and_b32 v8, 15, v1
v_lshrrev_b32 v9, 4, v1
v_sub_u32 v10, 3, v8
v_and_b32 v10, 3, v10
v_mul_u32_u24 v10, 4160, v10
v_sub_u32 v11, 2047, v8
v_and_b32 v11, 0xfffffffc, v11
v_lshlrev_b32 v12, 3, v9
v_add_u32 v11, v11, v12
v_subrev_u32 v11, 2032, v11
v_lshlrev_b32 v11, 1, v11
v_add_u32 v10, v10, v11
v_add_u32 v10, s57, v10
v_lshlrev_b32 v11, 4, v8
v_lshlrev_b32 v12, 3, v9
v_add_u32 v11, v11, v12
v_lshlrev_b32 v11, 1, v11
v_add_u32 v11, 16672, v11
v_add_u32 v11, s57, v11
s_waitcnt lgkmcnt(0)
ds_read_b64 a[0:1], v10 offset:4032
ds_read_b64 a[2:3], v10 offset:4040
ds_read_b128 a[64:67], v11 offset:448
ds_read_b64 a[4:5], v10 offset:3520
ds_read_b64 a[6:7], v10 offset:3528
ds_read_b128 a[68:71], v11 offset:960
ds_read_b64 a[8:9], v10 offset:3008
ds_read_b64 a[10:11], v10 offset:3016
ds_read_b128 a[72:75], v11 offset:1472
ds_read_b64 a[12:13], v10 offset:2496
ds_read_b64 a[14:15], v10 offset:2504
ds_read_b128 a[76:79], v11 offset:1984
ds_read_b64 a[16:17], v10 offset:1984
ds_read_b64 a[18:19], v10 offset:1992
ds_read_b128 a[80:83], v11 offset:2496
ds_read_b64 a[20:21], v10 offset:1472
ds_read_b64 a[22:23], v10 offset:1480
ds_read_b128 a[84:87], v11 offset:3008
ds_read_b64 a[24:25], v10 offset:960
ds_read_b64 a[26:27], v10 offset:968
ds_read_b128 a[88:91], v11 offset:3520
ds_read_b64 a[28:29], v10 offset:448
ds_read_b64 a[30:31], v10 offset:456
ds_read_b128 a[92:95], v11 offset:4032
s_waitcnt lgkmcnt(0)
v_mfma_f32_16x16x32_bf16 v[16:19], a[0:3], a[64:67], 0
ds_read_b64 a[32:33], v10 offset:3968
v_mfma_f32_16x16x32_bf16 v[20:23], a[0:3], a[68:71], 0
ds_read_b64 a[34:35], v10 offset:3976
v_mfma_f32_16x16x32_bf16 v[24:27], a[0:3], a[72:75], 0
ds_read_b128 v[64:67], v11 offset:384
v_mfma_f32_16x16x32_bf16 v[28:31], a[0:3], a[76:79], 0
ds_read_b64 a[36:37], v10 offset:3456
v_mfma_f32_16x16x32_bf16 v[32:35], a[0:3], a[80:83], 0
ds_read_b64 a[38:39], v10 offset:3464
v_mfma_f32_16x16x32_bf16 v[36:39], a[0:3], a[84:87], 0
ds_read_b128 v[68:71], v11 offset:896
v_mfma_f32_16x16x32_bf16 v[40:43], a[0:3], a[88:91], 0
ds_read_b64 a[40:41], v10 offset:2944
v_mfma_f32_16x16x32_bf16 v[44:47], a[0:3], a[92:95], 0
ds_read_b64 a[42:43], v10 offset:2952
v_mfma_f32_16x16x32_bf16 v[20:23], a[4:7], a[64:67], v[20:23]
ds_read_b128 v[72:75], v11 offset:1408
v_mfma_f32_16x16x32_bf16 v[24:27], a[4:7], a[68:71], v[24:27]
ds_read_b64 a[44:45], v10 offset:2432
v_mfma_f32_16x16x32_bf16 v[28:31], a[4:7], a[72:75], v[28:31]
ds_read_b64 a[46:47], v10 offset:2440
v_mfma_f32_16x16x32_bf16 v[32:35], a[4:7], a[76:79], v[32:35]
ds_read_b128 v[76:79], v11 offset:1920
v_mfma_f32_16x16x32_bf16 v[36:39], a[4:7], a[80:83], v[36:39]
ds_read_b64 a[48:49], v10 offset:1920
v_mfma_f32_16x16x32_bf16 v[40:43], a[4:7], a[84:87], v[40:43]
ds_read_b64 a[50:51], v10 offset:1928
v_mfma_f32_16x16x32_bf16 v[44:47], a[4:7], a[88:91], v[44:47]
ds_read_b128 v[80:83], v11 offset:2432
v_mfma_f32_16x16x32_bf16 v[24:27], a[8:11], a[64:67], v[24:27]
ds_read_b64 a[52:53], v10 offset:1408
v_mfma_f32_16x16x32_bf16 v[28:31], a[8:11], a[68:71], v[28:31]
ds_read_b64 a[54:55], v10 offset:1416
v_mfma_f32_16x16x32_bf16 v[32:35], a[8:11], a[72:75], v[32:35]
ds_read_b128 v[84:87], v11 offset:2944
v_mfma_f32_16x16x32_bf16 v[36:39], a[8:11], a[76:79], v[36:39]
ds_read_b64 a[56:57], v10 offset:896
v_mfma_f32_16x16x32_bf16 v[40:43], a[8:11], a[80:83], v[40:43]
ds_read_b64 a[58:59], v10 offset:904
v_mfma_f32_16x16x32_bf16 v[44:47], a[8:11], a[84:87], v[44:47]
ds_read_b128 v[88:91], v11 offset:3456
v_mfma_f32_16x16x32_bf16 v[28:31], a[12:15], a[64:67], v[28:31]
ds_read_b64 a[60:61], v10 offset:384
v_mfma_f32_16x16x32_bf16 v[32:35], a[12:15], a[68:71], v[32:35]
ds_read_b64 a[62:63], v10 offset:392
v_mfma_f32_16x16x32_bf16 v[36:39], a[12:15], a[72:75], v[36:39]
ds_read_b128 v[92:95], v11 offset:3968
v_mfma_f32_16x16x32_bf16 v[40:43], a[12:15], a[76:79], v[40:43]
v_mfma_f32_16x16x32_bf16 v[44:47], a[12:15], a[80:83], v[44:47]
v_mfma_f32_16x16x32_bf16 v[32:35], a[16:19], a[64:67], v[32:35]
v_mfma_f32_16x16x32_bf16 v[36:39], a[16:19], a[68:71], v[36:39]
v_mfma_f32_16x16x32_bf16 v[40:43], a[16:19], a[72:75], v[40:43]
v_mfma_f32_16x16x32_bf16 v[44:47], a[16:19], a[76:79], v[44:47]
v_mfma_f32_16x16x32_bf16 v[36:39], a[20:23], a[64:67], v[36:39]
v_mfma_f32_16x16x32_bf16 v[40:43], a[20:23], a[68:71], v[40:43]
v_mfma_f32_16x16x32_bf16 v[44:47], a[20:23], a[72:75], v[44:47]
v_mfma_f32_16x16x32_bf16 v[40:43], a[24:27], a[64:67], v[40:43]
v_mfma_f32_16x16x32_bf16 v[44:47], a[24:27], a[68:71], v[44:47]
v_mfma_f32_16x16x32_bf16 v[44:47], a[28:31], a[64:67], v[44:47]
s_waitcnt lgkmcnt(0)
v_mfma_f32_16x16x32_bf16 v[16:19], a[32:35], v[64:67], v[16:19]
ds_read_b64 a[0:1], v10 offset:3904
v_mfma_f32_16x16x32_bf16 v[20:23], a[32:35], v[68:71], v[20:23]
ds_read_b64 a[2:3], v10 offset:3912
v_mfma_f32_16x16x32_bf16 v[24:27], a[32:35], v[72:75], v[24:27]
ds_read_b128 a[64:67], v11 offset:320
v_mfma_f32_16x16x32_bf16 v[28:31], a[32:35], v[76:79], v[28:31]
ds_read_b64 a[4:5], v10 offset:3392
v_mfma_f32_16x16x32_bf16 v[32:35], a[32:35], v[80:83], v[32:35]
ds_read_b64 a[6:7], v10 offset:3400
v_mfma_f32_16x16x32_bf16 v[36:39], a[32:35], v[84:87], v[36:39]
ds_read_b128 a[68:71], v11 offset:832
v_mfma_f32_16x16x32_bf16 v[40:43], a[32:35], v[88:91], v[40:43]
ds_read_b64 a[8:9], v10 offset:2880
v_mfma_f32_16x16x32_bf16 v[44:47], a[32:35], v[92:95], v[44:47]
ds_read_b64 a[10:11], v10 offset:2888
v_mfma_f32_16x16x32_bf16 v[20:23], a[36:39], v[64:67], v[20:23]
ds_read_b128 a[72:75], v11 offset:1344
v_mfma_f32_16x16x32_bf16 v[24:27], a[36:39], v[68:71], v[24:27]
ds_read_b64 a[12:13], v10 offset:2368
v_mfma_f32_16x16x32_bf16 v[28:31], a[36:39], v[72:75], v[28:31]
ds_read_b64 a[14:15], v10 offset:2376
v_mfma_f32_16x16x32_bf16 v[32:35], a[36:39], v[76:79], v[32:35]
ds_read_b128 a[76:79], v11 offset:1856
v_mfma_f32_16x16x32_bf16 v[36:39], a[36:39], v[80:83], v[36:39]
ds_read_b64 a[16:17], v10 offset:1856
v_mfma_f32_16x16x32_bf16 v[40:43], a[36:39], v[84:87], v[40:43]
ds_read_b64 a[18:19], v10 offset:1864
v_mfma_f32_16x16x32_bf16 v[44:47], a[36:39], v[88:91], v[44:47]
ds_read_b128 a[80:83], v11 offset:2368
v_mfma_f32_16x16x32_bf16 v[24:27], a[40:43], v[64:67], v[24:27]
ds_read_b64 a[20:21], v10 offset:1344
v_mfma_f32_16x16x32_bf16 v[28:31], a[40:43], v[68:71], v[28:31]
ds_read_b64 a[22:23], v10 offset:1352
v_mfma_f32_16x16x32_bf16 v[32:35], a[40:43], v[72:75], v[32:35]
ds_read_b128 a[84:87], v11 offset:2880
v_mfma_f32_16x16x32_bf16 v[36:39], a[40:43], v[76:79], v[36:39]
ds_read_b64 a[24:25], v10 offset:832
v_mfma_f32_16x16x32_bf16 v[40:43], a[40:43], v[80:83], v[40:43]
ds_read_b64 a[26:27], v10 offset:840
v_mfma_f32_16x16x32_bf16 v[44:47], a[40:43], v[84:87], v[44:47]
ds_read_b128 a[88:91], v11 offset:3392
v_mfma_f32_16x16x32_bf16 v[28:31], a[44:47], v[64:67], v[28:31]
ds_read_b64 a[28:29], v10 offset:320
v_mfma_f32_16x16x32_bf16 v[32:35], a[44:47], v[68:71], v[32:35]
ds_read_b64 a[30:31], v10 offset:328
v_mfma_f32_16x16x32_bf16 v[36:39], a[44:47], v[72:75], v[36:39]
ds_read_b128 a[92:95], v11 offset:3904
v_mfma_f32_16x16x32_bf16 v[40:43], a[44:47], v[76:79], v[40:43]
v_mfma_f32_16x16x32_bf16 v[44:47], a[44:47], v[80:83], v[44:47]
v_mfma_f32_16x16x32_bf16 v[32:35], a[48:51], v[64:67], v[32:35]
v_mfma_f32_16x16x32_bf16 v[36:39], a[48:51], v[68:71], v[36:39]
v_mfma_f32_16x16x32_bf16 v[40:43], a[48:51], v[72:75], v[40:43]
v_mfma_f32_16x16x32_bf16 v[44:47], a[48:51], v[76:79], v[44:47]
v_mfma_f32_16x16x32_bf16 v[36:39], a[52:55], v[64:67], v[36:39]
v_mfma_f32_16x16x32_bf16 v[40:43], a[52:55], v[68:71], v[40:43]
v_mfma_f32_16x16x32_bf16 v[44:47], a[52:55], v[72:75], v[44:47]
v_mfma_f32_16x16x32_bf16 v[40:43], a[56:59], v[64:67], v[40:43]
v_mfma_f32_16x16x32_bf16 v[44:47], a[56:59], v[68:71], v[44:47]
v_mfma_f32_16x16x32_bf16 v[44:47], a[60:63], v[64:67], v[44:47]
s_waitcnt lgkmcnt(0)
v_mfma_f32_16x16x32_bf16 v[16:19], a[0:3], a[64:67], v[16:19]
ds_read_b64 a[32:33], v10 offset:3840
v_mfma_f32_16x16x32_bf16 v[20:23], a[0:3], a[68:71], v[20:23]
ds_read_b64 a[34:35], v10 offset:3848
v_mfma_f32_16x16x32_bf16 v[24:27], a[0:3], a[72:75], v[24:27]
ds_read_b128 v[64:67], v11 offset:256
v_mfma_f32_16x16x32_bf16 v[28:31], a[0:3], a[76:79], v[28:31]
ds_read_b64 a[36:37], v10 offset:3328
v_mfma_f32_16x16x32_bf16 v[32:35], a[0:3], a[80:83], v[32:35]
ds_read_b64 a[38:39], v10 offset:3336
v_mfma_f32_16x16x32_bf16 v[36:39], a[0:3], a[84:87], v[36:39]
ds_read_b128 v[68:71], v11 offset:768
v_mfma_f32_16x16x32_bf16 v[40:43], a[0:3], a[88:91], v[40:43]
ds_read_b64 a[40:41], v10 offset:2816
v_mfma_f32_16x16x32_bf16 v[44:47], a[0:3], a[92:95], v[44:47]
ds_read_b64 a[42:43], v10 offset:2824
v_mfma_f32_16x16x32_bf16 v[20:23], a[4:7], a[64:67], v[20:23]
ds_read_b128 v[72:75], v11 offset:1280
v_mfma_f32_16x16x32_bf16 v[24:27], a[4:7], a[68:71], v[24:27]
ds_read_b64 a[44:45], v10 offset:2304
v_mfma_f32_16x16x32_bf16 v[28:31], a[4:7], a[72:75], v[28:31]
ds_read_b64 a[46:47], v10 offset:2312
v_mfma_f32_16x16x32_bf16 v[32:35], a[4:7], a[76:79], v[32:35]
ds_read_b128 v[76:79], v11 offset:1792
v_mfma_f32_16x16x32_bf16 v[36:39], a[4:7], a[80:83], v[36:39]
ds_read_b64 a[48:49], v10 offset:1792
v_mfma_f32_16x16x32_bf16 v[40:43], a[4:7], a[84:87], v[40:43]
ds_read_b64 a[50:51], v10 offset:1800
v_mfma_f32_16x16x32_bf16 v[44:47], a[4:7], a[88:91], v[44:47]
ds_read_b128 v[80:83], v11 offset:2304
v_mfma_f32_16x16x32_bf16 v[24:27], a[8:11], a[64:67], v[24:27]
ds_read_b64 a[52:53], v10 offset:1280
v_mfma_f32_16x16x32_bf16 v[28:31], a[8:11], a[68:71], v[28:31]
ds_read_b64 a[54:55], v10 offset:1288
v_mfma_f32_16x16x32_bf16 v[32:35], a[8:11], a[72:75], v[32:35]
ds_read_b128 v[84:87], v11 offset:2816
v_mfma_f32_16x16x32_bf16 v[36:39], a[8:11], a[76:79], v[36:39]
ds_read_b64 a[56:57], v10 offset:768
v_mfma_f32_16x16x32_bf16 v[40:43], a[8:11], a[80:83], v[40:43]
ds_read_b64 a[58:59], v10 offset:776
v_mfma_f32_16x16x32_bf16 v[44:47], a[8:11], a[84:87], v[44:47]
ds_read_b128 v[88:91], v11 offset:3328
v_mfma_f32_16x16x32_bf16 v[28:31], a[12:15], a[64:67], v[28:31]
ds_read_b64 a[60:61], v10 offset:256
v_mfma_f32_16x16x32_bf16 v[32:35], a[12:15], a[68:71], v[32:35]
ds_read_b64 a[62:63], v10 offset:264
v_mfma_f32_16x16x32_bf16 v[36:39], a[12:15], a[72:75], v[36:39]
ds_read_b128 v[92:95], v11 offset:3840
v_mfma_f32_16x16x32_bf16 v[40:43], a[12:15], a[76:79], v[40:43]
v_mfma_f32_16x16x32_bf16 v[44:47], a[12:15], a[80:83], v[44:47]
v_mfma_f32_16x16x32_bf16 v[32:35], a[16:19], a[64:67], v[32:35]
v_mfma_f32_16x16x32_bf16 v[36:39], a[16:19], a[68:71], v[36:39]
v_mfma_f32_16x16x32_bf16 v[40:43], a[16:19], a[72:75], v[40:43]
v_mfma_f32_16x16x32_bf16 v[44:47], a[16:19], a[76:79], v[44:47]
v_mfma_f32_16x16x32_bf16 v[36:39], a[20:23], a[64:67], v[36:39]
v_mfma_f32_16x16x32_bf16 v[40:43], a[20:23], a[68:71], v[40:43]
v_mfma_f32_16x16x32_bf16 v[44:47], a[20:23], a[72:75], v[44:47]
v_mfma_f32_16x16x32_bf16 v[40:43], a[24:27], a[64:67], v[40:43]
v_mfma_f32_16x16x32_bf16 v[44:47], a[24:27], a[68:71], v[44:47]
v_mfma_f32_16x16x32_bf16 v[44:47], a[28:31], a[64:67], v[44:47]
s_waitcnt lgkmcnt(0)
v_mfma_f32_16x16x32_bf16 v[16:19], a[32:35], v[64:67], v[16:19]
ds_read_b64 a[0:1], v10 offset:3776
v_mfma_f32_16x16x32_bf16 v[20:23], a[32:35], v[68:71], v[20:23]
ds_read_b64 a[2:3], v10 offset:3784
v_mfma_f32_16x16x32_bf16 v[24:27], a[32:35], v[72:75], v[24:27]
ds_read_b128 a[64:67], v11 offset:192
v_mfma_f32_16x16x32_bf16 v[28:31], a[32:35], v[76:79], v[28:31]
ds_read_b64 a[4:5], v10 offset:3264
v_mfma_f32_16x16x32_bf16 v[32:35], a[32:35], v[80:83], v[32:35]
ds_read_b64 a[6:7], v10 offset:3272
v_mfma_f32_16x16x32_bf16 v[36:39], a[32:35], v[84:87], v[36:39]
ds_read_b128 a[68:71], v11 offset:704
v_mfma_f32_16x16x32_bf16 v[40:43], a[32:35], v[88:91], v[40:43]
ds_read_b64 a[8:9], v10 offset:2752
v_mfma_f32_16x16x32_bf16 v[44:47], a[32:35], v[92:95], v[44:47]
ds_read_b64 a[10:11], v10 offset:2760
v_mfma_f32_16x16x32_bf16 v[20:23], a[36:39], v[64:67], v[20:23]
ds_read_b128 a[72:75], v11 offset:1216
v_mfma_f32_16x16x32_bf16 v[24:27], a[36:39], v[68:71], v[24:27]
ds_read_b64 a[12:13], v10 offset:2240
v_mfma_f32_16x16x32_bf16 v[28:31], a[36:39], v[72:75], v[28:31]
ds_read_b64 a[14:15], v10 offset:2248
v_mfma_f32_16x16x32_bf16 v[32:35], a[36:39], v[76:79], v[32:35]
ds_read_b128 a[76:79], v11 offset:1728
v_mfma_f32_16x16x32_bf16 v[36:39], a[36:39], v[80:83], v[36:39]
ds_read_b64 a[16:17], v10 offset:1728
v_mfma_f32_16x16x32_bf16 v[40:43], a[36:39], v[84:87], v[40:43]
ds_read_b64 a[18:19], v10 offset:1736
v_mfma_f32_16x16x32_bf16 v[44:47], a[36:39], v[88:91], v[44:47]
ds_read_b128 a[80:83], v11 offset:2240
v_mfma_f32_16x16x32_bf16 v[24:27], a[40:43], v[64:67], v[24:27]
ds_read_b64 a[20:21], v10 offset:1216
v_mfma_f32_16x16x32_bf16 v[28:31], a[40:43], v[68:71], v[28:31]
ds_read_b64 a[22:23], v10 offset:1224
v_mfma_f32_16x16x32_bf16 v[32:35], a[40:43], v[72:75], v[32:35]
ds_read_b128 a[84:87], v11 offset:2752
v_mfma_f32_16x16x32_bf16 v[36:39], a[40:43], v[76:79], v[36:39]
ds_read_b64 a[24:25], v10 offset:704
v_mfma_f32_16x16x32_bf16 v[40:43], a[40:43], v[80:83], v[40:43]
ds_read_b64 a[26:27], v10 offset:712
v_mfma_f32_16x16x32_bf16 v[44:47], a[40:43], v[84:87], v[44:47]
ds_read_b128 a[88:91], v11 offset:3264
v_mfma_f32_16x16x32_bf16 v[28:31], a[44:47], v[64:67], v[28:31]
ds_read_b64 a[28:29], v10 offset:192
v_mfma_f32_16x16x32_bf16 v[32:35], a[44:47], v[68:71], v[32:35]
ds_read_b64 a[30:31], v10 offset:200
v_mfma_f32_16x16x32_bf16 v[36:39], a[44:47], v[72:75], v[36:39]
ds_read_b128 a[92:95], v11 offset:3776
v_mfma_f32_16x16x32_bf16 v[40:43], a[44:47], v[76:79], v[40:43]
v_mfma_f32_16x16x32_bf16 v[44:47], a[44:47], v[80:83], v[44:47]
v_mfma_f32_16x16x32_bf16 v[32:35], a[48:51], v[64:67], v[32:35]
v_mfma_f32_16x16x32_bf16 v[36:39], a[48:51], v[68:71], v[36:39]
v_mfma_f32_16x16x32_bf16 v[40:43], a[48:51], v[72:75], v[40:43]
v_mfma_f32_16x16x32_bf16 v[44:47], a[48:51], v[76:79], v[44:47]
v_mfma_f32_16x16x32_bf16 v[36:39], a[52:55], v[64:67], v[36:39]
v_mfma_f32_16x16x32_bf16 v[40:43], a[52:55], v[68:71], v[40:43]
v_mfma_f32_16x16x32_bf16 v[44:47], a[52:55], v[72:75], v[44:47]
v_mfma_f32_16x16x32_bf16 v[40:43], a[56:59], v[64:67], v[40:43]
v_mfma_f32_16x16x32_bf16 v[44:47], a[56:59], v[68:71], v[44:47]
v_mfma_f32_16x16x32_bf16 v[44:47], a[60:63], v[64:67], v[44:47]
s_waitcnt lgkmcnt(0)
v_mfma_f32_16x16x32_bf16 v[16:19], a[0:3], a[64:67], v[16:19]
ds_read_b64 a[32:33], v10 offset:3712
v_mfma_f32_16x16x32_bf16 v[20:23], a[0:3], a[68:71], v[20:23]
ds_read_b64 a[34:35], v10 offset:3720
v_mfma_f32_16x16x32_bf16 v[24:27], a[0:3], a[72:75], v[24:27]
ds_read_b128 v[64:67], v11 offset:128
v_mfma_f32_16x16x32_bf16 v[28:31], a[0:3], a[76:79], v[28:31]
ds_read_b64 a[36:37], v10 offset:3200
v_mfma_f32_16x16x32_bf16 v[32:35], a[0:3], a[80:83], v[32:35]
ds_read_b64 a[38:39], v10 offset:3208
v_mfma_f32_16x16x32_bf16 v[36:39], a[0:3], a[84:87], v[36:39]
ds_read_b128 v[68:71], v11 offset:640
v_mfma_f32_16x16x32_bf16 v[40:43], a[0:3], a[88:91], v[40:43]
ds_read_b64 a[40:41], v10 offset:2688
v_mfma_f32_16x16x32_bf16 v[44:47], a[0:3], a[92:95], v[44:47]
ds_read_b64 a[42:43], v10 offset:2696
v_mfma_f32_16x16x32_bf16 v[20:23], a[4:7], a[64:67], v[20:23]
ds_read_b128 v[72:75], v11 offset:1152
v_mfma_f32_16x16x32_bf16 v[24:27], a[4:7], a[68:71], v[24:27]
ds_read_b64 a[44:45], v10 offset:2176
v_mfma_f32_16x16x32_bf16 v[28:31], a[4:7], a[72:75], v[28:31]
ds_read_b64 a[46:47], v10 offset:2184
v_mfma_f32_16x16x32_bf16 v[32:35], a[4:7], a[76:79], v[32:35]
ds_read_b128 v[76:79], v11 offset:1664
v_mfma_f32_16x16x32_bf16 v[36:39], a[4:7], a[80:83], v[36:39]
ds_read_b64 a[48:49], v10 offset:1664
v_mfma_f32_16x16x32_bf16 v[40:43], a[4:7], a[84:87], v[40:43]
ds_read_b64 a[50:51], v10 offset:1672
v_mfma_f32_16x16x32_bf16 v[44:47], a[4:7], a[88:91], v[44:47]
ds_read_b128 v[80:83], v11 offset:2176
v_mfma_f32_16x16x32_bf16 v[24:27], a[8:11], a[64:67], v[24:27]
ds_read_b64 a[52:53], v10 offset:1152
v_mfma_f32_16x16x32_bf16 v[28:31], a[8:11], a[68:71], v[28:31]
ds_read_b64 a[54:55], v10 offset:1160
v_mfma_f32_16x16x32_bf16 v[32:35], a[8:11], a[72:75], v[32:35]
ds_read_b128 v[84:87], v11 offset:2688
v_mfma_f32_16x16x32_bf16 v[36:39], a[8:11], a[76:79], v[36:39]
ds_read_b64 a[56:57], v10 offset:640
v_mfma_f32_16x16x32_bf16 v[40:43], a[8:11], a[80:83], v[40:43]
ds_read_b64 a[58:59], v10 offset:648
v_mfma_f32_16x16x32_bf16 v[44:47], a[8:11], a[84:87], v[44:47]
ds_read_b128 v[88:91], v11 offset:3200
v_mfma_f32_16x16x32_bf16 v[28:31], a[12:15], a[64:67], v[28:31]
ds_read_b64 a[60:61], v10 offset:128
v_mfma_f32_16x16x32_bf16 v[32:35], a[12:15], a[68:71], v[32:35]
ds_read_b64 a[62:63], v10 offset:136
v_mfma_f32_16x16x32_bf16 v[36:39], a[12:15], a[72:75], v[36:39]
ds_read_b128 v[92:95], v11 offset:3712
v_mfma_f32_16x16x32_bf16 v[40:43], a[12:15], a[76:79], v[40:43]
v_mfma_f32_16x16x32_bf16 v[44:47], a[12:15], a[80:83], v[44:47]
v_mfma_f32_16x16x32_bf16 v[32:35], a[16:19], a[64:67], v[32:35]
v_mfma_f32_16x16x32_bf16 v[36:39], a[16:19], a[68:71], v[36:39]
v_mfma_f32_16x16x32_bf16 v[40:43], a[16:19], a[72:75], v[40:43]
v_mfma_f32_16x16x32_bf16 v[44:47], a[16:19], a[76:79], v[44:47]
v_mfma_f32_16x16x32_bf16 v[36:39], a[20:23], a[64:67], v[36:39]
v_mfma_f32_16x16x32_bf16 v[40:43], a[20:23], a[68:71], v[40:43]
v_mfma_f32_16x16x32_bf16 v[44:47], a[20:23], a[72:75], v[44:47]
v_mfma_f32_16x16x32_bf16 v[40:43], a[24:27], a[64:67], v[40:43]
v_mfma_f32_16x16x32_bf16 v[44:47], a[24:27], a[68:71], v[44:47]
v_mfma_f32_16x16x32_bf16 v[44:47], a[28:31], a[64:67], v[44:47]
s_waitcnt lgkmcnt(0)
v_mfma_f32_16x16x32_bf16 v[16:19], a[32:35], v[64:67], v[16:19]
ds_read_b64 a[0:1], v10 offset:3648
v_mfma_f32_16x16x32_bf16 v[20:23], a[32:35], v[68:71], v[20:23]
ds_read_b64 a[2:3], v10 offset:3656
v_mfma_f32_16x16x32_bf16 v[24:27], a[32:35], v[72:75], v[24:27]
ds_read_b128 a[64:67], v11 offset:64
v_mfma_f32_16x16x32_bf16 v[28:31], a[32:35], v[76:79], v[28:31]
ds_read_b64 a[4:5], v10 offset:3136
v_mfma_f32_16x16x32_bf16 v[32:35], a[32:35], v[80:83], v[32:35]
ds_read_b64 a[6:7], v10 offset:3144
v_mfma_f32_16x16x32_bf16 v[36:39], a[32:35], v[84:87], v[36:39]
ds_read_b128 a[68:71], v11 offset:576
v_mfma_f32_16x16x32_bf16 v[40:43], a[32:35], v[88:91], v[40:43]
ds_read_b64 a[8:9], v10 offset:2624
v_mfma_f32_16x16x32_bf16 v[44:47], a[32:35], v[92:95], v[44:47]
ds_read_b64 a[10:11], v10 offset:2632
v_mfma_f32_16x16x32_bf16 v[20:23], a[36:39], v[64:67], v[20:23]
ds_read_b128 a[72:75], v11 offset:1088
v_mfma_f32_16x16x32_bf16 v[24:27], a[36:39], v[68:71], v[24:27]
ds_read_b64 a[12:13], v10 offset:2112
v_mfma_f32_16x16x32_bf16 v[28:31], a[36:39], v[72:75], v[28:31]
ds_read_b64 a[14:15], v10 offset:2120
v_mfma_f32_16x16x32_bf16 v[32:35], a[36:39], v[76:79], v[32:35]
ds_read_b128 a[76:79], v11 offset:1600
v_mfma_f32_16x16x32_bf16 v[36:39], a[36:39], v[80:83], v[36:39]
ds_read_b64 a[16:17], v10 offset:1600
v_mfma_f32_16x16x32_bf16 v[40:43], a[36:39], v[84:87], v[40:43]
ds_read_b64 a[18:19], v10 offset:1608
v_mfma_f32_16x16x32_bf16 v[44:47], a[36:39], v[88:91], v[44:47]
ds_read_b128 a[80:83], v11 offset:2112
v_mfma_f32_16x16x32_bf16 v[24:27], a[40:43], v[64:67], v[24:27]
ds_read_b64 a[20:21], v10 offset:1088
v_mfma_f32_16x16x32_bf16 v[28:31], a[40:43], v[68:71], v[28:31]
ds_read_b64 a[22:23], v10 offset:1096
v_mfma_f32_16x16x32_bf16 v[32:35], a[40:43], v[72:75], v[32:35]
ds_read_b128 a[84:87], v11 offset:2624
v_mfma_f32_16x16x32_bf16 v[36:39], a[40:43], v[76:79], v[36:39]
ds_read_b64 a[24:25], v10 offset:576
v_mfma_f32_16x16x32_bf16 v[40:43], a[40:43], v[80:83], v[40:43]
ds_read_b64 a[26:27], v10 offset:584
v_mfma_f32_16x16x32_bf16 v[44:47], a[40:43], v[84:87], v[44:47]
ds_read_b128 a[88:91], v11 offset:3136
v_mfma_f32_16x16x32_bf16 v[28:31], a[44:47], v[64:67], v[28:31]
ds_read_b64 a[28:29], v10 offset:64
v_mfma_f32_16x16x32_bf16 v[32:35], a[44:47], v[68:71], v[32:35]
ds_read_b64 a[30:31], v10 offset:72
v_mfma_f32_16x16x32_bf16 v[36:39], a[44:47], v[72:75], v[36:39]
ds_read_b128 a[92:95], v11 offset:3648
v_mfma_f32_16x16x32_bf16 v[40:43], a[44:47], v[76:79], v[40:43]
v_mfma_f32_16x16x32_bf16 v[44:47], a[44:47], v[80:83], v[44:47]
v_mfma_f32_16x16x32_bf16 v[32:35], a[48:51], v[64:67], v[32:35]
v_mfma_f32_16x16x32_bf16 v[36:39], a[48:51], v[68:71], v[36:39]
v_mfma_f32_16x16x32_bf16 v[40:43], a[48:51], v[72:75], v[40:43]
v_mfma_f32_16x16x32_bf16 v[44:47], a[48:51], v[76:79], v[44:47]
v_mfma_f32_16x16x32_bf16 v[36:39], a[52:55], v[64:67], v[36:39]
v_mfma_f32_16x16x32_bf16 v[40:43], a[52:55], v[68:71], v[40:43]
v_mfma_f32_16x16x32_bf16 v[44:47], a[52:55], v[72:75], v[44:47]
v_mfma_f32_16x16x32_bf16 v[40:43], a[56:59], v[64:67], v[40:43]
v_mfma_f32_16x16x32_bf16 v[44:47], a[56:59], v[68:71], v[44:47]
v_mfma_f32_16x16x32_bf16 v[44:47], a[60:63], v[64:67], v[44:47]
s_waitcnt lgkmcnt(0)
v_mfma_f32_16x16x32_bf16 v[16:19], a[0:3], a[64:67], v[16:19]
ds_read_b64 a[32:33], v10 offset:3584
v_mfma_f32_16x16x32_bf16 v[20:23], a[0:3], a[68:71], v[20:23]
ds_read_b64 a[34:35], v10 offset:3592
v_mfma_f32_16x16x32_bf16 v[24:27], a[0:3], a[72:75], v[24:27]
ds_read_b128 v[64:67], v11 offset:0
v_mfma_f32_16x16x32_bf16 v[28:31], a[0:3], a[76:79], v[28:31]
ds_read_b64 a[36:37], v10 offset:3072
v_mfma_f32_16x16x32_bf16 v[32:35], a[0:3], a[80:83], v[32:35]
ds_read_b64 a[38:39], v10 offset:3080
v_mfma_f32_16x16x32_bf16 v[36:39], a[0:3], a[84:87], v[36:39]
ds_read_b128 v[68:71], v11 offset:512
v_mfma_f32_16x16x32_bf16 v[40:43], a[0:3], a[88:91], v[40:43]
ds_read_b64 a[40:41], v10 offset:2560
v_mfma_f32_16x16x32_bf16 v[44:47], a[0:3], a[92:95], v[44:47]
ds_read_b64 a[42:43], v10 offset:2568
v_mfma_f32_16x16x32_bf16 v[20:23], a[4:7], a[64:67], v[20:23]
ds_read_b128 v[72:75], v11 offset:1024
v_mfma_f32_16x16x32_bf16 v[24:27], a[4:7], a[68:71], v[24:27]
ds_read_b64 a[44:45], v10 offset:2048
v_mfma_f32_16x16x32_bf16 v[28:31], a[4:7], a[72:75], v[28:31]
ds_read_b64 a[46:47], v10 offset:2056
v_mfma_f32_16x16x32_bf16 v[32:35], a[4:7], a[76:79], v[32:35]
ds_read_b128 v[76:79], v11 offset:1536
v_mfma_f32_16x16x32_bf16 v[36:39], a[4:7], a[80:83], v[36:39]
ds_read_b64 a[48:49], v10 offset:1536
v_mfma_f32_16x16x32_bf16 v[40:43], a[4:7], a[84:87], v[40:43]
ds_read_b64 a[50:51], v10 offset:1544
v_mfma_f32_16x16x32_bf16 v[44:47], a[4:7], a[88:91], v[44:47]
ds_read_b128 v[80:83], v11 offset:2048
v_mfma_f32_16x16x32_bf16 v[24:27], a[8:11], a[64:67], v[24:27]
ds_read_b64 a[52:53], v10 offset:1024
v_mfma_f32_16x16x32_bf16 v[28:31], a[8:11], a[68:71], v[28:31]
ds_read_b64 a[54:55], v10 offset:1032
v_mfma_f32_16x16x32_bf16 v[32:35], a[8:11], a[72:75], v[32:35]
ds_read_b128 v[84:87], v11 offset:2560
v_mfma_f32_16x16x32_bf16 v[36:39], a[8:11], a[76:79], v[36:39]
ds_read_b64 a[56:57], v10 offset:512
v_mfma_f32_16x16x32_bf16 v[40:43], a[8:11], a[80:83], v[40:43]
ds_read_b64 a[58:59], v10 offset:520
v_mfma_f32_16x16x32_bf16 v[44:47], a[8:11], a[84:87], v[44:47]
ds_read_b128 v[88:91], v11 offset:3072
v_mfma_f32_16x16x32_bf16 v[28:31], a[12:15], a[64:67], v[28:31]
ds_read_b64 a[60:61], v10 offset:0
v_mfma_f32_16x16x32_bf16 v[32:35], a[12:15], a[68:71], v[32:35]
ds_read_b64 a[62:63], v10 offset:8
v_mfma_f32_16x16x32_bf16 v[36:39], a[12:15], a[72:75], v[36:39]
ds_read_b128 v[92:95], v11 offset:3584
v_mfma_f32_16x16x32_bf16 v[40:43], a[12:15], a[76:79], v[40:43]
v_mfma_f32_16x16x32_bf16 v[44:47], a[12:15], a[80:83], v[44:47]
v_mfma_f32_16x16x32_bf16 v[32:35], a[16:19], a[64:67], v[32:35]
v_mfma_f32_16x16x32_bf16 v[36:39], a[16:19], a[68:71], v[36:39]
v_mfma_f32_16x16x32_bf16 v[40:43], a[16:19], a[72:75], v[40:43]
v_mfma_f32_16x16x32_bf16 v[44:47], a[16:19], a[76:79], v[44:47]
v_mfma_f32_16x16x32_bf16 v[36:39], a[20:23], a[64:67], v[36:39]
v_mfma_f32_16x16x32_bf16 v[40:43], a[20:23], a[68:71], v[40:43]
v_mfma_f32_16x16x32_bf16 v[44:47], a[20:23], a[72:75], v[44:47]
v_mfma_f32_16x16x32_bf16 v[40:43], a[24:27], a[64:67], v[40:43]
v_mfma_f32_16x16x32_bf16 v[44:47], a[24:27], a[68:71], v[44:47]
v_mfma_f32_16x16x32_bf16 v[44:47], a[28:31], a[64:67], v[44:47]
s_waitcnt lgkmcnt(0)
v_lshlrev_b32 v112, 2, v1
s_lshl_b32 s63, s8, 8
s_add_u32 s63, s63, 27660288
buffer_load_dword v113, v112, s[24:27], s63 offen sc1
v_mfma_f32_16x16x32_bf16 v[16:19], a[32:35], v[64:67], v[16:19]
v_mfma_f32_16x16x32_bf16 v[20:23], a[32:35], v[68:71], v[20:23]
v_mfma_f32_16x16x32_bf16 v[24:27], a[32:35], v[72:75], v[24:27]
v_mfma_f32_16x16x32_bf16 v[28:31], a[32:35], v[76:79], v[28:31]
v_mfma_f32_16x16x32_bf16 v[32:35], a[32:35], v[80:83], v[32:35]
v_mfma_f32_16x16x32_bf16 v[36:39], a[32:35], v[84:87], v[36:39]
v_mfma_f32_16x16x32_bf16 v[40:43], a[32:35], v[88:91], v[40:43]
v_mfma_f32_16x16x32_bf16 v[44:47], a[32:35], v[92:95], v[44:47]
v_mfma_f32_16x16x32_bf16 v[20:23], a[36:39], v[64:67], v[20:23]
v_mfma_f32_16x16x32_bf16 v[24:27], a[36:39], v[68:71], v[24:27]
v_mfma_f32_16x16x32_bf16 v[28:31], a[36:39], v[72:75], v[28:31]
v_mfma_f32_16x16x32_bf16 v[32:35], a[36:39], v[76:79], v[32:35]
v_mfma_f32_16x16x32_bf16 v[36:39], a[36:39], v[80:83], v[36:39]
v_mfma_f32_16x16x32_bf16 v[40:43], a[36:39], v[84:87], v[40:43]
v_mfma_f32_16x16x32_bf16 v[44:47], a[36:39], v[88:91], v[44:47]
v_mfma_f32_16x16x32_bf16 v[24:27], a[40:43], v[64:67], v[24:27]
v_mfma_f32_16x16x32_bf16 v[28:31], a[40:43], v[68:71], v[28:31]
v_mfma_f32_16x16x32_bf16 v[32:35], a[40:43], v[72:75], v[32:35]
v_mfma_f32_16x16x32_bf16 v[36:39], a[40:43], v[76:79], v[36:39]
v_mfma_f32_16x16x32_bf16 v[40:43], a[40:43], v[80:83], v[40:43]
v_mfma_f32_16x16x32_bf16 v[44:47], a[40:43], v[84:87], v[44:47]
v_mfma_f32_16x16x32_bf16 v[28:31], a[44:47], v[64:67], v[28:31]
v_mfma_f32_16x16x32_bf16 v[32:35], a[44:47], v[68:71], v[32:35]
v_mfma_f32_16x16x32_bf16 v[36:39], a[44:47], v[72:75], v[36:39]
v_mfma_f32_16x16x32_bf16 v[40:43], a[44:47], v[76:79], v[40:43]
v_mfma_f32_16x16x32_bf16 v[44:47], a[44:47], v[80:83], v[44:47]
v_mfma_f32_16x16x32_bf16 v[32:35], a[48:51], v[64:67], v[32:35]
v_mfma_f32_16x16x32_bf16 v[36:39], a[48:51], v[68:71], v[36:39]
v_mfma_f32_16x16x32_bf16 v[40:43], a[48:51], v[72:75], v[40:43]
v_mfma_f32_16x16x32_bf16 v[44:47], a[48:51], v[76:79], v[44:47]
v_mfma_f32_16x16x32_bf16 v[36:39], a[52:55], v[64:67], v[36:39]
v_mfma_f32_16x16x32_bf16 v[40:43], a[52:55], v[68:71], v[40:43]
v_mfma_f32_16x16x32_bf16 v[44:47], a[52:55], v[72:75], v[44:47]
v_mfma_f32_16x16x32_bf16 v[40:43], a[56:59], v[64:67], v[40:43]
v_mfma_f32_16x16x32_bf16 v[44:47], a[56:59], v[68:71], v[44:47]
v_mfma_f32_16x16x32_bf16 v[44:47], a[60:63], v[64:67], v[44:47]
s_waitcnt lgkmcnt(0)
v_lshlrev_b32 v14, 4, v8
v_lshlrev_b32 v15, 2, v9
v_add_u32 v14, v14, v15
v_sub_u32 v15, 252, v14
v_lshlrev_b32 v15, 1, v15
v_add_u32 v15, s57, v15
ds_read_b64 v[64:65], v15 offset:3584
ds_read_b64 v[66:67], v15 offset:3072
ds_read_b64 v[68:69], v15 offset:2560
ds_read_b64 v[70:71], v15 offset:2048
ds_read_b64 v[72:73], v15 offset:1536
ds_read_b64 v[74:75], v15 offset:1024
ds_read_b64 v[76:77], v15 offset:512
ds_read_b64 v[78:79], v15 offset:0
v_lshlrev_b32 v13, 16, v13
v_and_b32 v84, 1, v9
v_lshlrev_b32 v84, 9, v84
v_lshrrev_b32 v85, 1, v9
v_lshlrev_b32 v85, 4, v85
v_add_u32 v84, v84, v85
v_lshlrev_b32 v85, 5, v8
v_add_u32 v84, v84, v85
s_mov_b32 s10, s58
s_waitcnt lgkmcnt(0)
s_mov_b32 s61, s59
s_mov_b32 s62, s58
s_mov_b32 s28, s82
s_and_b32 s29, s83, 0xffff
s_mov_b32 s30, 7340032
s_mov_b32 s31, 0x20000
v_lshlrev_b32 v2, 4, v1
v_add_u32 v3, 112640, v2
s_and_b32 s55, s9, 1
s_mul_i32 s55, s55, 32
s_lshl_b32 s50, s8, 3
s_lshl_b32 s10, s5, 1
s_add_u32 s50, s50, s10
s_mul_i32 s50, s50, 114688
s_lshl_b32 s51, s5, 12
v_lshrrev_b32 v6, 3, v1
v_and_b32 v7, 7, v1
v_lshrrev_b32 v8, 1, v7
v_lshrrev_b32 v9, 1, v6
v_xor_b32 v8, v8, v9
v_lshlrev_b32 v8, 1, v8
v_and_b32 v9, 1, v7
v_or_b32 v8, v8, v9
v_lshlrev_b32 v8, 4, v8
v_lshlrev_b32 v6, 11, v6
v_add_u32 v4, v6, v8
v_add_u32 v5, 15360, v4
s_lshl_b32 s52, s5, 15
s_lshl_b32 s10, s9, 7
s_add_u32 s54, s52, s10
s_xor_b32 s10, s10, 128
s_add_u32 s10, s52, s10
s_mov_b32 s52, s54
s_mov_b32 s54, s10
s_lshl_b32 s53, s5, 11
s_add_u32 s53, s53, 16384
s_lshl_b32 s10, s55, 11
s_add_u32 s56, s50, s10
s_lshl_b32 s10, s55, 17
s_add_u32 s57, s52, s10
s_add_u32 s58, s54, s10
s_barrier
s_waitcnt vmcnt(0)
s_mov_b32 s98, 0x0
s_mov_b32 s99, 0xff0
s_and_b32 s10, s9, 1
s_cmp_eq_u32 s10, 0
s_cselect_b32 s98, 0xff, s98
s_cselect_b32 s99, 0x0, s99
v_cmp_ne_u32 vcc, s97, v113
s_nop 1
s_and_b64 vcc, vcc, s[98:99]
s_cbranch_scc0 L_hok_26
s_mov_b32 s14, 0x200000
L_hlp_27:
buffer_load_dword v113, v112, s[24:27], s63 offen sc1
s_waitcnt vmcnt(0)
v_cmp_ne_u32 vcc, s97, v113
s_sub_u32 s14, s14, 1
s_cmp_eq_u32 s14, 0
s_cbranch_scc1 L_hok_26
s_and_b64 vcc, vcc, s[98:99]
s_cbranch_scc0 L_hok_26
s_sleep 8
s_branch L_hlp_27
L_hok_26:
s_add_u32 m0, s53, 32768
s_add_u32 s10, s57, 262144
buffer_load_dwordx4 v4, s[28:31], s10 offen offset:0 lds
buffer_load_dwordx4 v5, s[28:31], s10 offen offset:1024 lds
s_add_u32 m0, s53, 40960
s_add_u32 s10, s58, 262144
buffer_load_dwordx4 v4, s[28:31], s10 offen offset:0 lds
buffer_load_dwordx4 v5, s[28:31], s10 offen offset:1024 lds
s_add_u32 m0, s51, 32768
s_add_u32 s10, s56, 4096
buffer_load_dwordx4 v2, s[24:27], s10 offen offset:0 sc1 lds
buffer_load_dwordx4 v2, s[24:27], s10 offen offset:1024 sc1 lds
buffer_load_dwordx4 v3, s[24:27], s10 offen offset:2048 sc1 lds
buffer_load_dwordx4 v3, s[24:27], s10 offen offset:3072 sc1 lds
s_add_u32 m0, s53, 65536
s_add_u32 s10, s57, 393216
buffer_load_dwordx4 v4, s[28:31], s10 offen offset:0 lds
buffer_load_dwordx4 v5, s[28:31], s10 offen offset:1024 lds
s_add_u32 m0, s53, 73728
s_add_u32 s10, s58, 393216
buffer_load_dwordx4 v4, s[28:31], s10 offen offset:0 lds
buffer_load_dwordx4 v5, s[28:31], s10 offen offset:1024 lds
s_add_u32 m0, s51, 65536
s_add_u32 s10, s56, 6144
buffer_load_dwordx4 v2, s[24:27], s10 offen offset:0 sc1 lds
buffer_load_dwordx4 v2, s[24:27], s10 offen offset:1024 sc1 lds
buffer_load_dwordx4 v3, s[24:27], s10 offen offset:2048 sc1 lds
buffer_load_dwordx4 v3, s[24:27], s10 offen offset:3072 sc1 lds
s_mov_b32 s10, s62
v_lshlrev_b32 v80, 16, v64
v_and_b32 v81, 0xffff0000, v64
v_lshlrev_b32 v82, 16, v65
v_and_b32 v83, 0xffff0000, v65
v_fmac_f32 v19, v80, v13
v_fmac_f32 v18, v81, v13
v_fmac_f32 v17, v82, v13
v_fmac_f32 v16, v83, v13
v_cvt_pk_bf16_f32 v96, v16, v17
v_cvt_pk_bf16_f32 v97, v18, v19
v_lshlrev_b32 v80, 16, v66
v_and_b32 v81, 0xffff0000, v66
v_lshlrev_b32 v82, 16, v67
v_and_b32 v83, 0xffff0000, v67
v_fmac_f32 v23, v80, v13
v_fmac_f32 v22, v81, v13
v_fmac_f32 v21, v82, v13
v_fmac_f32 v20, v83, v13
v_cvt_pk_bf16_f32 v98, v20, v21
v_cvt_pk_bf16_f32 v99, v22, v23
v_lshlrev_b32 v80, 16, v68
v_and_b32 v81, 0xffff0000, v68
v_lshlrev_b32 v82, 16, v69
v_and_b32 v83, 0xffff0000, v69
v_fmac_f32 v27, v80, v13
v_fmac_f32 v26, v81, v13
v_fmac_f32 v25, v82, v13
v_fmac_f32 v24, v83, v13
v_cvt_pk_bf16_f32 v100, v24, v25
v_cvt_pk_bf16_f32 v101, v26, v27
v_lshlrev_b32 v80, 16, v70
v_and_b32 v81, 0xffff0000, v70
v_lshlrev_b32 v82, 16, v71
v_and_b32 v83, 0xffff0000, v71
v_fmac_f32 v31, v80, v13
v_fmac_f32 v30, v81, v13
v_fmac_f32 v29, v82, v13
v_fmac_f32 v28, v83, v13
v_cvt_pk_bf16_f32 v102, v28, v29
v_cvt_pk_bf16_f32 v103, v30, v31
v_lshlrev_b32 v80, 16, v72
v_and_b32 v81, 0xffff0000, v72
v_lshlrev_b32 v82, 16, v73
v_and_b32 v83, 0xffff0000, v73
v_fmac_f32 v35, v80, v13
v_fmac_f32 v34, v81, v13
v_fmac_f32 v33, v82, v13
v_fmac_f32 v32, v83, v13
v_cvt_pk_bf16_f32 v104, v32, v33
v_cvt_pk_bf16_f32 v105, v34, v35
v_lshlrev_b32 v80, 16, v74
v_and_b32 v81, 0xffff0000, v74
v_lshlrev_b32 v82, 16, v75
v_and_b32 v83, 0xffff0000, v75
v_fmac_f32 v39, v80, v13
v_fmac_f32 v38, v81, v13
v_fmac_f32 v37, v82, v13
v_fmac_f32 v36, v83, v13
v_cvt_pk_bf16_f32 v106, v36, v37
v_cvt_pk_bf16_f32 v107, v38, v39
v_lshlrev_b32 v80, 16, v76
v_and_b32 v81, 0xffff0000, v76
v_lshlrev_b32 v82, 16, v77
v_and_b32 v83, 0xffff0000, v77
v_fmac_f32 v43, v80, v13
v_fmac_f32 v42, v81, v13
v_fmac_f32 v41, v82, v13
v_fmac_f32 v40, v83, v13
v_cvt_pk_bf16_f32 v108, v40, v41
v_cvt_pk_bf16_f32 v109, v42, v43
v_lshlrev_b32 v80, 16, v78
v_and_b32 v81, 0xffff0000, v78
v_lshlrev_b32 v82, 16, v79
v_and_b32 v83, 0xffff0000, v79
v_fmac_f32 v47, v80, v13
v_fmac_f32 v46, v81, v13
v_fmac_f32 v45, v82, v13
v_fmac_f32 v44, v83, v13
v_cvt_pk_bf16_f32 v110, v44, v45
v_cvt_pk_bf16_f32 v111, v46, v47
s_nop 1
v_permlane16_swap_b32 v96, v98
v_permlane16_swap_b32 v97, v99
s_nop 1
buffer_store_dwordx4 v[96:99], v84, s[24:27], s10 offen offset:0 sc1
v_permlane16_swap_b32 v100, v102
v_permlane16_swap_b32 v101, v103
s_nop 1
buffer_store_dwordx4 v[100:103], v84, s[24:27], s10 offen offset:1024 sc1
v_permlane16_swap_b32 v104, v106
v_permlane16_swap_b32 v105, v107
s_nop 1
buffer_store_dwordx4 v[104:107], v84, s[24:27], s10 offen offset:2048 sc1
v_permlane16_swap_b32 v108, v110
v_permlane16_swap_b32 v109, v111
s_nop 1
buffer_store_dwordx4 v[108:111], v84, s[24:27], s10 offen offset:3072 sc1
s_barrier
s_add_u32 m0, s53, 131072
s_add_u32 s10, s57, 524288
buffer_load_dwordx4 v4, s[28:31], s10 offen offset:0 lds
buffer_load_dwordx4 v5, s[28:31], s10 offen offset:1024 lds
s_add_u32 m0, s53, 139264
s_add_u32 s10, s58, 524288
buffer_load_dwordx4 v4, s[28:31], s10 offen offset:0 lds
buffer_load_dwordx4 v5, s[28:31], s10 offen offset:1024 lds
s_add_u32 m0, s51, 131072
s_add_u32 s10, s56, 8192
buffer_load_dwordx4 v2, s[24:27], s10 offen offset:0 sc1 lds
buffer_load_dwordx4 v2, s[24:27], s10 offen offset:1024 sc1 lds
buffer_load_dwordx4 v3, s[24:27], s10 offen offset:2048 sc1 lds
buffer_load_dwordx4 v3, s[24:27], s10 offen offset:3072 sc1 lds
s_waitcnt vmcnt(20)
s_barrier
buffer_load_dword v113, v112, s[24:27], s63 offen sc1
s_add_u32 m0, s53, 0
s_add_u32 s10, s57, 655360
buffer_load_dwordx4 v4, s[28:31], s10 offen offset:0 lds
buffer_load_dwordx4 v5, s[28:31], s10 offen offset:1024 lds
s_add_u32 m0, s53, 8192
s_add_u32 s10, s58, 655360
buffer_load_dwordx4 v4, s[28:31], s10 offen offset:0 lds
buffer_load_dwordx4 v5, s[28:31], s10 offen offset:1024 lds
s_add_u32 m0, s51, 0
s_add_u32 s10, s56, 10240
buffer_load_dwordx4 v2, s[24:27], s10 offen offset:0 sc1 lds
buffer_load_dwordx4 v2, s[24:27], s10 offen offset:1024 sc1 lds
buffer_load_dwordx4 v3, s[24:27], s10 offen offset:2048 sc1 lds
buffer_load_dwordx4 v3, s[24:27], s10 offen offset:3072 sc1 lds
s_waitcnt vmcnt(21)
s_barrier
s_waitcnt vmcnt(8)
s_mov_b32 s98, 0x0
s_mov_b32 s99, 0xf000
s_and_b32 s10, s9, 1
s_cmp_eq_u32 s10, 0
s_cselect_b32 s98, 0xf00, s98
s_cselect_b32 s99, 0x0, s99
v_cmp_ne_u32 vcc, s97, v113
s_nop 1
s_and_b64 vcc, vcc, s[98:99]
s_cbranch_scc0 L_hok_28
s_mov_b32 s14, 0x200000
L_hlp_29:
buffer_load_dword v113, v112, s[24:27], s63 offen sc1
s_waitcnt vmcnt(0)
v_cmp_ne_u32 vcc, s97, v113
s_sub_u32 s14, s14, 1
s_cmp_eq_u32 s14, 0
s_cbranch_scc1 L_hok_28
s_and_b64 vcc, vcc, s[98:99]
s_cbranch_scc0 L_hok_28
s_sleep 8
s_branch L_hlp_29
L_hok_28:
s_add_u32 m0, s53, 32768
s_add_u32 s10, s57, 786432
buffer_load_dwordx4 v4, s[28:31], s10 offen offset:0 lds
buffer_load_dwordx4 v5, s[28:31], s10 offen offset:1024 lds
s_add_u32 m0, s53, 40960
s_add_u32 s10, s58, 786432
buffer_load_dwordx4 v4, s[28:31], s10 offen offset:0 lds
buffer_load_dwordx4 v5, s[28:31], s10 offen offset:1024 lds
s_add_u32 m0, s51, 32768
s_add_u32 s10, s56, 12288
buffer_load_dwordx4 v2, s[24:27], s10 offen offset:0 sc1 lds
buffer_load_dwordx4 v2, s[24:27], s10 offen offset:1024 sc1 lds
buffer_load_dwordx4 v3, s[24:27], s10 offen offset:2048 sc1 lds
buffer_load_dwordx4 v3, s[24:27], s10 offen offset:3072 sc1 lds
s_barrier
v_mov_b32 v20, 0
v_mov_b32 v21, s97
buffer_store_dword v21, v20, s[24:27], s61 offen sc1
s_add_u32 m0, s53, 65536
s_add_u32 s10, s57, 917504
buffer_load_dwordx4 v4, s[28:31], s10 offen offset:0 lds
buffer_load_dwordx4 v5, s[28:31], s10 offen offset:1024 lds
s_add_u32 m0, s53, 73728
s_add_u32 s10, s58, 917504
buffer_load_dwordx4 v4, s[28:31], s10 offen offset:0 lds
buffer_load_dwordx4 v5, s[28:31], s10 offen offset:1024 lds
s_add_u32 m0, s51, 65536
s_add_u32 s10, s56, 14336
buffer_load_dwordx4 v2, s[24:27], s10 offen offset:0 sc1 lds
buffer_load_dwordx4 v2, s[24:27], s10 offen offset:1024 sc1 lds
buffer_load_dwordx4 v3, s[24:27], s10 offen offset:2048 sc1 lds
buffer_load_dwordx4 v3, s[24:27], s10 offen offset:3072 sc1 lds
s_waitcnt vmcnt(17)
s_barrier
s_add_u32 m0, s53, 131072
s_add_u32 s10, s57, 1048576
buffer_load_dwordx4 v4, s[28:31], s10 offen offset:0 lds
buffer_load_dwordx4 v5, s[28:31], s10 offen offset:1024 lds
s_add_u32 m0, s53, 139264
s_add_u32 s10, s58, 1048576
buffer_load_dwordx4 v4, s[28:31], s10 offen offset:0 lds
buffer_load_dwordx4 v5, s[28:31], s10 offen offset:1024 lds
s_add_u32 m0, s51, 131072
s_add_u32 s10, s56, 16384
buffer_load_dwordx4 v2, s[24:27], s10 offen offset:0 sc1 lds
buffer_load_dwordx4 v2, s[24:27], s10 offen offset:1024 sc1 lds
buffer_load_dwordx4 v3, s[24:27], s10 offen offset:2048 sc1 lds
buffer_load_dwordx4 v3, s[24:27], s10 offen offset:3072 sc1 lds
s_waitcnt vmcnt(17)
s_barrier
buffer_load_dword v113, v112, s[24:27], s63 offen sc1
s_add_u32 m0, s53, 0
s_add_u32 s10, s57, 1179648
buffer_load_dwordx4 v4, s[28:31], s10 offen offset:0 lds
buffer_load_dwordx4 v5, s[28:31], s10 offen offset:1024 lds
s_add_u32 m0, s53, 8192
s_add_u32 s10, s58, 1179648
buffer_load_dwordx4 v4, s[28:31], s10 offen offset:0 lds
buffer_load_dwordx4 v5, s[28:31], s10 offen offset:1024 lds
s_add_u32 m0, s51, 0
s_add_u32 s10, s56, 18432
buffer_load_dwordx4 v2, s[24:27], s10 offen offset:0 sc1 lds
buffer_load_dwordx4 v2, s[24:27], s10 offen offset:1024 sc1 lds
buffer_load_dwordx4 v3, s[24:27], s10 offen offset:2048 sc1 lds
buffer_load_dwordx4 v3, s[24:27], s10 offen offset:3072 sc1 lds
s_waitcnt vmcnt(17)
s_barrier
s_waitcnt vmcnt(8)
s_mov_b32 s98, 0x0
s_mov_b32 s99, 0xf0000
s_and_b32 s10, s9, 1
s_cmp_eq_u32 s10, 0
s_cselect_b32 s98, 0xf000, s98
s_cselect_b32 s99, 0x0, s99
v_cmp_ne_u32 vcc, s97, v113
s_nop 1
s_and_b64 vcc, vcc, s[98:99]
s_cbranch_scc0 L_hok_30
s_mov_b32 s14, 0x200000
L_hlp_31:
buffer_load_dword v113, v112, s[24:27], s63 offen sc1
s_waitcnt vmcnt(0)
v_cmp_ne_u32 vcc, s97, v113
s_sub_u32 s14, s14, 1
s_cmp_eq_u32 s14, 0
s_cbranch_scc1 L_hok_30
s_and_b64 vcc, vcc, s[98:99]
s_cbranch_scc0 L_hok_30
s_sleep 8
s_branch L_hlp_31
L_hok_30:
s_add_u32 m0, s53, 32768
s_add_u32 s10, s57, 1310720
buffer_load_dwordx4 v4, s[28:31], s10 offen offset:0 lds
buffer_load_dwordx4 v5, s[28:31], s10 offen offset:1024 lds
s_add_u32 m0, s53, 40960
s_add_u32 s10, s58, 1310720
buffer_load_dwordx4 v4, s[28:31], s10 offen offset:0 lds
buffer_load_dwordx4 v5, s[28:31], s10 offen offset:1024 lds
s_add_u32 m0, s51, 32768
s_add_u32 s10, s56, 20480
buffer_load_dwordx4 v2, s[24:27], s10 offen offset:0 sc1 lds
buffer_load_dwordx4 v2, s[24:27], s10 offen offset:1024 sc1 lds
buffer_load_dwordx4 v3, s[24:27], s10 offen offset:2048 sc1 lds
buffer_load_dwordx4 v3, s[24:27], s10 offen offset:3072 sc1 lds
s_barrier
s_add_u32 m0, s53, 65536
s_add_u32 s10, s57, 1441792
buffer_load_dwordx4 v4, s[28:31], s10 offen offset:0 lds
buffer_load_dwordx4 v5, s[28:31], s10 offen offset:1024 lds
s_add_u32 m0, s53, 73728
s_add_u32 s10, s58, 1441792
buffer_load_dwordx4 v4, s[28:31], s10 offen offset:0 lds
buffer_load_dwordx4 v5, s[28:31], s10 offen offset:1024 lds
s_add_u32 m0, s51, 65536
s_add_u32 s10, s56, 22528
buffer_load_dwordx4 v2, s[24:27], s10 offen offset:0 sc1 lds
buffer_load_dwordx4 v2, s[24:27], s10 offen offset:1024 sc1 lds
buffer_load_dwordx4 v3, s[24:27], s10 offen offset:2048 sc1 lds
buffer_load_dwordx4 v3, s[24:27], s10 offen offset:3072 sc1 lds
s_waitcnt vmcnt(16)
s_barrier
buffer_load_dword v113, v112, s[24:27], s63 offen sc1
s_add_u32 m0, s53, 131072
s_add_u32 s10, s57, 1572864
buffer_load_dwordx4 v4, s[28:31], s10 offen offset:0 lds
buffer_load_dwordx4 v5, s[28:31], s10 offen offset:1024 lds
s_add_u32 m0, s53, 139264
s_add_u32 s10, s58, 1572864
buffer_load_dwordx4 v4, s[28:31], s10 offen offset:0 lds
buffer_load_dwordx4 v5, s[28:31], s10 offen offset:1024 lds
s_add_u32 m0, s51, 131072
s_add_u32 s10, s56, 24576
buffer_load_dwordx4 v2, s[24:27], s10 offen offset:0 sc1 lds
buffer_load_dwordx4 v2, s[24:27], s10 offen offset:1024 sc1 lds
buffer_load_dwordx4 v3, s[24:27], s10 offen offset:2048 sc1 lds
buffer_load_dwordx4 v3, s[24:27], s10 offen offset:3072 sc1 lds
s_waitcnt vmcnt(17)
s_barrier
s_waitcnt vmcnt(8)
s_mov_b32 s98, 0x0
s_mov_b32 s99, 0xf00000
s_and_b32 s10, s9, 1
s_cmp_eq_u32 s10, 0
s_cselect_b32 s98, 0xf0000, s98
s_cselect_b32 s99, 0x0, s99
v_cmp_ne_u32 vcc, s97, v113
s_nop 1
s_and_b64 vcc, vcc, s[98:99]
s_cbranch_scc0 L_hok_32
s_mov_b32 s14, 0x200000
L_hlp_33:
buffer_load_dword v113, v112, s[24:27], s63 offen sc1
s_waitcnt vmcnt(0)
v_cmp_ne_u32 vcc, s97, v113
s_sub_u32 s14, s14, 1
s_cmp_eq_u32 s14, 0
s_cbranch_scc1 L_hok_32
s_and_b64 vcc, vcc, s[98:99]
s_cbranch_scc0 L_hok_32
s_sleep 8
s_branch L_hlp_33
L_hok_32:
s_add_u32 m0, s53, 0
s_add_u32 s10, s57, 1703936
buffer_load_dwordx4 v4, s[28:31], s10 offen offset:0 lds
buffer_load_dwordx4 v5, s[28:31], s10 offen offset:1024 lds
s_add_u32 m0, s53, 8192
s_add_u32 s10, s58, 1703936
buffer_load_dwordx4 v4, s[28:31], s10 offen offset:0 lds
buffer_load_dwordx4 v5, s[28:31], s10 offen offset:1024 lds
s_add_u32 m0, s51, 0
s_add_u32 s10, s56, 26624
buffer_load_dwordx4 v2, s[24:27], s10 offen offset:0 sc1 lds
buffer_load_dwordx4 v2, s[24:27], s10 offen offset:1024 sc1 lds
buffer_load_dwordx4 v3, s[24:27], s10 offen offset:2048 sc1 lds
buffer_load_dwordx4 v3, s[24:27], s10 offen offset:3072 sc1 lds
s_barrier
s_cmp_eq_u32 s5, 3
s_cbranch_scc0 L_ipf_34
s_getpc_b64 s[10:11]
L_here_35:
s_sub_u32 s10, s10, L_here_35-parallel_sum__ssm_conv_h3__mixer_channel_mlp__prompt_kernel
s_subb_u32 s11, s11, 0
s_lshr_b32 s3, s2, 3
s_lshl_b32 s3, s3, 4
v_and_b32 v58, 15, v1
v_add_u32 v58, s3, v58
v_lshlrev_b32 v58, 7, v58
v_min_u32 v58, L_end_parallel_sum__ssm_conv_h3__mixer_channel_mlp__prompt_kernel-parallel_sum__ssm_conv_h3__mixer_channel_mlp__prompt_kernel, v58
v_mov_b32 v59, s11
v_add_co_u32 v58, vcc, s10, v58
s_nop 1
v_addc_co_u32 v59, vcc, 0, v59, vcc
s_mov_b64 s[98:99], exec
s_mov_b64 exec, 0xffff
global_load_dword v139, v[58:59], off
s_mov_b64 exec, s[98:99]
L_ipf_34:
v_lshlrev_b32 v10, 2, v1
s_lshl_b32 s12, s9, 8
s_add_u32 s12, s12, 27664384
buffer_load_dword v11, v10, s[24:27], s12 offen sc1
s_add_u32 m0, s53, 32768
s_add_u32 s10, s57, 1835008
buffer_load_dwordx4 v4, s[28:31], s10 offen offset:0 lds
buffer_load_dwordx4 v5, s[28:31], s10 offen offset:1024 lds
s_add_u32 m0, s53, 40960
s_add_u32 s10, s58, 1835008
buffer_load_dwordx4 v4, s[28:31], s10 offen offset:0 lds
buffer_load_dwordx4 v5, s[28:31], s10 offen offset:1024 lds
s_add_u32 m0, s51, 32768
s_add_u32 s10, s56, 28672
buffer_load_dwordx4 v2, s[24:27], s10 offen offset:0 sc1 lds
buffer_load_dwordx4 v2, s[24:27], s10 offen offset:1024 sc1 lds
buffer_load_dwordx4 v3, s[24:27], s10 offen offset:2048 sc1 lds
buffer_load_dwordx4 v3, s[24:27], s10 offen offset:3072 sc1 lds
s_waitcnt vmcnt(17)
s_barrier
s_add_u32 m0, s53, 65536
s_add_u32 s10, s57, 1966080
buffer_load_dwordx4 v4, s[28:31], s10 offen offset:0 lds
buffer_load_dwordx4 v5, s[28:31], s10 offen offset:1024 lds
s_add_u32 m0, s53, 73728
s_add_u32 s10, s58, 1966080
buffer_load_dwordx4 v4, s[28:31], s10 offen offset:0 lds
buffer_load_dwordx4 v5, s[28:31], s10 offen offset:1024 lds
s_add_u32 m0, s51, 65536
s_add_u32 s10, s56, 30720
buffer_load_dwordx4 v2, s[24:27], s10 offen offset:0 sc1 lds
buffer_load_dwordx4 v2, s[24:27], s10 offen offset:1024 sc1 lds
buffer_load_dwordx4 v3, s[24:27], s10 offen offset:2048 sc1 lds
buffer_load_dwordx4 v3, s[24:27], s10 offen offset:3072 sc1 lds
s_waitcnt vmcnt(17)
s_barrier
buffer_load_dword v113, v112, s[24:27], s63 offen sc1
s_add_u32 m0, s53, 131072
s_add_u32 s10, s57, 2097152
buffer_load_dwordx4 v4, s[28:31], s10 offen offset:0 lds
buffer_load_dwordx4 v5, s[28:31], s10 offen offset:1024 lds
s_add_u32 m0, s53, 139264
s_add_u32 s10, s58, 2097152
buffer_load_dwordx4 v4, s[28:31], s10 offen offset:0 lds
buffer_load_dwordx4 v5, s[28:31], s10 offen offset:1024 lds
s_add_u32 m0, s51, 131072
s_add_u32 s10, s56, 32768
buffer_load_dwordx4 v2, s[24:27], s10 offen offset:0 sc1 lds
buffer_load_dwordx4 v2, s[24:27], s10 offen offset:1024 sc1 lds
buffer_load_dwordx4 v3, s[24:27], s10 offen offset:2048 sc1 lds
buffer_load_dwordx4 v3, s[24:27], s10 offen offset:3072 sc1 lds
s_waitcnt vmcnt(25)
v_cmp_ne_u32 vcc, s97, v11
s_nop 0
s_cbranch_vccz L_ok_36
s_mov_b32 s14, 0x200000
L_poll_37:
buffer_load_dword v11, v10, s[24:27], s12 offen sc1
s_waitcnt vmcnt(0)
v_cmp_ne_u32 vcc, s97, v11
s_sub_u32 s14, s14, 1
s_cmp_eq_u32 s14, 0
s_cbranch_scc1 L_pollx_38
s_cbranch_vccz L_pollx_38
s_sleep 8
s_branch L_poll_37
L_pollx_38:
L_ok_36:
v_lshrrev_b32 v10, 3, v1
v_and_b32 v11, 7, v1
v_xor_b32 v11, v11, v10
v_lshlrev_b32 v11, 4, v11
s_lshl_b32 s10, s5, 5
v_add_u32 v10, s10, v10
v_lshlrev_b32 v10, 11, v10
v_add_u32 v12, v10, v11
s_lshl_b32 s12, s8, 18
s_lshl_b32 s11, s9, 7
s_add_u32 s12, s12, s11
s_lshl_b32 s11, s5, 12
s_add_u32 m0, s11, 98304
v_add_u32 v13, 0, v12
buffer_load_dwordx4 v13, s[16:19], s12 offen offset:0 lds
v_add_u32 v13, 15360, v12
buffer_load_dwordx4 v13, s[16:19], s12 offen offset:1024 lds
v_add_u32 v13, 30720, v12
buffer_load_dwordx4 v13, s[16:19], s12 offen offset:2048 lds
v_add_u32 v13, 46080, v12
buffer_load_dwordx4 v13, s[16:19], s12 offen offset:3072 lds
v_lshrrev_b32 v10, 4, v1
v_and_b32 v11, 15, v1
v_lshrrev_b32 v14, 1, v11
v_and_b32 v11, 1, v11
s_lshl_b32 s12, s9, 6
s_lshl_b32 s11, s5, 4
s_add_u32 s12, s12, s11
s_mul_i32 s12, s12, 4224
s_lshl_b32 s11, s8, 8
s_add_u32 s12, s12, s11
s_add_u32 s12, s12, 16777216
s_lshl_b32 s11, s5, 12
s_add_u32 m0, s11, 114688
v_add_u32 v15, 0, v10
v_and_b32 v16, 7, v15
v_xor_b32 v16, v16, v14
v_lshlrev_b32 v16, 1, v16
v_or_b32 v16, v16, v11
v_lshlrev_b32 v16, 4, v16
v_mul_u32_u24 v15, 4224, v15
v_add_u32 v15, v15, v16
v_subrev_u32 v15, 0, v15
buffer_load_dwordx4 v15, s[24:27], s12 offen offset:0 sc1 lds
v_add_u32 v15, 4, v10
v_and_b32 v16, 7, v15
v_xor_b32 v16, v16, v14
v_lshlrev_b32 v16, 1, v16
v_or_b32 v16, v16, v11
v_lshlrev_b32 v16, 4, v16
v_mul_u32_u24 v15, 4224, v15
v_add_u32 v15, v15, v16
v_subrev_u32 v15, 1024, v15
buffer_load_dwordx4 v15, s[24:27], s12 offen offset:1024 sc1 lds
v_add_u32 v15, 8, v10
v_and_b32 v16, 7, v15
v_xor_b32 v16, v16, v14
v_lshlrev_b32 v16, 1, v16
v_or_b32 v16, v16, v11
v_lshlrev_b32 v16, 4, v16
v_mul_u32_u24 v15, 4224, v15
v_add_u32 v15, v15, v16
v_subrev_u32 v15, 2048, v15
buffer_load_dwordx4 v15, s[24:27], s12 offen offset:2048 sc1 lds
v_add_u32 v15, 12, v10
v_and_b32 v16, 7, v15
v_xor_b32 v16, v16, v14
v_lshlrev_b32 v16, 1, v16
v_or_b32 v16, v16, v11
v_lshlrev_b32 v16, 4, v16
v_mul_u32_u24 v15, 4224, v15
v_add_u32 v15, v15, v16
v_subrev_u32 v15, 3072, v15
buffer_load_dwordx4 v15, s[24:27], s12 offen offset:3072 sc1 lds
s_waitcnt vmcnt(25)
s_barrier
s_waitcnt vmcnt(16)
s_mov_b32 s98, 0x0
s_mov_b32 s99, 0xf000000
s_and_b32 s10, s9, 1
s_cmp_eq_u32 s10, 0
s_cselect_b32 s98, 0xf00000, s98
s_cselect_b32 s99, 0x0, s99
v_cmp_ne_u32 vcc, s97, v113
s_nop 1
s_and_b64 vcc, vcc, s[98:99]
s_cbranch_scc0 L_hok_39
s_mov_b32 s14, 0x200000
L_hlp_40:
buffer_load_dword v113, v112, s[24:27], s63 offen sc1
s_waitcnt vmcnt(0)
v_cmp_ne_u32 vcc, s97, v113
s_sub_u32 s14, s14, 1
s_cmp_eq_u32 s14, 0
s_cbranch_scc1 L_hok_39
s_and_b64 vcc, vcc, s[98:99]
s_cbranch_scc0 L_hok_39
s_sleep 8
s_branch L_hlp_40
L_hok_39:
s_add_u32 m0, s53, 0
s_add_u32 s10, s57, 2228224
buffer_load_dwordx4 v4, s[28:31], s10 offen offset:0 lds
buffer_load_dwordx4 v5, s[28:31], s10 offen offset:1024 lds
s_add_u32 m0, s53, 8192
s_add_u32 s10, s58, 2228224
buffer_load_dwordx4 v4, s[28:31], s10 offen offset:0 lds
buffer_load_dwordx4 v5, s[28:31], s10 offen offset:1024 lds
s_add_u32 m0, s51, 0
s_add_u32 s10, s56, 34816
buffer_load_dwordx4 v2, s[24:27], s10 offen offset:0 sc1 lds
buffer_load_dwordx4 v2, s[24:27], s10 offen offset:1024 sc1 lds
buffer_load_dwordx4 v3, s[24:27], s10 offen offset:2048 sc1 lds
buffer_load_dwordx4 v3, s[24:27], s10 offen offset:3072 sc1 lds
s_barrier
s_add_u32 m0, s53, 32768
s_add_u32 s10, s57, 2359296
buffer_load_dwordx4 v4, s[28:31], s10 offen offset:0 lds
buffer_load_dwordx4 v5, s[28:31], s10 offen offset:1024 lds
s_add_u32 m0, s53, 40960
s_add_u32 s10, s58, 2359296
buffer_load_dwordx4 v4, s[28:31], s10 offen offset:0 lds
buffer_load_dwordx4 v5, s[28:31], s10 offen offset:1024 lds
s_add_u32 m0, s51, 32768
s_add_u32 s10, s56, 36864
buffer_load_dwordx4 v2, s[24:27], s10 offen offset:0 sc1 lds
buffer_load_dwordx4 v2, s[24:27], s10 offen offset:1024 sc1 lds
buffer_load_dwordx4 v3, s[24:27], s10 offen offset:2048 sc1 lds
buffer_load_dwordx4 v3, s[24:27], s10 offen offset:3072 sc1 lds
s_waitcnt vmcnt(24)
s_barrier
buffer_load_dword v113, v112, s[24:27], s63 offen sc1
s_add_u32 m0, s53, 65536
s_add_u32 s10, s57, 2490368
buffer_load_dwordx4 v4, s[28:31], s10 offen offset:0 lds
buffer_load_dwordx4 v5, s[28:31], s10 offen offset:1024 lds
s_add_u32 m0, s53, 73728
s_add_u32 s10, s58, 2490368
buffer_load_dwordx4 v4, s[28:31], s10 offen offset:0 lds
buffer_load_dwordx4 v5, s[28:31], s10 offen offset:1024 lds
s_add_u32 m0, s51, 65536
s_add_u32 s10, s56, 38912
buffer_load_dwordx4 v2, s[24:27], s10 offen offset:0 sc1 lds
buffer_load_dwordx4 v2, s[24:27], s10 offen offset:1024 sc1 lds
buffer_load_dwordx4 v3, s[24:27], s10 offen offset:2048 sc1 lds
buffer_load_dwordx4 v3, s[24:27], s10 offen offset:3072 sc1 lds
s_waitcnt vmcnt(17)
s_barrier
s_waitcnt vmcnt(8)
s_mov_b32 s98, 0x0
s_mov_b32 s99, 0xf0000000
s_and_b32 s10, s9, 1
s_cmp_eq_u32 s10, 0
s_cselect_b32 s98, 0xf000000, s98
s_cselect_b32 s99, 0x0, s99
v_cmp_ne_u32 vcc, s97, v113
s_nop 1
s_and_b64 vcc, vcc, s[98:99]
s_cbranch_scc0 L_hok_41
s_mov_b32 s14, 0x200000
L_hlp_42:
buffer_load_dword v113, v112, s[24:27], s63 offen sc1
s_waitcnt vmcnt(0)
v_cmp_ne_u32 vcc, s97, v113
s_sub_u32 s14, s14, 1
s_cmp_eq_u32 s14, 0
s_cbranch_scc1 L_hok_41
s_and_b64 vcc, vcc, s[98:99]
s_cbranch_scc0 L_hok_41
s_sleep 8
s_branch L_hlp_42
L_hok_41:
s_add_u32 m0, s53, 131072
s_add_u32 s10, s57, 2621440
buffer_load_dwordx4 v4, s[28:31], s10 offen offset:0 lds
buffer_load_dwordx4 v5, s[28:31], s10 offen offset:1024 lds
s_add_u32 m0, s53, 139264
s_add_u32 s10, s58, 2621440
buffer_load_dwordx4 v4, s[28:31], s10 offen offset:0 lds
buffer_load_dwordx4 v5, s[28:31], s10 offen offset:1024 lds
s_add_u32 m0, s51, 131072
s_add_u32 s10, s56, 40960
buffer_load_dwordx4 v2, s[24:27], s10 offen offset:0 sc1 lds
buffer_load_dwordx4 v2, s[24:27], s10 offen offset:1024 sc1 lds
buffer_load_dwordx4 v3, s[24:27], s10 offen offset:2048 sc1 lds
buffer_load_dwordx4 v3, s[24:27], s10 offen offset:3072 sc1 lds
s_barrier
s_add_u32 m0, s53, 0
s_add_u32 s10, s57, 2752512
buffer_load_dwordx4 v4, s[28:31], s10 offen offset:0 lds
buffer_load_dwordx4 v5, s[28:31], s10 offen offset:1024 lds
s_add_u32 m0, s53, 8192
s_add_u32 s10, s58, 2752512
buffer_load_dwordx4 v4, s[28:31], s10 offen offset:0 lds
buffer_load_dwordx4 v5, s[28:31], s10 offen offset:1024 lds
s_add_u32 m0, s51, 0
s_add_u32 s10, s56, 43008
buffer_load_dwordx4 v2, s[24:27], s10 offen offset:0 sc1 lds
buffer_load_dwordx4 v2, s[24:27], s10 offen offset:1024 sc1 lds
buffer_load_dwordx4 v3, s[24:27], s10 offen offset:2048 sc1 lds
buffer_load_dwordx4 v3, s[24:27], s10 offen offset:3072 sc1 lds
s_waitcnt vmcnt(16)
s_barrier
s_add_u32 m0, s53, 32768
s_add_u32 s10, s57, 2883584
buffer_load_dwordx4 v4, s[28:31], s10 offen offset:0 lds
buffer_load_dwordx4 v5, s[28:31], s10 offen offset:1024 lds
s_add_u32 m0, s53, 40960
s_add_u32 s10, s58, 2883584
buffer_load_dwordx4 v4, s[28:31], s10 offen offset:0 lds
buffer_load_dwordx4 v5, s[28:31], s10 offen offset:1024 lds
s_add_u32 m0, s51, 32768
s_add_u32 s10, s56, 45056
buffer_load_dwordx4 v2, s[24:27], s10 offen offset:0 sc1 lds
buffer_load_dwordx4 v2, s[24:27], s10 offen offset:1024 sc1 lds
buffer_load_dwordx4 v3, s[24:27], s10 offen offset:2048 sc1 lds
buffer_load_dwordx4 v3, s[24:27], s10 offen offset:3072 sc1 lds
s_waitcnt vmcnt(16)
s_barrier
buffer_load_dword v113, v112, s[24:27], s63 offen sc1
s_add_u32 m0, s53, 65536
s_add_u32 s10, s57, 3014656
buffer_load_dwordx4 v4, s[28:31], s10 offen offset:0 lds
buffer_load_dwordx4 v5, s[28:31], s10 offen offset:1024 lds
s_add_u32 m0, s53, 73728
s_add_u32 s10, s58, 3014656
buffer_load_dwordx4 v4, s[28:31], s10 offen offset:0 lds
buffer_load_dwordx4 v5, s[28:31], s10 offen offset:1024 lds
s_add_u32 m0, s51, 65536
s_add_u32 s10, s56, 47104
buffer_load_dwordx4 v2, s[24:27], s10 offen offset:0 sc1 lds
buffer_load_dwordx4 v2, s[24:27], s10 offen offset:1024 sc1 lds
buffer_load_dwordx4 v3, s[24:27], s10 offen offset:2048 sc1 lds
buffer_load_dwordx4 v3, s[24:27], s10 offen offset:3072 sc1 lds
s_waitcnt vmcnt(17)
s_barrier
s_waitcnt vmcnt(8)
s_mov_b32 s98, 0xff000000
s_mov_b32 s99, 0x0
s_and_b32 s10, s9, 1
s_cmp_eq_u32 s10, 0
s_cselect_b32 s98, 0xf0000000, s98
s_cselect_b32 s99, 0x0, s99
v_cmp_ne_u32 vcc, s97, v113
s_nop 1
s_and_b64 vcc, vcc, s[98:99]
s_cbranch_scc0 L_hok_43
s_mov_b32 s14, 0x200000
L_hlp_44:
buffer_load_dword v113, v112, s[24:27], s63 offen sc1
s_waitcnt vmcnt(0)
v_cmp_ne_u32 vcc, s97, v113
s_sub_u32 s14, s14, 1
s_cmp_eq_u32 s14, 0
s_cbranch_scc1 L_hok_43
s_and_b64 vcc, vcc, s[98:99]
s_cbranch_scc0 L_hok_43
s_sleep 8
s_branch L_hlp_44
L_hok_43:
s_add_u32 m0, s53, 131072
s_add_u32 s10, s52, 3145728
buffer_load_dwordx4 v4, s[28:31], s10 offen offset:0 lds
buffer_load_dwordx4 v5, s[28:31], s10 offen offset:1024 lds
s_add_u32 m0, s51, 131072
s_add_u32 s10, s50, 49152
buffer_load_dwordx4 v2, s[24:27], s10 offen offset:0 sc1 lds
buffer_load_dwordx4 v2, s[24:27], s10 offen offset:1024 sc1 lds
buffer_load_dwordx4 v3, s[24:27], s10 offen offset:2048 sc1 lds
buffer_load_dwordx4 v3, s[24:27], s10 offen offset:3072 sc1 lds
s_barrier
s_add_u32 m0, s53, 0
s_add_u32 s10, s52, 3276800
buffer_load_dwordx4 v4, s[28:31], s10 offen offset:0 lds
buffer_load_dwordx4 v5, s[28:31], s10 offen offset:1024 lds
s_add_u32 m0, s51, 0
s_add_u32 s10, s50, 51200
buffer_load_dwordx4 v2, s[24:27], s10 offen offset:0 sc1 lds
buffer_load_dwordx4 v2, s[24:27], s10 offen offset:1024 sc1 lds
buffer_load_dwordx4 v3, s[24:27], s10 offen offset:2048 sc1 lds
buffer_load_dwordx4 v3, s[24:27], s10 offen offset:3072 sc1 lds
s_waitcnt vmcnt(12)
s_barrier
s_add_u32 m0, s53, 32768
s_add_u32 s10, s52, 3407872
buffer_load_dwordx4 v4, s[28:31], s10 offen offset:0 lds
buffer_load_dwordx4 v5, s[28:31], s10 offen offset:1024 lds
s_add_u32 m0, s51, 32768
s_add_u32 s10, s50, 53248
buffer_load_dwordx4 v2, s[24:27], s10 offen offset:0 sc1 lds
buffer_load_dwordx4 v2, s[24:27], s10 offen offset:1024 sc1 lds
buffer_load_dwordx4 v3, s[24:27], s10 offen offset:2048 sc1 lds
buffer_load_dwordx4 v3, s[24:27], s10 offen offset:3072 sc1 lds
s_waitcnt vmcnt(12)
s_barrier
buffer_load_dword v113, v112, s[24:27], s63 offen sc1
s_add_u32 m0, s53, 65536
s_add_u32 s10, s52, 3538944
buffer_load_dwordx4 v4, s[28:31], s10 offen offset:0 lds
buffer_load_dwordx4 v5, s[28:31], s10 offen offset:1024 lds
s_add_u32 m0, s51, 65536
s_add_u32 s10, s50, 55296
buffer_load_dwordx4 v2, s[24:27], s10 offen offset:0 sc1 lds
buffer_load_dwordx4 v2, s[24:27], s10 offen offset:1024 sc1 lds
buffer_load_dwordx4 v3, s[24:27], s10 offen offset:2048 sc1 lds
buffer_load_dwordx4 v3, s[24:27], s10 offen offset:3072 sc1 lds
s_waitcnt vmcnt(13)
s_barrier
s_waitcnt vmcnt(6)
s_mov_b32 s98, 0x0
s_mov_b32 s99, 0xf
s_and_b32 s10, s9, 1
s_cmp_eq_u32 s10, 0
s_cselect_b32 s98, 0x0, s98
s_cselect_b32 s99, 0xf, s99
v_cmp_ne_u32 vcc, s97, v113
s_nop 1
s_and_b64 vcc, vcc, s[98:99]
s_cbranch_scc0 L_hok_45
s_mov_b32 s14, 0x200000
L_hlp_46:
buffer_load_dword v113, v112, s[24:27], s63 offen sc1
s_waitcnt vmcnt(0)
v_cmp_ne_u32 vcc, s97, v113
s_sub_u32 s14, s14, 1
s_cmp_eq_u32 s14, 0
s_cbranch_scc1 L_hok_45
s_and_b64 vcc, vcc, s[98:99]
s_cbranch_scc0 L_hok_45
s_sleep 8
s_branch L_hlp_46
L_hok_45:
s_add_u32 m0, s53, 131072
s_add_u32 s10, s52, 3670016
buffer_load_dwordx4 v4, s[28:31], s10 offen offset:0 lds
buffer_load_dwordx4 v5, s[28:31], s10 offen offset:1024 lds
s_add_u32 m0, s51, 131072
s_add_u32 s10, s50, 57344
buffer_load_dwordx4 v2, s[24:27], s10 offen offset:0 sc1 lds
buffer_load_dwordx4 v2, s[24:27], s10 offen offset:1024 sc1 lds
buffer_load_dwordx4 v3, s[24:27], s10 offen offset:2048 sc1 lds
buffer_load_dwordx4 v3, s[24:27], s10 offen offset:3072 sc1 lds
s_barrier
s_add_u32 m0, s53, 0
s_add_u32 s10, s52, 3801088
buffer_load_dwordx4 v4, s[28:31], s10 offen offset:0 lds
buffer_load_dwordx4 v5, s[28:31], s10 offen offset:1024 lds
s_add_u32 m0, s51, 0
s_add_u32 s10, s50, 59392
buffer_load_dwordx4 v2, s[24:27], s10 offen offset:0 sc1 lds
buffer_load_dwordx4 v2, s[24:27], s10 offen offset:1024 sc1 lds
buffer_load_dwordx4 v3, s[24:27], s10 offen offset:2048 sc1 lds
buffer_load_dwordx4 v3, s[24:27], s10 offen offset:3072 sc1 lds
s_waitcnt vmcnt(12)
s_barrier
buffer_load_dword v113, v112, s[24:27], s63 offen sc1
s_add_u32 m0, s53, 32768
s_add_u32 s10, s52, 3932160
buffer_load_dwordx4 v4, s[28:31], s10 offen offset:0 lds
buffer_load_dwordx4 v5, s[28:31], s10 offen offset:1024 lds
s_add_u32 m0, s51, 32768
s_add_u32 s10, s50, 61440
buffer_load_dwordx4 v2, s[24:27], s10 offen offset:0 sc1 lds
buffer_load_dwordx4 v2, s[24:27], s10 offen offset:1024 sc1 lds
buffer_load_dwordx4 v3, s[24:27], s10 offen offset:2048 sc1 lds
buffer_load_dwordx4 v3, s[24:27], s10 offen offset:3072 sc1 lds
s_waitcnt vmcnt(13)
s_barrier
s_waitcnt vmcnt(6)
s_mov_b32 s98, 0x0
s_mov_b32 s99, 0x0
s_and_b32 s10, s9, 1
s_cmp_eq_u32 s10, 0
s_cselect_b32 s98, 0x0, s98
s_cselect_b32 s99, 0xf0, s99
v_cmp_ne_u32 vcc, s97, v113
s_nop 1
s_and_b64 vcc, vcc, s[98:99]
s_cbranch_scc0 L_hok_47
s_mov_b32 s14, 0x200000
L_hlp_48:
buffer_load_dword v113, v112, s[24:27], s63 offen sc1
s_waitcnt vmcnt(0)
v_cmp_ne_u32 vcc, s97, v113
s_sub_u32 s14, s14, 1
s_cmp_eq_u32 s14, 0
s_cbranch_scc1 L_hok_47
s_and_b64 vcc, vcc, s[98:99]
s_cbranch_scc0 L_hok_47
s_sleep 8
s_branch L_hlp_48
L_hok_47:
s_add_u32 m0, s53, 65536
s_add_u32 s10, s52, 4063232
buffer_load_dwordx4 v4, s[28:31], s10 offen offset:0 lds
buffer_load_dwordx4 v5, s[28:31], s10 offen offset:1024 lds
s_add_u32 m0, s51, 65536
s_add_u32 s10, s50, 63488
buffer_load_dwordx4 v2, s[24:27], s10 offen offset:0 sc1 lds
buffer_load_dwordx4 v2, s[24:27], s10 offen offset:1024 sc1 lds
buffer_load_dwordx4 v3, s[24:27], s10 offen offset:2048 sc1 lds
buffer_load_dwordx4 v3, s[24:27], s10 offen offset:3072 sc1 lds
s_barrier
s_waitcnt vmcnt(6)
s_barrier
s_lshl_b32 s59, s8, 4
s_xor_b32 s11, s9, 1
s_add_u32 s59, s59, s11
s_lshl_b32 s59, s59, 2
s_add_u32 s59, s59, s5
s_lshl_b32 s60, s59, 2
s_add_u32 s60, s60, 27668480
s_lshl_b32 s59, s59, 13
s_add_u32 s59, s59, 41943040
v_mov_b32 v20, 0
buffer_load_dword v21, v20, s[24:27], s60 offen sc1
s_waitcnt vmcnt(1)
s_barrier
s_waitcnt vmcnt(0)
v_cmp_ne_u32 vcc, s97, v21
s_nop 0
s_cbranch_vccz L_ok_49
s_mov_b32 s14, 0x200000
L_poll_50:
buffer_load_dword v21, v20, s[24:27], s60 offen sc1
s_waitcnt vmcnt(0)
v_cmp_ne_u32 vcc, s97, v21
s_sub_u32 s14, s14, 1
s_cmp_eq_u32 s14, 0
s_cbranch_scc1 L_pollx_51
s_cbranch_vccz L_pollx_51
s_sleep 8
s_branch L_poll_50
L_pollx_51:
L_ok_49:
s_sub_u32 s10, s5, 1
s_lshl_b32 s10, s10, 15
s_cmp_eq_u32 s5, 0
s_cselect_b32 s10, 131072, s10
s_add_u32 s10, s10, 24576
v_lshlrev_b32 v22, 4, v1
s_add_u32 m0, s10, 0
s_add_u32 s11, s59, 0
buffer_load_dwordx4 v22, s[24:27], s11 offen offset:0 sc1 lds
buffer_load_dwordx4 v22, s[24:27], s11 offen offset:1024 sc1 lds
buffer_load_dwordx4 v22, s[24:27], s11 offen offset:2048 sc1 lds
buffer_load_dwordx4 v22, s[24:27], s11 offen offset:3072 sc1 lds
s_add_u32 m0, s10, 4096
s_add_u32 s11, s59, 4096
buffer_load_dwordx4 v22, s[24:27], s11 offen offset:0 sc1 lds
buffer_load_dwordx4 v22, s[24:27], s11 offen offset:1024 sc1 lds
buffer_load_dwordx4 v22, s[24:27], s11 offen offset:2048 sc1 lds
buffer_load_dwordx4 v22, s[24:27], s11 offen offset:3072 sc1 lds
s_barrier
s_waitcnt vmcnt(0)
s_barrier
s_cmp_eq_u32 s4, 4
s_cbranch_scc0 L_ep_52
s_cmp_eq_u32 s2, 0
s_cbranch_scc0 L_ep_52
v_lshlrev_b32 v112, 2, v1
s_lshl_b32 s63, s8, 8
s_add_u32 s63, s63, 27660288
s_mov_b32 s14, 0x200000
L_poll_53:
buffer_load_dword v113, v112, s[24:27], s63 offen sc1
s_waitcnt vmcnt(0)
v_cmp_ne_u32 vcc, s97, v113
s_sub_u32 s14, s14, 1
s_cmp_eq_u32 s14, 0
s_cbranch_scc1 L_pollx_54
s_cbranch_vccz L_pollx_54
s_sleep 8
s_branch L_poll_53
L_pollx_54:
s_mov_b32 s10, 27688960
v_mov_b32 v2, 0
v_mov_b32 v3, s97
buffer_store_dword v3, v2, s[24:27], s10 offen sc1
L_ep_52:
s_barrier
s_mov_b32 s32, s86
s_and_b32 s33, s87, 0xffff
s_mov_b32 s34, 4194304
s_mov_b32 s35, 0x20000
v_lshrrev_b32 v8, 3, v1
v_and_b32 v9, 7, v1
s_lshl_b32 s10, s4, 4
v_add_u32 v10, s10, v8
v_lshlrev_b32 v11, 7, v10
v_xor_b32 v12, v9, v8
v_lshlrev_b32 v12, 4, v12
v_add_u32 v11, v11, v12
v_add_u32 v11, 98304, v11
s_lshl_b32 s10, s8, 7
v_add_u32 v10, s10, v10
v_lshlrev_b32 v10, 11, v10
v_lshlrev_b32 v9, 4, v9
v_add_u32 v10, v10, v9
s_lshl_b32 s10, s9, 7
ds_read_b128 v[16:19], v11 offset:0
ds_read_b128 v[20:23], v11 offset:1024
s_waitcnt lgkmcnt(1)
s_add_u32 s11, s10, 0
buffer_store_dwordx4 v[16:19], v10, s[32:35], s11 offen
s_waitcnt lgkmcnt(0)
s_add_u32 s11, s10, 16384
buffer_store_dwordx4 v[20:23], v10, s[32:35], s11 offen
L_end_parallel_sum__ssm_conv_h3__mixer_channel_mlp__prompt_kernel:
s_endpgm
.section .rodata,"a"
.p2align 6
.amdhsa_kernel parallel_sum__ssm_conv_h3__mixer_channel_mlp__prompt_kernel
  .amdhsa_next_free_vgpr 256
  .amdhsa_next_free_sgpr 102
  .amdhsa_accum_offset 160
  .amdhsa_group_segment_fixed_size 0
  .amdhsa_kernarg_size 112
  .amdhsa_user_sgpr_count 2
  .amdhsa_user_sgpr_kernarg_segment_ptr 1
  .amdhsa_system_sgpr_workgroup_id_x 1
.end_amdhsa_kernel
.text
```
